```python
import torch

def _softmax(x, axis=-1):
    return torch.softmax(x, dim=axis)
def _gelu(x):
    return torch.nn.functional.gelu(x, approximate="tanh")
def _silu(x):
    return torch.nn.functional.silu(x)
def _sigmoid(x):
    return torch.sigmoid(x)
def _layernorm(x, axis=-1, eps=1e-5):
    m = x.mean(dim=axis, keepdim=True)
    v = x.var(dim=axis, keepdim=True, unbiased=False)
    return (x - m) / torch.sqrt(v + eps)
def _scatter_add(tgt, idx, src, axis=0):
    return tgt.clone().index_add_(axis, idx, src)
def _segment_sum(src, seg, n):
    out = torch.zeros((n,) + src.shape[1:], dtype=src.dtype)
    return out.index_add_(0, seg, src)
def _pad(x, pw):
    flat = tuple(v for pair in reversed(pw) for v in pair)
    return torch.nn.functional.pad(x, flat)

kernel_name = 'sequential_preLN__sliding_block__dense_activation_relu__prompt'

def setup_inputs():

    _w = (lambda a: (lambda t: t.to(torch.bfloat16) if t.is_floating_point() else t)(torch.as_tensor(a)))
    def _A_setup():
        B, S, D = 1, 2048, 512
        return {
            "x": _w((lambda *s: torch.randn(*s, dtype=torch.bfloat16) * 0.05)(B, S, D)),
            "wqkv": _w((lambda *s: torch.randn(*s, dtype=torch.bfloat16) * 0.05)(D, 3 * D)),
            "wo": _w((lambda *s: torch.randn(*s, dtype=torch.bfloat16) * 0.05)(D, D)),
        }
    _A_in = _A_setup()

    def _B_setup():
        B, S, D, Dff = 1, 2048, 512, 1376
        return {
            "x": _w((lambda *s: torch.randn(*s, dtype=torch.bfloat16) * 0.05)(B, S, D)),
            "w1": _w((lambda *s: torch.randn(*s, dtype=torch.bfloat16) * 0.05)(D, Dff)),
            "w2": _w((lambda *s: torch.randn(*s, dtype=torch.bfloat16) * 0.05)(Dff, D)),
        }
    _B_in = _B_setup()

    return {
        "A_x": _A_in["x"],
        "A_wqkv": _A_in["wqkv"],
        "A_wo": _A_in["wo"],
        "B_x": _B_in["x"],
        "B_w1": _B_in["w1"],
        "B_w2": _B_in["w2"],
    }

def reference(A_x, A_wqkv, A_wo, B_x, B_w1, B_w2):
    def _A_ref(x, wqkv, wo):
        B, S, D = x.shape
        H = 32; Dh = D // H; W = 256
        qkv = (lambda x, *d: x.permute(*d))((x @ wqkv).reshape(B, S, 3, H, Dh), 2, 0, 3, 1, 4)
        q, k, v = qkv[0], qkv[1], qkv[2]
        scores = torch.einsum("bhqd,bhkd->bhqk", q, k) * (Dh ** -0.5)
        idx = torch.arange(S)
        mask = (idx[:, None] - idx[None, :] >= 0) & (idx[:, None] - idx[None, :] < W)
        scores = torch.where(mask[None, None], scores, -1e9)
        p = _softmax(scores, axis=-1)
        o = torch.einsum("bhqk,bhkd->bhqd", p, v)
        return (lambda x, *d: x.permute(*d))(o, 0, 2, 1, 3).reshape(B, S, D) @ wo

    def _B_ref(x, w1, w2):
        h = torch.einsum("bsd,df->bsf", x, w1)
        zero = torch.zeros_like(h)
        h = torch.maximum(h, zero)
        return torch.einsum("bsf,fd->bsd", h, w2)

    x = A_x
    h = x + _A_ref(_layernorm(x, axis=-1), A_wqkv, A_wo)
    h2 = h + _B_ref(_layernorm(h, axis=-1), B_w1, B_w2)
    return h2
```

```asm
; @launch kernel=k1_qkv_kernel grid=(256,1,1) block=(512,1,1) lds=145408
; @launch kernel=k2_attn_kernel grid=(256,1,1) block=(1024,1,1) lds=90112
; @launch kernel=k3_wo_kernel grid=(256,1,1) block=(512,1,1) lds=133120
; @launch kernel=k4_w1_kernel grid=(240,1,1) block=(512,1,1) lds=145408
; @launch kernel=k5_w2_kernel grid=(256,1,1) block=(512,1,1) lds=133120
.amdgcn_target "amdgcn-amd-amdhsa--gfx950"
.text
.globl k1_qkv_kernel
.p2align 8
.type k1_qkv_kernel,@function
k1_qkv_kernel:
    s_cmp_ge_u32 s2, 256
    s_cbranch_scc1 k1_qkv_kernel_end
    s_load_dwordx2 s[4:5], s[0:1], 0
    s_load_dwordx2 s[6:7], s[0:1], 8
    s_load_dwordx2 s[34:35], s[0:1], 64
    v_lshrrev_b32 v1, 6, v0
    v_and_b32 v2, 63, v0
    s_lshr_b32 s27, s2, 3
    s_lshr_b32 s28, s27, 4
    s_and_b32 s29, s27, 15
    s_and_b32 s27, s2, 7
    s_mul_i32 s27, s27, 2
    s_add_u32 s28, s28, s27
    v_readfirstlane_b32 s24, v1
    s_mul_i32 s25, s28, 128
    s_mul_i32 s26, s29, 96
    v_and_b32 v3, 15, v2
    v_lshrrev_b32 v4, 4, v2
    s_cmp_ge_u32 s24, 4
    s_cbranch_scc1 k1_qkv_kernel_loader
    s_mul_i32 s32, s24, 32
    s_mul_i32 s27, s24, 4096
    s_mov_b32 s33, s26
    s_mov_b32 s28, 2048
    s_add_u32 s32, s32, s25
    s_add_u32 s27, s27, 2048
    v_and_b32 v8, 3, v2
    v_bfe_u32 v9, v2, 2, 2
    v_lshl_add_u32 v9, v4, 3, v9
    v_lshlrev_b32 v9, 6, v9
    v_lshl_add_u32 v9, v8, 3, v9
    v_add_u32 v9, s28, v9
    v_and_b32 v10, 1, v4
    v_lshlrev_b32 v10, 5, v10
    v_xor_b32 v11, 32, v10
    v_add_u32 v10, v9, v10
    v_add_u32 v11, v9, v11
    v_lshlrev_b32 v9, 7, v3
    v_add_u32 v9, s27, v9
    v_lshrrev_b32 v8, 1, v3
    v_xor_b32 v12, v4, v8
    v_xor_b32 v13, 4, v12
    v_lshl_add_u32 v12, v12, 4, v9
    v_lshl_add_u32 v13, v13, 4, v9
    s_add_u32 s27, s24, 4
    s_cmp_lt_u32 s24, 2
    s_cselect_b32 s28, s27, s24
    s_lshr_b32 s27, s24, 1
    s_mul_i32 s27, s27, 4096
    s_and_b32 s29, s24, 1
    s_cmp_eq_u32 s29, 0
    s_cselect_b64 vcc, -1, 0
    v_cndmask_b32 v14, v11, v10, vcc
    v_add_u32 v14, s27, v14
    s_lshl_b32 s48, s24, 6
    s_lshr_b32 s27, s28, 1
    s_mul_i32 s27, s27, 4096
    s_and_b32 s29, s28, 1
    s_cmp_eq_u32 s29, 0
    s_cselect_b64 vcc, -1, 0
    v_cndmask_b32 v15, v11, v10, vcc
    v_add_u32 v15, s27, v15
    s_lshl_b32 s49, s28, 6
    v_mov_b32 v80, 0
    v_mov_b32 v81, 0
    v_mov_b32 v82, 0
    v_mov_b32 v83, 0
    v_mov_b32 v84, 0
    v_mov_b32 v85, 0
    v_mov_b32 v86, 0
    v_mov_b32 v87, 0
    v_mov_b32 v88, 0
    v_mov_b32 v89, 0
    v_mov_b32 v90, 0
    v_mov_b32 v91, 0
    v_mov_b32 v92, 0
    v_mov_b32 v93, 0
    v_mov_b32 v94, 0
    v_mov_b32 v95, 0
    v_mov_b32 v96, 0
    v_mov_b32 v97, 0
    v_mov_b32 v98, 0
    v_mov_b32 v99, 0
    v_mov_b32 v100, 0
    v_mov_b32 v101, 0
    v_mov_b32 v102, 0
    v_mov_b32 v103, 0
    v_mov_b32 v104, 0
    v_mov_b32 v105, 0
    v_mov_b32 v106, 0
    v_mov_b32 v107, 0
    v_mov_b32 v108, 0
    v_mov_b32 v109, 0
    v_mov_b32 v110, 0
    v_mov_b32 v111, 0
    v_mov_b32 v112, 0
    v_mov_b32 v113, 0
    v_mov_b32 v114, 0
    v_mov_b32 v115, 0
    v_mov_b32 v116, 0
    v_mov_b32 v117, 0
    v_mov_b32 v118, 0
    v_mov_b32 v119, 0
    v_mov_b32 v120, 0
    v_mov_b32 v121, 0
    v_mov_b32 v122, 0
    v_mov_b32 v123, 0
    v_mov_b32 v124, 0
    v_mov_b32 v125, 0
    v_mov_b32 v126, 0
    v_mov_b32 v127, 0
    v_mov_b32 v128, 0
    v_mov_b32 v129, 0
    v_mov_b32 v130, 0
    v_mov_b32 v131, 0
    v_mov_b32 v132, 0
    v_mov_b32 v133, 0
    v_mov_b32 v134, 0
    v_mov_b32 v135, 0
    v_mov_b32 v136, 0
    v_mov_b32 v137, 0
    v_mov_b32 v138, 0
    v_mov_b32 v139, 0
    v_mov_b32 v140, 0
    v_mov_b32 v141, 0
    v_mov_b32 v142, 0
    v_mov_b32 v143, 0
    v_mov_b32 v144, 0
    v_mov_b32 v145, 0
    v_mov_b32 v146, 0
    v_mov_b32 v147, 0
    v_mov_b32 v148, 0
    v_mov_b32 v149, 0
    v_mov_b32 v150, 0
    v_mov_b32 v151, 0
    v_mov_b32 v152, 0
    v_mov_b32 v153, 0
    v_mov_b32 v154, 0
    v_mov_b32 v155, 0
    v_mov_b32 v156, 0
    v_mov_b32 v157, 0
    v_mov_b32 v158, 0
    v_mov_b32 v159, 0
    v_mov_b32 v160, 0
    v_mov_b32 v161, 0
    v_mov_b32 v162, 0
    v_mov_b32 v163, 0
    v_mov_b32 v164, 0
    v_mov_b32 v165, 0
    v_mov_b32 v166, 0
    v_mov_b32 v167, 0
    s_mov_b32 s41, 0x3f803f80
    v_mov_b32 v168, s41
    v_mov_b32 v169, s41
    v_mov_b32 v170, s41
    v_mov_b32 v171, s41
    s_mov_b32 s45, 0
    s_mov_b32 s46, 8
    s_mov_b32 s40, -114688
    s_waitcnt lgkmcnt(0)
    s_mov_b32 s16, s34
    s_mov_b32 s17, s35
    s_mov_b32 s18, 4194304
    s_mov_b32 s19, 0x00020000
    s_mov_b32 s20, s34
    s_mov_b32 s21, s35
    s_mov_b32 s22, 6291456
    s_mov_b32 s23, 0x00020000
    s_cmp_gt_u32 s26, 864
    s_cbranch_scc1 k1_qkv_kernel_var1
    s_barrier
    ds_read_b128 v[16:19], v12 offset:0
    ds_read_b128 v[20:23], v12 offset:2048
    ds_read_b64_tr_b16 v[32:33], v10 offset:16384
    ds_read_b64_tr_b16 v[34:35], v10 offset:16640
    ds_read_b64_tr_b16 v[36:37], v11 offset:16384
    ds_read_b64_tr_b16 v[38:39], v11 offset:16640
    ds_read_b64_tr_b16 v[40:41], v10 offset:20480
    ds_read_b64_tr_b16 v[42:43], v10 offset:20736
    s_waitcnt lgkmcnt(6)
    ds_read_b64_tr_b16 v[44:45], v11 offset:20480
    ds_read_b64_tr_b16 v[46:47], v11 offset:20736
    ds_read_b64_tr_b16 v[48:49], v10 offset:24576
    ds_read_b64_tr_b16 v[50:51], v10 offset:24832
    ds_read_b64_tr_b16 v[52:53], v11 offset:24576
    ds_read_b64_tr_b16 v[54:55], v11 offset:24832
    ds_read_b64_tr_b16 v[136:137], v14 offset:16384
    ds_read_b64_tr_b16 v[138:139], v14 offset:16640
    ds_read_b64_tr_b16 v[140:141], v15 offset:16384
    ds_read_b64_tr_b16 v[142:143], v15 offset:16640
    s_waitcnt lgkmcnt(0)
    ds_read_b128 v[24:27], v13 offset:0
    v_mfma_f32_16x16x32_bf16 v[80:83], v[32:35], v[16:19], v[80:83]
    ds_read_b128 v[28:31], v13 offset:2048
    v_mfma_f32_16x16x32_bf16 v[104:107], v[32:35], v[20:23], v[104:107]
    ds_read_b64_tr_b16 v[56:57], v10 offset:18432
    v_mfma_f32_16x16x32_bf16 v[152:155], v[168:171], v[16:19], v[152:155]
    ds_read_b64_tr_b16 v[58:59], v10 offset:18688
    v_mfma_f32_16x16x32_bf16 v[156:159], v[16:19], v[16:19], v[156:159]
    ds_read_b64_tr_b16 v[60:61], v11 offset:18432
    v_mfma_f32_16x16x32_bf16 v[84:87], v[36:39], v[16:19], v[84:87]
    ds_read_b64_tr_b16 v[62:63], v11 offset:18688
    v_mfma_f32_16x16x32_bf16 v[108:111], v[36:39], v[20:23], v[108:111]
    ds_read_b64_tr_b16 v[64:65], v10 offset:22528
    v_mfma_f32_16x16x32_bf16 v[160:163], v[168:171], v[20:23], v[160:163]
    ds_read_b64_tr_b16 v[66:67], v10 offset:22784
    v_mfma_f32_16x16x32_bf16 v[164:167], v[20:23], v[20:23], v[164:167]
    s_waitcnt lgkmcnt(6)
    v_mfma_f32_16x16x32_bf16 v[88:91], v[40:43], v[16:19], v[88:91]
    ds_read_b64_tr_b16 v[68:69], v11 offset:22528
    v_mfma_f32_16x16x32_bf16 v[112:115], v[40:43], v[20:23], v[112:115]
    ds_read_b64_tr_b16 v[70:71], v11 offset:22784
    v_mfma_f32_16x16x32_bf16 v[128:131], v[168:171], v[136:139], v[128:131]
    ds_read_b64_tr_b16 v[72:73], v10 offset:26624
    v_mfma_f32_16x16x32_bf16 v[92:95], v[44:47], v[16:19], v[92:95]
    ds_read_b64_tr_b16 v[74:75], v10 offset:26880
    v_mfma_f32_16x16x32_bf16 v[116:119], v[44:47], v[20:23], v[116:119]
    ds_read_b64_tr_b16 v[76:77], v11 offset:26624
    v_mfma_f32_16x16x32_bf16 v[132:135], v[168:171], v[140:143], v[132:135]
    ds_read_b64_tr_b16 v[78:79], v11 offset:26880
    v_mfma_f32_16x16x32_bf16 v[96:99], v[48:51], v[16:19], v[96:99]
    ds_read_b64_tr_b16 v[144:145], v14 offset:18432
    v_mfma_f32_16x16x32_bf16 v[120:123], v[48:51], v[20:23], v[120:123]
    ds_read_b64_tr_b16 v[146:147], v14 offset:18688
    v_mfma_f32_16x16x32_bf16 v[100:103], v[52:55], v[16:19], v[100:103]
    ds_read_b64_tr_b16 v[148:149], v15 offset:18432
    ds_read_b64_tr_b16 v[150:151], v15 offset:18688
    v_mfma_f32_16x16x32_bf16 v[124:127], v[52:55], v[20:23], v[124:127]
    s_waitcnt lgkmcnt(0)
    s_barrier
    v_add_u32 v10, 28672, v10
    v_add_u32 v11, 28672, v11
    v_add_u32 v12, 28672, v12
    v_add_u32 v13, 28672, v13
    v_add_u32 v14, 28672, v14
    v_add_u32 v15, 28672, v15
    ds_read_b128 v[16:19], v12 offset:0
    v_mfma_f32_16x16x32_bf16 v[80:83], v[56:59], v[24:27], v[80:83]
    ds_read_b128 v[20:23], v12 offset:2048
    v_mfma_f32_16x16x32_bf16 v[104:107], v[56:59], v[28:31], v[104:107]
    ds_read_b64_tr_b16 v[32:33], v10 offset:16384
    v_mfma_f32_16x16x32_bf16 v[152:155], v[168:171], v[24:27], v[152:155]
    ds_read_b64_tr_b16 v[34:35], v10 offset:16640
    v_mfma_f32_16x16x32_bf16 v[156:159], v[24:27], v[24:27], v[156:159]
    ds_read_b64_tr_b16 v[36:37], v11 offset:16384
    v_mfma_f32_16x16x32_bf16 v[84:87], v[60:63], v[24:27], v[84:87]
    ds_read_b64_tr_b16 v[38:39], v11 offset:16640
    v_mfma_f32_16x16x32_bf16 v[108:111], v[60:63], v[28:31], v[108:111]
    ds_read_b64_tr_b16 v[40:41], v10 offset:20480
    v_mfma_f32_16x16x32_bf16 v[160:163], v[168:171], v[28:31], v[160:163]
    ds_read_b64_tr_b16 v[42:43], v10 offset:20736
    v_mfma_f32_16x16x32_bf16 v[164:167], v[28:31], v[28:31], v[164:167]
    s_waitcnt lgkmcnt(6)
    v_mfma_f32_16x16x32_bf16 v[88:91], v[64:67], v[24:27], v[88:91]
    ds_read_b64_tr_b16 v[44:45], v11 offset:20480
    v_mfma_f32_16x16x32_bf16 v[112:115], v[64:67], v[28:31], v[112:115]
    ds_read_b64_tr_b16 v[46:47], v11 offset:20736
    v_mfma_f32_16x16x32_bf16 v[128:131], v[168:171], v[144:147], v[128:131]
    ds_read_b64_tr_b16 v[48:49], v10 offset:24576
    v_mfma_f32_16x16x32_bf16 v[92:95], v[68:71], v[24:27], v[92:95]
    ds_read_b64_tr_b16 v[50:51], v10 offset:24832
    v_mfma_f32_16x16x32_bf16 v[116:119], v[68:71], v[28:31], v[116:119]
    ds_read_b64_tr_b16 v[52:53], v11 offset:24576
    v_mfma_f32_16x16x32_bf16 v[132:135], v[168:171], v[148:151], v[132:135]
    ds_read_b64_tr_b16 v[54:55], v11 offset:24832
    v_mfma_f32_16x16x32_bf16 v[96:99], v[72:75], v[24:27], v[96:99]
    ds_read_b64_tr_b16 v[136:137], v14 offset:16384
    v_mfma_f32_16x16x32_bf16 v[120:123], v[72:75], v[28:31], v[120:123]
    ds_read_b64_tr_b16 v[138:139], v14 offset:16640
    v_mfma_f32_16x16x32_bf16 v[100:103], v[76:79], v[24:27], v[100:103]
    ds_read_b64_tr_b16 v[140:141], v15 offset:16384
    ds_read_b64_tr_b16 v[142:143], v15 offset:16640
    v_mfma_f32_16x16x32_bf16 v[124:127], v[76:79], v[28:31], v[124:127]
    s_waitcnt lgkmcnt(0)
    ds_read_b128 v[24:27], v13 offset:0
    v_mfma_f32_16x16x32_bf16 v[80:83], v[32:35], v[16:19], v[80:83]
    ds_read_b128 v[28:31], v13 offset:2048
    v_mfma_f32_16x16x32_bf16 v[104:107], v[32:35], v[20:23], v[104:107]
    ds_read_b64_tr_b16 v[56:57], v10 offset:18432
    v_mfma_f32_16x16x32_bf16 v[152:155], v[168:171], v[16:19], v[152:155]
    ds_read_b64_tr_b16 v[58:59], v10 offset:18688
    v_mfma_f32_16x16x32_bf16 v[156:159], v[16:19], v[16:19], v[156:159]
    ds_read_b64_tr_b16 v[60:61], v11 offset:18432
    v_mfma_f32_16x16x32_bf16 v[84:87], v[36:39], v[16:19], v[84:87]
    ds_read_b64_tr_b16 v[62:63], v11 offset:18688
    v_mfma_f32_16x16x32_bf16 v[108:111], v[36:39], v[20:23], v[108:111]
    ds_read_b64_tr_b16 v[64:65], v10 offset:22528
    v_mfma_f32_16x16x32_bf16 v[160:163], v[168:171], v[20:23], v[160:163]
    ds_read_b64_tr_b16 v[66:67], v10 offset:22784
    v_mfma_f32_16x16x32_bf16 v[164:167], v[20:23], v[20:23], v[164:167]
    s_waitcnt lgkmcnt(6)
    v_mfma_f32_16x16x32_bf16 v[88:91], v[40:43], v[16:19], v[88:91]
    ds_read_b64_tr_b16 v[68:69], v11 offset:22528
    v_mfma_f32_16x16x32_bf16 v[112:115], v[40:43], v[20:23], v[112:115]
    ds_read_b64_tr_b16 v[70:71], v11 offset:22784
    v_mfma_f32_16x16x32_bf16 v[128:131], v[168:171], v[136:139], v[128:131]
    ds_read_b64_tr_b16 v[72:73], v10 offset:26624
    v_mfma_f32_16x16x32_bf16 v[92:95], v[44:47], v[16:19], v[92:95]
    ds_read_b64_tr_b16 v[74:75], v10 offset:26880
    v_mfma_f32_16x16x32_bf16 v[116:119], v[44:47], v[20:23], v[116:119]
    ds_read_b64_tr_b16 v[76:77], v11 offset:26624
    v_mfma_f32_16x16x32_bf16 v[132:135], v[168:171], v[140:143], v[132:135]
    ds_read_b64_tr_b16 v[78:79], v11 offset:26880
    v_mfma_f32_16x16x32_bf16 v[96:99], v[48:51], v[16:19], v[96:99]
    ds_read_b64_tr_b16 v[144:145], v14 offset:18432
    v_mfma_f32_16x16x32_bf16 v[120:123], v[48:51], v[20:23], v[120:123]
    ds_read_b64_tr_b16 v[146:147], v14 offset:18688
    v_mfma_f32_16x16x32_bf16 v[100:103], v[52:55], v[16:19], v[100:103]
    ds_read_b64_tr_b16 v[148:149], v15 offset:18432
    ds_read_b64_tr_b16 v[150:151], v15 offset:18688
    v_mfma_f32_16x16x32_bf16 v[124:127], v[52:55], v[20:23], v[124:127]
    s_waitcnt lgkmcnt(0)
    s_barrier
    v_add_u32 v10, 28672, v10
    v_add_u32 v11, 28672, v11
    v_add_u32 v12, 28672, v12
    v_add_u32 v13, 28672, v13
    v_add_u32 v14, 28672, v14
    v_add_u32 v15, 28672, v15
    ds_read_b128 v[16:19], v12 offset:0
    v_mfma_f32_16x16x32_bf16 v[80:83], v[56:59], v[24:27], v[80:83]
    ds_read_b128 v[20:23], v12 offset:2048
    v_mfma_f32_16x16x32_bf16 v[104:107], v[56:59], v[28:31], v[104:107]
    ds_read_b64_tr_b16 v[32:33], v10 offset:16384
    v_mfma_f32_16x16x32_bf16 v[152:155], v[168:171], v[24:27], v[152:155]
    ds_read_b64_tr_b16 v[34:35], v10 offset:16640
    v_mfma_f32_16x16x32_bf16 v[156:159], v[24:27], v[24:27], v[156:159]
    ds_read_b64_tr_b16 v[36:37], v11 offset:16384
    v_mfma_f32_16x16x32_bf16 v[84:87], v[60:63], v[24:27], v[84:87]
    ds_read_b64_tr_b16 v[38:39], v11 offset:16640
    v_mfma_f32_16x16x32_bf16 v[108:111], v[60:63], v[28:31], v[108:111]
    ds_read_b64_tr_b16 v[40:41], v10 offset:20480
    v_mfma_f32_16x16x32_bf16 v[160:163], v[168:171], v[28:31], v[160:163]
    ds_read_b64_tr_b16 v[42:43], v10 offset:20736
    v_mfma_f32_16x16x32_bf16 v[164:167], v[28:31], v[28:31], v[164:167]
    s_waitcnt lgkmcnt(6)
    v_mfma_f32_16x16x32_bf16 v[88:91], v[64:67], v[24:27], v[88:91]
    ds_read_b64_tr_b16 v[44:45], v11 offset:20480
    v_mfma_f32_16x16x32_bf16 v[112:115], v[64:67], v[28:31], v[112:115]
    ds_read_b64_tr_b16 v[46:47], v11 offset:20736
    v_mfma_f32_16x16x32_bf16 v[128:131], v[168:171], v[144:147], v[128:131]
    ds_read_b64_tr_b16 v[48:49], v10 offset:24576
    v_mfma_f32_16x16x32_bf16 v[92:95], v[68:71], v[24:27], v[92:95]
    ds_read_b64_tr_b16 v[50:51], v10 offset:24832
    v_mfma_f32_16x16x32_bf16 v[116:119], v[68:71], v[28:31], v[116:119]
    ds_read_b64_tr_b16 v[52:53], v11 offset:24576
    v_mfma_f32_16x16x32_bf16 v[132:135], v[168:171], v[148:151], v[132:135]
    ds_read_b64_tr_b16 v[54:55], v11 offset:24832
    v_mfma_f32_16x16x32_bf16 v[96:99], v[72:75], v[24:27], v[96:99]
    ds_read_b64_tr_b16 v[136:137], v14 offset:16384
    v_mfma_f32_16x16x32_bf16 v[120:123], v[72:75], v[28:31], v[120:123]
    ds_read_b64_tr_b16 v[138:139], v14 offset:16640
    v_mfma_f32_16x16x32_bf16 v[100:103], v[76:79], v[24:27], v[100:103]
    ds_read_b64_tr_b16 v[140:141], v15 offset:16384
    ds_read_b64_tr_b16 v[142:143], v15 offset:16640
    v_mfma_f32_16x16x32_bf16 v[124:127], v[76:79], v[28:31], v[124:127]
    s_waitcnt lgkmcnt(0)
    ds_read_b128 v[24:27], v13 offset:0
    v_mfma_f32_16x16x32_bf16 v[80:83], v[32:35], v[16:19], v[80:83]
    ds_read_b128 v[28:31], v13 offset:2048
    v_mfma_f32_16x16x32_bf16 v[104:107], v[32:35], v[20:23], v[104:107]
    ds_read_b64_tr_b16 v[56:57], v10 offset:18432
    v_mfma_f32_16x16x32_bf16 v[152:155], v[168:171], v[16:19], v[152:155]
    ds_read_b64_tr_b16 v[58:59], v10 offset:18688
    v_mfma_f32_16x16x32_bf16 v[156:159], v[16:19], v[16:19], v[156:159]
    ds_read_b64_tr_b16 v[60:61], v11 offset:18432
    v_mfma_f32_16x16x32_bf16 v[84:87], v[36:39], v[16:19], v[84:87]
    ds_read_b64_tr_b16 v[62:63], v11 offset:18688
    v_mfma_f32_16x16x32_bf16 v[108:111], v[36:39], v[20:23], v[108:111]
    ds_read_b64_tr_b16 v[64:65], v10 offset:22528
    v_mfma_f32_16x16x32_bf16 v[160:163], v[168:171], v[20:23], v[160:163]
    ds_read_b64_tr_b16 v[66:67], v10 offset:22784
    v_mfma_f32_16x16x32_bf16 v[164:167], v[20:23], v[20:23], v[164:167]
    s_waitcnt lgkmcnt(6)
    v_mfma_f32_16x16x32_bf16 v[88:91], v[40:43], v[16:19], v[88:91]
    ds_read_b64_tr_b16 v[68:69], v11 offset:22528
    v_mfma_f32_16x16x32_bf16 v[112:115], v[40:43], v[20:23], v[112:115]
    ds_read_b64_tr_b16 v[70:71], v11 offset:22784
    v_mfma_f32_16x16x32_bf16 v[128:131], v[168:171], v[136:139], v[128:131]
    ds_read_b64_tr_b16 v[72:73], v10 offset:26624
    v_mfma_f32_16x16x32_bf16 v[92:95], v[44:47], v[16:19], v[92:95]
    ds_read_b64_tr_b16 v[74:75], v10 offset:26880
    v_mfma_f32_16x16x32_bf16 v[116:119], v[44:47], v[20:23], v[116:119]
    ds_read_b64_tr_b16 v[76:77], v11 offset:26624
    v_mfma_f32_16x16x32_bf16 v[132:135], v[168:171], v[140:143], v[132:135]
    ds_read_b64_tr_b16 v[78:79], v11 offset:26880
    v_mfma_f32_16x16x32_bf16 v[96:99], v[48:51], v[16:19], v[96:99]
    ds_read_b64_tr_b16 v[144:145], v14 offset:18432
    v_mfma_f32_16x16x32_bf16 v[120:123], v[48:51], v[20:23], v[120:123]
    ds_read_b64_tr_b16 v[146:147], v14 offset:18688
    v_mfma_f32_16x16x32_bf16 v[100:103], v[52:55], v[16:19], v[100:103]
    ds_read_b64_tr_b16 v[148:149], v15 offset:18432
    ds_read_b64_tr_b16 v[150:151], v15 offset:18688
    v_mfma_f32_16x16x32_bf16 v[124:127], v[52:55], v[20:23], v[124:127]
    s_waitcnt lgkmcnt(0)
    s_barrier
    v_add_u32 v10, 28672, v10
    v_add_u32 v11, 28672, v11
    v_add_u32 v12, 28672, v12
    v_add_u32 v13, 28672, v13
    v_add_u32 v14, 28672, v14
    v_add_u32 v15, 28672, v15
    ds_read_b128 v[16:19], v12 offset:0
    v_mfma_f32_16x16x32_bf16 v[80:83], v[56:59], v[24:27], v[80:83]
    ds_read_b128 v[20:23], v12 offset:2048
    v_mfma_f32_16x16x32_bf16 v[104:107], v[56:59], v[28:31], v[104:107]
    ds_read_b64_tr_b16 v[32:33], v10 offset:16384
    v_mfma_f32_16x16x32_bf16 v[152:155], v[168:171], v[24:27], v[152:155]
    ds_read_b64_tr_b16 v[34:35], v10 offset:16640
    v_mfma_f32_16x16x32_bf16 v[156:159], v[24:27], v[24:27], v[156:159]
    ds_read_b64_tr_b16 v[36:37], v11 offset:16384
    v_mfma_f32_16x16x32_bf16 v[84:87], v[60:63], v[24:27], v[84:87]
    ds_read_b64_tr_b16 v[38:39], v11 offset:16640
    v_mfma_f32_16x16x32_bf16 v[108:111], v[60:63], v[28:31], v[108:111]
    ds_read_b64_tr_b16 v[40:41], v10 offset:20480
    v_mfma_f32_16x16x32_bf16 v[160:163], v[168:171], v[28:31], v[160:163]
    ds_read_b64_tr_b16 v[42:43], v10 offset:20736
    v_mfma_f32_16x16x32_bf16 v[164:167], v[28:31], v[28:31], v[164:167]
    s_waitcnt lgkmcnt(6)
    v_mfma_f32_16x16x32_bf16 v[88:91], v[64:67], v[24:27], v[88:91]
    ds_read_b64_tr_b16 v[44:45], v11 offset:20480
    v_mfma_f32_16x16x32_bf16 v[112:115], v[64:67], v[28:31], v[112:115]
    ds_read_b64_tr_b16 v[46:47], v11 offset:20736
    v_mfma_f32_16x16x32_bf16 v[128:131], v[168:171], v[144:147], v[128:131]
    ds_read_b64_tr_b16 v[48:49], v10 offset:24576
    v_mfma_f32_16x16x32_bf16 v[92:95], v[68:71], v[24:27], v[92:95]
    ds_read_b64_tr_b16 v[50:51], v10 offset:24832
    v_mfma_f32_16x16x32_bf16 v[116:119], v[68:71], v[28:31], v[116:119]
    ds_read_b64_tr_b16 v[52:53], v11 offset:24576
    v_mfma_f32_16x16x32_bf16 v[132:135], v[168:171], v[148:151], v[132:135]
    ds_read_b64_tr_b16 v[54:55], v11 offset:24832
    v_mfma_f32_16x16x32_bf16 v[96:99], v[72:75], v[24:27], v[96:99]
    ds_read_b64_tr_b16 v[136:137], v14 offset:16384
    v_mfma_f32_16x16x32_bf16 v[120:123], v[72:75], v[28:31], v[120:123]
    ds_read_b64_tr_b16 v[138:139], v14 offset:16640
    v_mfma_f32_16x16x32_bf16 v[100:103], v[76:79], v[24:27], v[100:103]
    ds_read_b64_tr_b16 v[140:141], v15 offset:16384
    ds_read_b64_tr_b16 v[142:143], v15 offset:16640
    v_mfma_f32_16x16x32_bf16 v[124:127], v[76:79], v[28:31], v[124:127]
    s_waitcnt lgkmcnt(0)
    ds_read_b128 v[24:27], v13 offset:0
    v_mfma_f32_16x16x32_bf16 v[80:83], v[32:35], v[16:19], v[80:83]
    ds_read_b128 v[28:31], v13 offset:2048
    v_mfma_f32_16x16x32_bf16 v[104:107], v[32:35], v[20:23], v[104:107]
    ds_read_b64_tr_b16 v[56:57], v10 offset:18432
    v_mfma_f32_16x16x32_bf16 v[152:155], v[168:171], v[16:19], v[152:155]
    ds_read_b64_tr_b16 v[58:59], v10 offset:18688
    v_mfma_f32_16x16x32_bf16 v[156:159], v[16:19], v[16:19], v[156:159]
    ds_read_b64_tr_b16 v[60:61], v11 offset:18432
    v_mfma_f32_16x16x32_bf16 v[84:87], v[36:39], v[16:19], v[84:87]
    ds_read_b64_tr_b16 v[62:63], v11 offset:18688
    v_mfma_f32_16x16x32_bf16 v[108:111], v[36:39], v[20:23], v[108:111]
    ds_read_b64_tr_b16 v[64:65], v10 offset:22528
    v_mfma_f32_16x16x32_bf16 v[160:163], v[168:171], v[20:23], v[160:163]
    ds_read_b64_tr_b16 v[66:67], v10 offset:22784
    v_mfma_f32_16x16x32_bf16 v[164:167], v[20:23], v[20:23], v[164:167]
    s_waitcnt lgkmcnt(6)
    v_mfma_f32_16x16x32_bf16 v[88:91], v[40:43], v[16:19], v[88:91]
    ds_read_b64_tr_b16 v[68:69], v11 offset:22528
    v_mfma_f32_16x16x32_bf16 v[112:115], v[40:43], v[20:23], v[112:115]
    ds_read_b64_tr_b16 v[70:71], v11 offset:22784
    v_mfma_f32_16x16x32_bf16 v[128:131], v[168:171], v[136:139], v[128:131]
    ds_read_b64_tr_b16 v[72:73], v10 offset:26624
    v_mfma_f32_16x16x32_bf16 v[92:95], v[44:47], v[16:19], v[92:95]
    ds_read_b64_tr_b16 v[74:75], v10 offset:26880
    v_mfma_f32_16x16x32_bf16 v[116:119], v[44:47], v[20:23], v[116:119]
    ds_read_b64_tr_b16 v[76:77], v11 offset:26624
    v_mfma_f32_16x16x32_bf16 v[132:135], v[168:171], v[140:143], v[132:135]
    ds_read_b64_tr_b16 v[78:79], v11 offset:26880
    v_mfma_f32_16x16x32_bf16 v[96:99], v[48:51], v[16:19], v[96:99]
    ds_read_b64_tr_b16 v[144:145], v14 offset:18432
    v_mfma_f32_16x16x32_bf16 v[120:123], v[48:51], v[20:23], v[120:123]
    ds_read_b64_tr_b16 v[146:147], v14 offset:18688
    v_mfma_f32_16x16x32_bf16 v[100:103], v[52:55], v[16:19], v[100:103]
    ds_read_b64_tr_b16 v[148:149], v15 offset:18432
    ds_read_b64_tr_b16 v[150:151], v15 offset:18688
    v_mfma_f32_16x16x32_bf16 v[124:127], v[52:55], v[20:23], v[124:127]
    s_waitcnt lgkmcnt(0)
    s_barrier
    v_add_u32 v10, 28672, v10
    v_add_u32 v11, 28672, v11
    v_add_u32 v12, 28672, v12
    v_add_u32 v13, 28672, v13
    v_add_u32 v14, 28672, v14
    v_add_u32 v15, 28672, v15
    ds_read_b128 v[16:19], v12 offset:0
    v_mfma_f32_16x16x32_bf16 v[80:83], v[56:59], v[24:27], v[80:83]
    ds_read_b128 v[20:23], v12 offset:2048
    v_mfma_f32_16x16x32_bf16 v[104:107], v[56:59], v[28:31], v[104:107]
    ds_read_b64_tr_b16 v[32:33], v10 offset:16384
    v_mfma_f32_16x16x32_bf16 v[152:155], v[168:171], v[24:27], v[152:155]
    ds_read_b64_tr_b16 v[34:35], v10 offset:16640
    v_mfma_f32_16x16x32_bf16 v[156:159], v[24:27], v[24:27], v[156:159]
    ds_read_b64_tr_b16 v[36:37], v11 offset:16384
    v_mfma_f32_16x16x32_bf16 v[84:87], v[60:63], v[24:27], v[84:87]
    ds_read_b64_tr_b16 v[38:39], v11 offset:16640
    v_mfma_f32_16x16x32_bf16 v[108:111], v[60:63], v[28:31], v[108:111]
    ds_read_b64_tr_b16 v[40:41], v10 offset:20480
    v_mfma_f32_16x16x32_bf16 v[160:163], v[168:171], v[28:31], v[160:163]
    ds_read_b64_tr_b16 v[42:43], v10 offset:20736
    v_mfma_f32_16x16x32_bf16 v[164:167], v[28:31], v[28:31], v[164:167]
    s_waitcnt lgkmcnt(6)
    v_mfma_f32_16x16x32_bf16 v[88:91], v[64:67], v[24:27], v[88:91]
    ds_read_b64_tr_b16 v[44:45], v11 offset:20480
    v_mfma_f32_16x16x32_bf16 v[112:115], v[64:67], v[28:31], v[112:115]
    ds_read_b64_tr_b16 v[46:47], v11 offset:20736
    v_mfma_f32_16x16x32_bf16 v[128:131], v[168:171], v[144:147], v[128:131]
    ds_read_b64_tr_b16 v[48:49], v10 offset:24576
    v_mfma_f32_16x16x32_bf16 v[92:95], v[68:71], v[24:27], v[92:95]
    ds_read_b64_tr_b16 v[50:51], v10 offset:24832
    v_mfma_f32_16x16x32_bf16 v[116:119], v[68:71], v[28:31], v[116:119]
    ds_read_b64_tr_b16 v[52:53], v11 offset:24576
    v_mfma_f32_16x16x32_bf16 v[132:135], v[168:171], v[148:151], v[132:135]
    ds_read_b64_tr_b16 v[54:55], v11 offset:24832
    v_mfma_f32_16x16x32_bf16 v[96:99], v[72:75], v[24:27], v[96:99]
    ds_read_b64_tr_b16 v[136:137], v14 offset:16384
    v_mfma_f32_16x16x32_bf16 v[120:123], v[72:75], v[28:31], v[120:123]
    ds_read_b64_tr_b16 v[138:139], v14 offset:16640
    v_mfma_f32_16x16x32_bf16 v[100:103], v[76:79], v[24:27], v[100:103]
    ds_read_b64_tr_b16 v[140:141], v15 offset:16384
    ds_read_b64_tr_b16 v[142:143], v15 offset:16640
    v_mfma_f32_16x16x32_bf16 v[124:127], v[76:79], v[28:31], v[124:127]
    s_waitcnt lgkmcnt(0)
    ds_read_b128 v[24:27], v13 offset:0
    v_mfma_f32_16x16x32_bf16 v[80:83], v[32:35], v[16:19], v[80:83]
    ds_read_b128 v[28:31], v13 offset:2048
    v_mfma_f32_16x16x32_bf16 v[104:107], v[32:35], v[20:23], v[104:107]
    ds_read_b64_tr_b16 v[56:57], v10 offset:18432
    v_mfma_f32_16x16x32_bf16 v[152:155], v[168:171], v[16:19], v[152:155]
    ds_read_b64_tr_b16 v[58:59], v10 offset:18688
    v_mfma_f32_16x16x32_bf16 v[156:159], v[16:19], v[16:19], v[156:159]
    ds_read_b64_tr_b16 v[60:61], v11 offset:18432
    v_mfma_f32_16x16x32_bf16 v[84:87], v[36:39], v[16:19], v[84:87]
    ds_read_b64_tr_b16 v[62:63], v11 offset:18688
    v_mfma_f32_16x16x32_bf16 v[108:111], v[36:39], v[20:23], v[108:111]
    ds_read_b64_tr_b16 v[64:65], v10 offset:22528
    v_mfma_f32_16x16x32_bf16 v[160:163], v[168:171], v[20:23], v[160:163]
    ds_read_b64_tr_b16 v[66:67], v10 offset:22784
    v_mfma_f32_16x16x32_bf16 v[164:167], v[20:23], v[20:23], v[164:167]
    s_waitcnt lgkmcnt(6)
    v_mfma_f32_16x16x32_bf16 v[88:91], v[40:43], v[16:19], v[88:91]
    ds_read_b64_tr_b16 v[68:69], v11 offset:22528
    v_mfma_f32_16x16x32_bf16 v[112:115], v[40:43], v[20:23], v[112:115]
    ds_read_b64_tr_b16 v[70:71], v11 offset:22784
    v_mfma_f32_16x16x32_bf16 v[128:131], v[168:171], v[136:139], v[128:131]
    ds_read_b64_tr_b16 v[72:73], v10 offset:26624
    v_mfma_f32_16x16x32_bf16 v[92:95], v[44:47], v[16:19], v[92:95]
    ds_read_b64_tr_b16 v[74:75], v10 offset:26880
    v_mfma_f32_16x16x32_bf16 v[116:119], v[44:47], v[20:23], v[116:119]
    ds_read_b64_tr_b16 v[76:77], v11 offset:26624
    v_mfma_f32_16x16x32_bf16 v[132:135], v[168:171], v[140:143], v[132:135]
    ds_read_b64_tr_b16 v[78:79], v11 offset:26880
    v_mfma_f32_16x16x32_bf16 v[96:99], v[48:51], v[16:19], v[96:99]
    ds_read_b64_tr_b16 v[144:145], v14 offset:18432
    v_mfma_f32_16x16x32_bf16 v[120:123], v[48:51], v[20:23], v[120:123]
    ds_read_b64_tr_b16 v[146:147], v14 offset:18688
    v_mfma_f32_16x16x32_bf16 v[100:103], v[52:55], v[16:19], v[100:103]
    ds_read_b64_tr_b16 v[148:149], v15 offset:18432
    ds_read_b64_tr_b16 v[150:151], v15 offset:18688
    v_mfma_f32_16x16x32_bf16 v[124:127], v[52:55], v[20:23], v[124:127]
    s_waitcnt lgkmcnt(0)
    s_barrier
    v_add_u32 v10, 4294852608, v10
    v_add_u32 v11, 4294852608, v11
    v_add_u32 v12, 4294852608, v12
    v_add_u32 v13, 4294852608, v13
    v_add_u32 v14, 4294852608, v14
    v_add_u32 v15, 4294852608, v15
    ds_read_b128 v[16:19], v12 offset:0
    v_mfma_f32_16x16x32_bf16 v[80:83], v[56:59], v[24:27], v[80:83]
    ds_read_b128 v[20:23], v12 offset:2048
    v_mfma_f32_16x16x32_bf16 v[104:107], v[56:59], v[28:31], v[104:107]
    ds_read_b64_tr_b16 v[32:33], v10 offset:16384
    v_mfma_f32_16x16x32_bf16 v[152:155], v[168:171], v[24:27], v[152:155]
    ds_read_b64_tr_b16 v[34:35], v10 offset:16640
    v_mfma_f32_16x16x32_bf16 v[156:159], v[24:27], v[24:27], v[156:159]
    ds_read_b64_tr_b16 v[36:37], v11 offset:16384
    v_mfma_f32_16x16x32_bf16 v[84:87], v[60:63], v[24:27], v[84:87]
    ds_read_b64_tr_b16 v[38:39], v11 offset:16640
    v_mfma_f32_16x16x32_bf16 v[108:111], v[60:63], v[28:31], v[108:111]
    ds_read_b64_tr_b16 v[40:41], v10 offset:20480
    v_mfma_f32_16x16x32_bf16 v[160:163], v[168:171], v[28:31], v[160:163]
    ds_read_b64_tr_b16 v[42:43], v10 offset:20736
    v_mfma_f32_16x16x32_bf16 v[164:167], v[28:31], v[28:31], v[164:167]
    s_waitcnt lgkmcnt(6)
    v_mfma_f32_16x16x32_bf16 v[88:91], v[64:67], v[24:27], v[88:91]
    ds_read_b64_tr_b16 v[44:45], v11 offset:20480
    v_mfma_f32_16x16x32_bf16 v[112:115], v[64:67], v[28:31], v[112:115]
    ds_read_b64_tr_b16 v[46:47], v11 offset:20736
    v_mfma_f32_16x16x32_bf16 v[128:131], v[168:171], v[144:147], v[128:131]
    ds_read_b64_tr_b16 v[48:49], v10 offset:24576
    v_mfma_f32_16x16x32_bf16 v[92:95], v[68:71], v[24:27], v[92:95]
    ds_read_b64_tr_b16 v[50:51], v10 offset:24832
    v_mfma_f32_16x16x32_bf16 v[116:119], v[68:71], v[28:31], v[116:119]
    ds_read_b64_tr_b16 v[52:53], v11 offset:24576
    v_mfma_f32_16x16x32_bf16 v[132:135], v[168:171], v[148:151], v[132:135]
    ds_read_b64_tr_b16 v[54:55], v11 offset:24832
    v_mfma_f32_16x16x32_bf16 v[96:99], v[72:75], v[24:27], v[96:99]
    ds_read_b64_tr_b16 v[136:137], v14 offset:16384
    v_mfma_f32_16x16x32_bf16 v[120:123], v[72:75], v[28:31], v[120:123]
    ds_read_b64_tr_b16 v[138:139], v14 offset:16640
    v_mfma_f32_16x16x32_bf16 v[100:103], v[76:79], v[24:27], v[100:103]
    ds_read_b64_tr_b16 v[140:141], v15 offset:16384
    ds_read_b64_tr_b16 v[142:143], v15 offset:16640
    v_mfma_f32_16x16x32_bf16 v[124:127], v[76:79], v[28:31], v[124:127]
    s_waitcnt lgkmcnt(0)
    ds_read_b128 v[24:27], v13 offset:0
    v_mfma_f32_16x16x32_bf16 v[80:83], v[32:35], v[16:19], v[80:83]
    ds_read_b128 v[28:31], v13 offset:2048
    v_mfma_f32_16x16x32_bf16 v[104:107], v[32:35], v[20:23], v[104:107]
    ds_read_b64_tr_b16 v[56:57], v10 offset:18432
    v_mfma_f32_16x16x32_bf16 v[152:155], v[168:171], v[16:19], v[152:155]
    ds_read_b64_tr_b16 v[58:59], v10 offset:18688
    v_mfma_f32_16x16x32_bf16 v[156:159], v[16:19], v[16:19], v[156:159]
    ds_read_b64_tr_b16 v[60:61], v11 offset:18432
    v_mfma_f32_16x16x32_bf16 v[84:87], v[36:39], v[16:19], v[84:87]
    ds_read_b64_tr_b16 v[62:63], v11 offset:18688
    v_mfma_f32_16x16x32_bf16 v[108:111], v[36:39], v[20:23], v[108:111]
    ds_read_b64_tr_b16 v[64:65], v10 offset:22528
    v_mfma_f32_16x16x32_bf16 v[160:163], v[168:171], v[20:23], v[160:163]
    ds_read_b64_tr_b16 v[66:67], v10 offset:22784
    v_mfma_f32_16x16x32_bf16 v[164:167], v[20:23], v[20:23], v[164:167]
    s_waitcnt lgkmcnt(6)
    v_mfma_f32_16x16x32_bf16 v[88:91], v[40:43], v[16:19], v[88:91]
    ds_read_b64_tr_b16 v[68:69], v11 offset:22528
    v_mfma_f32_16x16x32_bf16 v[112:115], v[40:43], v[20:23], v[112:115]
    ds_read_b64_tr_b16 v[70:71], v11 offset:22784
    v_mfma_f32_16x16x32_bf16 v[128:131], v[168:171], v[136:139], v[128:131]
    ds_read_b64_tr_b16 v[72:73], v10 offset:26624
    v_mfma_f32_16x16x32_bf16 v[92:95], v[44:47], v[16:19], v[92:95]
    ds_read_b64_tr_b16 v[74:75], v10 offset:26880
    v_mfma_f32_16x16x32_bf16 v[116:119], v[44:47], v[20:23], v[116:119]
    ds_read_b64_tr_b16 v[76:77], v11 offset:26624
    v_mfma_f32_16x16x32_bf16 v[132:135], v[168:171], v[140:143], v[132:135]
    ds_read_b64_tr_b16 v[78:79], v11 offset:26880
    v_mfma_f32_16x16x32_bf16 v[96:99], v[48:51], v[16:19], v[96:99]
    ds_read_b64_tr_b16 v[144:145], v14 offset:18432
    v_mfma_f32_16x16x32_bf16 v[120:123], v[48:51], v[20:23], v[120:123]
    ds_read_b64_tr_b16 v[146:147], v14 offset:18688
    v_mfma_f32_16x16x32_bf16 v[100:103], v[52:55], v[16:19], v[100:103]
    ds_read_b64_tr_b16 v[148:149], v15 offset:18432
    ds_read_b64_tr_b16 v[150:151], v15 offset:18688
    v_mfma_f32_16x16x32_bf16 v[124:127], v[52:55], v[20:23], v[124:127]
    s_waitcnt lgkmcnt(0)
    s_barrier
    v_add_u32 v10, 28672, v10
    v_add_u32 v11, 28672, v11
    v_add_u32 v12, 28672, v12
    v_add_u32 v13, 28672, v13
    v_add_u32 v14, 28672, v14
    v_add_u32 v15, 28672, v15
    ds_read_b128 v[16:19], v12 offset:0
    v_mfma_f32_16x16x32_bf16 v[80:83], v[56:59], v[24:27], v[80:83]
    ds_read_b128 v[20:23], v12 offset:2048
    v_mfma_f32_16x16x32_bf16 v[104:107], v[56:59], v[28:31], v[104:107]
    ds_read_b64_tr_b16 v[32:33], v10 offset:16384
    v_mfma_f32_16x16x32_bf16 v[152:155], v[168:171], v[24:27], v[152:155]
    ds_read_b64_tr_b16 v[34:35], v10 offset:16640
    v_mfma_f32_16x16x32_bf16 v[156:159], v[24:27], v[24:27], v[156:159]
    ds_read_b64_tr_b16 v[36:37], v11 offset:16384
    v_mfma_f32_16x16x32_bf16 v[84:87], v[60:63], v[24:27], v[84:87]
    ds_read_b64_tr_b16 v[38:39], v11 offset:16640
    v_mfma_f32_16x16x32_bf16 v[108:111], v[60:63], v[28:31], v[108:111]
    ds_read_b64_tr_b16 v[40:41], v10 offset:20480
    v_mfma_f32_16x16x32_bf16 v[160:163], v[168:171], v[28:31], v[160:163]
    ds_read_b64_tr_b16 v[42:43], v10 offset:20736
    v_mfma_f32_16x16x32_bf16 v[164:167], v[28:31], v[28:31], v[164:167]
    s_waitcnt lgkmcnt(6)
    v_mfma_f32_16x16x32_bf16 v[88:91], v[64:67], v[24:27], v[88:91]
    ds_read_b64_tr_b16 v[44:45], v11 offset:20480
    v_mfma_f32_16x16x32_bf16 v[112:115], v[64:67], v[28:31], v[112:115]
    ds_read_b64_tr_b16 v[46:47], v11 offset:20736
    v_mfma_f32_16x16x32_bf16 v[128:131], v[168:171], v[144:147], v[128:131]
    ds_read_b64_tr_b16 v[48:49], v10 offset:24576
    v_mfma_f32_16x16x32_bf16 v[92:95], v[68:71], v[24:27], v[92:95]
    ds_read_b64_tr_b16 v[50:51], v10 offset:24832
    v_mfma_f32_16x16x32_bf16 v[116:119], v[68:71], v[28:31], v[116:119]
    ds_read_b64_tr_b16 v[52:53], v11 offset:24576
    v_mfma_f32_16x16x32_bf16 v[132:135], v[168:171], v[148:151], v[132:135]
    ds_read_b64_tr_b16 v[54:55], v11 offset:24832
    v_mfma_f32_16x16x32_bf16 v[96:99], v[72:75], v[24:27], v[96:99]
    ds_read_b64_tr_b16 v[136:137], v14 offset:16384
    v_mfma_f32_16x16x32_bf16 v[120:123], v[72:75], v[28:31], v[120:123]
    ds_read_b64_tr_b16 v[138:139], v14 offset:16640
    v_mfma_f32_16x16x32_bf16 v[100:103], v[76:79], v[24:27], v[100:103]
    ds_read_b64_tr_b16 v[140:141], v15 offset:16384
    ds_read_b64_tr_b16 v[142:143], v15 offset:16640
    v_mfma_f32_16x16x32_bf16 v[124:127], v[76:79], v[28:31], v[124:127]
    s_waitcnt lgkmcnt(0)
    ds_read_b128 v[24:27], v13 offset:0
    v_mfma_f32_16x16x32_bf16 v[80:83], v[32:35], v[16:19], v[80:83]
    ds_read_b128 v[28:31], v13 offset:2048
    v_mfma_f32_16x16x32_bf16 v[104:107], v[32:35], v[20:23], v[104:107]
    ds_read_b64_tr_b16 v[56:57], v10 offset:18432
    v_mfma_f32_16x16x32_bf16 v[152:155], v[168:171], v[16:19], v[152:155]
    ds_read_b64_tr_b16 v[58:59], v10 offset:18688
    v_mfma_f32_16x16x32_bf16 v[156:159], v[16:19], v[16:19], v[156:159]
    ds_read_b64_tr_b16 v[60:61], v11 offset:18432
    v_mfma_f32_16x16x32_bf16 v[84:87], v[36:39], v[16:19], v[84:87]
    ds_read_b64_tr_b16 v[62:63], v11 offset:18688
    v_mfma_f32_16x16x32_bf16 v[108:111], v[36:39], v[20:23], v[108:111]
    ds_read_b64_tr_b16 v[64:65], v10 offset:22528
    v_mfma_f32_16x16x32_bf16 v[160:163], v[168:171], v[20:23], v[160:163]
    ds_read_b64_tr_b16 v[66:67], v10 offset:22784
    v_mfma_f32_16x16x32_bf16 v[164:167], v[20:23], v[20:23], v[164:167]
    s_waitcnt lgkmcnt(6)
    v_mfma_f32_16x16x32_bf16 v[88:91], v[40:43], v[16:19], v[88:91]
    ds_read_b64_tr_b16 v[68:69], v11 offset:22528
    v_mfma_f32_16x16x32_bf16 v[112:115], v[40:43], v[20:23], v[112:115]
    ds_read_b64_tr_b16 v[70:71], v11 offset:22784
    v_mfma_f32_16x16x32_bf16 v[128:131], v[168:171], v[136:139], v[128:131]
    ds_read_b64_tr_b16 v[72:73], v10 offset:26624
    v_mfma_f32_16x16x32_bf16 v[92:95], v[44:47], v[16:19], v[92:95]
    ds_read_b64_tr_b16 v[74:75], v10 offset:26880
    v_mfma_f32_16x16x32_bf16 v[116:119], v[44:47], v[20:23], v[116:119]
    ds_read_b64_tr_b16 v[76:77], v11 offset:26624
    v_mfma_f32_16x16x32_bf16 v[132:135], v[168:171], v[140:143], v[132:135]
    ds_read_b64_tr_b16 v[78:79], v11 offset:26880
    v_mfma_f32_16x16x32_bf16 v[96:99], v[48:51], v[16:19], v[96:99]
    ds_read_b64_tr_b16 v[144:145], v14 offset:18432
    v_mfma_f32_16x16x32_bf16 v[120:123], v[48:51], v[20:23], v[120:123]
    ds_read_b64_tr_b16 v[146:147], v14 offset:18688
    v_mfma_f32_16x16x32_bf16 v[100:103], v[52:55], v[16:19], v[100:103]
    ds_read_b64_tr_b16 v[148:149], v15 offset:18432
    ds_read_b64_tr_b16 v[150:151], v15 offset:18688
    v_mfma_f32_16x16x32_bf16 v[124:127], v[52:55], v[20:23], v[124:127]
    s_waitcnt lgkmcnt(0)
    s_barrier
    v_add_u32 v10, 28672, v10
    v_add_u32 v11, 28672, v11
    v_add_u32 v12, 28672, v12
    v_add_u32 v13, 28672, v13
    v_add_u32 v14, 28672, v14
    v_add_u32 v15, 28672, v15
    ds_read_b128 v[16:19], v12 offset:0
    v_mfma_f32_16x16x32_bf16 v[80:83], v[56:59], v[24:27], v[80:83]
    ds_read_b128 v[20:23], v12 offset:2048
    v_mfma_f32_16x16x32_bf16 v[104:107], v[56:59], v[28:31], v[104:107]
    ds_read_b64_tr_b16 v[32:33], v10 offset:16384
    v_mfma_f32_16x16x32_bf16 v[152:155], v[168:171], v[24:27], v[152:155]
    ds_read_b64_tr_b16 v[34:35], v10 offset:16640
    v_mfma_f32_16x16x32_bf16 v[156:159], v[24:27], v[24:27], v[156:159]
    ds_read_b64_tr_b16 v[36:37], v11 offset:16384
    v_mfma_f32_16x16x32_bf16 v[84:87], v[60:63], v[24:27], v[84:87]
    ds_read_b64_tr_b16 v[38:39], v11 offset:16640
    v_mfma_f32_16x16x32_bf16 v[108:111], v[60:63], v[28:31], v[108:111]
    ds_read_b64_tr_b16 v[40:41], v10 offset:20480
    v_mfma_f32_16x16x32_bf16 v[160:163], v[168:171], v[28:31], v[160:163]
    ds_read_b64_tr_b16 v[42:43], v10 offset:20736
    v_mfma_f32_16x16x32_bf16 v[164:167], v[28:31], v[28:31], v[164:167]
    s_waitcnt lgkmcnt(6)
    v_mfma_f32_16x16x32_bf16 v[88:91], v[64:67], v[24:27], v[88:91]
    ds_read_b64_tr_b16 v[44:45], v11 offset:20480
    v_mfma_f32_16x16x32_bf16 v[112:115], v[64:67], v[28:31], v[112:115]
    ds_read_b64_tr_b16 v[46:47], v11 offset:20736
    v_mfma_f32_16x16x32_bf16 v[128:131], v[168:171], v[144:147], v[128:131]
    ds_read_b64_tr_b16 v[48:49], v10 offset:24576
    v_mfma_f32_16x16x32_bf16 v[92:95], v[68:71], v[24:27], v[92:95]
    ds_read_b64_tr_b16 v[50:51], v10 offset:24832
    v_mfma_f32_16x16x32_bf16 v[116:119], v[68:71], v[28:31], v[116:119]
    ds_read_b64_tr_b16 v[52:53], v11 offset:24576
    v_mfma_f32_16x16x32_bf16 v[132:135], v[168:171], v[148:151], v[132:135]
    ds_read_b64_tr_b16 v[54:55], v11 offset:24832
    v_mfma_f32_16x16x32_bf16 v[96:99], v[72:75], v[24:27], v[96:99]
    ds_read_b64_tr_b16 v[136:137], v14 offset:16384
    v_mfma_f32_16x16x32_bf16 v[120:123], v[72:75], v[28:31], v[120:123]
    ds_read_b64_tr_b16 v[138:139], v14 offset:16640
    v_mfma_f32_16x16x32_bf16 v[100:103], v[76:79], v[24:27], v[100:103]
    ds_read_b64_tr_b16 v[140:141], v15 offset:16384
    ds_read_b64_tr_b16 v[142:143], v15 offset:16640
    v_mfma_f32_16x16x32_bf16 v[124:127], v[76:79], v[28:31], v[124:127]
    s_waitcnt lgkmcnt(0)
    ds_read_b128 v[24:27], v13 offset:0
    v_mfma_f32_16x16x32_bf16 v[80:83], v[32:35], v[16:19], v[80:83]
    ds_read_b128 v[28:31], v13 offset:2048
    v_mfma_f32_16x16x32_bf16 v[104:107], v[32:35], v[20:23], v[104:107]
    ds_read_b64_tr_b16 v[56:57], v10 offset:18432
    v_mfma_f32_16x16x32_bf16 v[152:155], v[168:171], v[16:19], v[152:155]
    ds_read_b64_tr_b16 v[58:59], v10 offset:18688
    v_mfma_f32_16x16x32_bf16 v[156:159], v[16:19], v[16:19], v[156:159]
    ds_read_b64_tr_b16 v[60:61], v11 offset:18432
    v_mfma_f32_16x16x32_bf16 v[84:87], v[36:39], v[16:19], v[84:87]
    ds_read_b64_tr_b16 v[62:63], v11 offset:18688
    v_mfma_f32_16x16x32_bf16 v[108:111], v[36:39], v[20:23], v[108:111]
    ds_read_b64_tr_b16 v[64:65], v10 offset:22528
    v_mfma_f32_16x16x32_bf16 v[160:163], v[168:171], v[20:23], v[160:163]
    ds_read_b64_tr_b16 v[66:67], v10 offset:22784
    v_mfma_f32_16x16x32_bf16 v[164:167], v[20:23], v[20:23], v[164:167]
    s_waitcnt lgkmcnt(6)
    v_mfma_f32_16x16x32_bf16 v[88:91], v[40:43], v[16:19], v[88:91]
    ds_read_b64_tr_b16 v[68:69], v11 offset:22528
    v_mfma_f32_16x16x32_bf16 v[112:115], v[40:43], v[20:23], v[112:115]
    ds_read_b64_tr_b16 v[70:71], v11 offset:22784
    v_mfma_f32_16x16x32_bf16 v[128:131], v[168:171], v[136:139], v[128:131]
    ds_read_b64_tr_b16 v[72:73], v10 offset:26624
    v_mfma_f32_16x16x32_bf16 v[92:95], v[44:47], v[16:19], v[92:95]
    ds_read_b64_tr_b16 v[74:75], v10 offset:26880
    v_mfma_f32_16x16x32_bf16 v[116:119], v[44:47], v[20:23], v[116:119]
    ds_read_b64_tr_b16 v[76:77], v11 offset:26624
    v_mfma_f32_16x16x32_bf16 v[132:135], v[168:171], v[140:143], v[132:135]
    ds_read_b64_tr_b16 v[78:79], v11 offset:26880
    v_mfma_f32_16x16x32_bf16 v[96:99], v[48:51], v[16:19], v[96:99]
    ds_read_b64_tr_b16 v[144:145], v14 offset:18432
    v_mfma_f32_16x16x32_bf16 v[120:123], v[48:51], v[20:23], v[120:123]
    ds_read_b64_tr_b16 v[146:147], v14 offset:18688
    v_mfma_f32_16x16x32_bf16 v[100:103], v[52:55], v[16:19], v[100:103]
    ds_read_b64_tr_b16 v[148:149], v15 offset:18432
    ds_read_b64_tr_b16 v[150:151], v15 offset:18688
    v_mfma_f32_16x16x32_bf16 v[124:127], v[52:55], v[20:23], v[124:127]
    s_waitcnt lgkmcnt(0)
    s_barrier
    v_add_u32 v10, 28672, v10
    v_add_u32 v11, 28672, v11
    v_add_u32 v12, 28672, v12
    v_add_u32 v13, 28672, v13
    v_add_u32 v14, 28672, v14
    v_add_u32 v15, 28672, v15
    ds_read_b128 v[16:19], v12 offset:0
    v_mfma_f32_16x16x32_bf16 v[80:83], v[56:59], v[24:27], v[80:83]
    ds_read_b128 v[20:23], v12 offset:2048
    v_mfma_f32_16x16x32_bf16 v[104:107], v[56:59], v[28:31], v[104:107]
    ds_read_b64_tr_b16 v[32:33], v10 offset:16384
    v_mfma_f32_16x16x32_bf16 v[152:155], v[168:171], v[24:27], v[152:155]
    ds_read_b64_tr_b16 v[34:35], v10 offset:16640
    v_mfma_f32_16x16x32_bf16 v[156:159], v[24:27], v[24:27], v[156:159]
    ds_read_b64_tr_b16 v[36:37], v11 offset:16384
    v_mfma_f32_16x16x32_bf16 v[84:87], v[60:63], v[24:27], v[84:87]
    ds_read_b64_tr_b16 v[38:39], v11 offset:16640
    v_mfma_f32_16x16x32_bf16 v[108:111], v[60:63], v[28:31], v[108:111]
    ds_read_b64_tr_b16 v[40:41], v10 offset:20480
    v_mfma_f32_16x16x32_bf16 v[160:163], v[168:171], v[28:31], v[160:163]
    ds_read_b64_tr_b16 v[42:43], v10 offset:20736
    v_mfma_f32_16x16x32_bf16 v[164:167], v[28:31], v[28:31], v[164:167]
    s_waitcnt lgkmcnt(6)
    v_mfma_f32_16x16x32_bf16 v[88:91], v[64:67], v[24:27], v[88:91]
    ds_read_b64_tr_b16 v[44:45], v11 offset:20480
    v_mfma_f32_16x16x32_bf16 v[112:115], v[64:67], v[28:31], v[112:115]
    ds_read_b64_tr_b16 v[46:47], v11 offset:20736
    v_mfma_f32_16x16x32_bf16 v[128:131], v[168:171], v[144:147], v[128:131]
    ds_read_b64_tr_b16 v[48:49], v10 offset:24576
    v_mfma_f32_16x16x32_bf16 v[92:95], v[68:71], v[24:27], v[92:95]
    ds_read_b64_tr_b16 v[50:51], v10 offset:24832
    v_mfma_f32_16x16x32_bf16 v[116:119], v[68:71], v[28:31], v[116:119]
    ds_read_b64_tr_b16 v[52:53], v11 offset:24576
    v_mfma_f32_16x16x32_bf16 v[132:135], v[168:171], v[148:151], v[132:135]
    ds_read_b64_tr_b16 v[54:55], v11 offset:24832
    v_mfma_f32_16x16x32_bf16 v[96:99], v[72:75], v[24:27], v[96:99]
    ds_read_b64_tr_b16 v[136:137], v14 offset:16384
    v_mfma_f32_16x16x32_bf16 v[120:123], v[72:75], v[28:31], v[120:123]
    ds_read_b64_tr_b16 v[138:139], v14 offset:16640
    v_mfma_f32_16x16x32_bf16 v[100:103], v[76:79], v[24:27], v[100:103]
    ds_read_b64_tr_b16 v[140:141], v15 offset:16384
    ds_read_b64_tr_b16 v[142:143], v15 offset:16640
    v_mfma_f32_16x16x32_bf16 v[124:127], v[76:79], v[28:31], v[124:127]
    s_waitcnt lgkmcnt(0)
    s_nop 7
    v_and_b32 v8, 1, v4
    v_lshrrev_b32 v9, 1, v4
    v_lshlrev_b32 v8, 5, v8
    v_lshl_add_u32 v8, v9, 4, v8
    s_mov_b32 s27, 2048
    v_mul_lo_u32 v14, v3, s27
    v_add_u32 v14, v14, v8
    v_lshl_add_u32 v15, v3, 12, v8
    s_mul_i32 s42, s32, 2048
    s_lshl_b32 s28, s33, 1
    s_add_u32 s42, s42, s28
    s_add_u32 s43, s33, -928
    s_lshl_b32 s43, s43, 12
    s_lshl_b32 s28, s32, 1
    s_add_u32 s43, s43, s28
    s_add_u32 s43, s43, 4194304
    v_lshlrev_b32 v8, 2, v3
    v_add_u32 v9, s48, v8
    ds_write_b32 v9, v128 offset:1024
    v_add_u32 v9, s49, v8
    ds_write_b32 v9, v132 offset:1024
    s_waitcnt lgkmcnt(0)
    s_barrier
    v_lshlrev_b32 v8, 4, v4
    v_lshlrev_b32 v9, 2, v3
    ds_read_b128 v[128:131], v8 offset:1024
    ds_read_b128 v[132:135], v8 offset:1088
    ds_read_b128 v[136:139], v8 offset:1152
    ds_read_b128 v[140:143], v8 offset:1216
    ds_read_b128 v[144:147], v8 offset:1280
    ds_read_b128 v[148:151], v8 offset:1344
    v_lshlrev_b32 v8, 2, v4
    v_sub_u32 v8, v3, v8
    v_mov_b32 v33, 0
    v_cmp_eq_u32 vcc, 0, v8
    s_nop 1
    v_cndmask_b32 v33, v33, v156, vcc
    v_cmp_eq_u32 vcc, 1, v8
    s_nop 1
    v_cndmask_b32 v33, v33, v157, vcc
    v_cmp_eq_u32 vcc, 2, v8
    s_nop 1
    v_cndmask_b32 v33, v33, v158, vcc
    v_cmp_eq_u32 vcc, 3, v8
    s_nop 1
    v_cndmask_b32 v33, v33, v159, vcc
    v_mov_b32 v35, v33
    s_nop 1
    v_permlane16_swap_b32 v33, v35
    s_nop 1
    v_add_f32 v33, v33, v35
    v_mov_b32 v35, v33
    s_nop 1
    v_permlane32_swap_b32 v33, v35
    s_nop 1
    v_add_f32 v33, v33, v35
    v_mov_b32 v32, v152
    v_mul_f32 v32, 0x3b000000, v32
    v_mul_f32 v33, 0x3b000000, v33
    v_fma_f32 v34, -v32, v32, v33
    v_max_f32 v34, 0, v34
    v_cvt_pk_bf16_f32 v35, v32, v34
    s_nop 0
    v_lshlrev_b32 v32, 16, v35
    v_and_b32 v34, 0xffff0000, v35
    v_add_f32 v34, 0x3727c5ac, v34
    v_cvt_pk_bf16_f32 v35, v34, v34
    s_nop 0
    v_lshlrev_b32 v34, 16, v35
    v_sqrt_f32 v34, v34
    s_nop 0
    v_cvt_pk_bf16_f32 v35, v34, v34
    s_nop 0
    v_lshlrev_b32 v34, 16, v35
    v_rcp_f32 v152, v34
    s_nop 0
    v_mul_f32 v154, -v32, v152
    v_mov_b32 v33, 0
    v_cmp_eq_u32 vcc, 0, v8
    s_nop 1
    v_cndmask_b32 v33, v33, v164, vcc
    v_cmp_eq_u32 vcc, 1, v8
    s_nop 1
    v_cndmask_b32 v33, v33, v165, vcc
    v_cmp_eq_u32 vcc, 2, v8
    s_nop 1
    v_cndmask_b32 v33, v33, v166, vcc
    v_cmp_eq_u32 vcc, 3, v8
    s_nop 1
    v_cndmask_b32 v33, v33, v167, vcc
    v_mov_b32 v35, v33
    s_nop 1
    v_permlane16_swap_b32 v33, v35
    s_nop 1
    v_add_f32 v33, v33, v35
    v_mov_b32 v35, v33
    s_nop 1
    v_permlane32_swap_b32 v33, v35
    s_nop 1
    v_add_f32 v33, v33, v35
    v_mov_b32 v32, v160
    v_mul_f32 v32, 0x3b000000, v32
    v_mul_f32 v33, 0x3b000000, v33
    v_fma_f32 v34, -v32, v32, v33
    v_max_f32 v34, 0, v34
    v_cvt_pk_bf16_f32 v35, v32, v34
    s_nop 0
    v_lshlrev_b32 v32, 16, v35
    v_and_b32 v34, 0xffff0000, v35
    v_add_f32 v34, 0x3727c5ac, v34
    v_cvt_pk_bf16_f32 v35, v34, v34
    s_nop 0
    v_lshlrev_b32 v34, 16, v35
    v_sqrt_f32 v34, v34
    s_nop 0
    v_cvt_pk_bf16_f32 v35, v34, v34
    s_nop 0
    v_lshlrev_b32 v34, 16, v35
    v_rcp_f32 v160, v34
    s_nop 0
    v_mul_f32 v162, -v32, v160
    s_waitcnt lgkmcnt(0)
    v_pk_mul_f32 v[8:9], v[128:129], v[154:155] op_sel_hi:[1,0]
    v_pk_fma_f32 v[80:81], v[80:81], v[152:153], v[8:9] op_sel_hi:[1,0,1]
    v_pk_mul_f32 v[8:9], v[130:131], v[154:155] op_sel_hi:[1,0]
    v_pk_fma_f32 v[82:83], v[82:83], v[152:153], v[8:9] op_sel_hi:[1,0,1]
    v_pk_mul_f32 v[8:9], v[132:133], v[154:155] op_sel_hi:[1,0]
    v_pk_fma_f32 v[84:85], v[84:85], v[152:153], v[8:9] op_sel_hi:[1,0,1]
    v_pk_mul_f32 v[8:9], v[134:135], v[154:155] op_sel_hi:[1,0]
    v_pk_fma_f32 v[86:87], v[86:87], v[152:153], v[8:9] op_sel_hi:[1,0,1]
    v_pk_mul_f32 v[8:9], v[136:137], v[154:155] op_sel_hi:[1,0]
    v_pk_fma_f32 v[88:89], v[88:89], v[152:153], v[8:9] op_sel_hi:[1,0,1]
    v_pk_mul_f32 v[8:9], v[138:139], v[154:155] op_sel_hi:[1,0]
    v_pk_fma_f32 v[90:91], v[90:91], v[152:153], v[8:9] op_sel_hi:[1,0,1]
    v_pk_mul_f32 v[8:9], v[140:141], v[154:155] op_sel_hi:[1,0]
    v_pk_fma_f32 v[92:93], v[92:93], v[152:153], v[8:9] op_sel_hi:[1,0,1]
    v_pk_mul_f32 v[8:9], v[142:143], v[154:155] op_sel_hi:[1,0]
    v_pk_fma_f32 v[94:95], v[94:95], v[152:153], v[8:9] op_sel_hi:[1,0,1]
    v_pk_mul_f32 v[8:9], v[144:145], v[154:155] op_sel_hi:[1,0]
    v_pk_fma_f32 v[96:97], v[96:97], v[152:153], v[8:9] op_sel_hi:[1,0,1]
    v_pk_mul_f32 v[8:9], v[146:147], v[154:155] op_sel_hi:[1,0]
    v_pk_fma_f32 v[98:99], v[98:99], v[152:153], v[8:9] op_sel_hi:[1,0,1]
    v_pk_mul_f32 v[8:9], v[148:149], v[154:155] op_sel_hi:[1,0]
    v_pk_fma_f32 v[100:101], v[100:101], v[152:153], v[8:9] op_sel_hi:[1,0,1]
    v_pk_mul_f32 v[8:9], v[150:151], v[154:155] op_sel_hi:[1,0]
    v_pk_fma_f32 v[102:103], v[102:103], v[152:153], v[8:9] op_sel_hi:[1,0,1]
    v_pk_mul_f32 v[8:9], v[128:129], v[162:163] op_sel_hi:[1,0]
    v_pk_fma_f32 v[104:105], v[104:105], v[160:161], v[8:9] op_sel_hi:[1,0,1]
    v_pk_mul_f32 v[8:9], v[130:131], v[162:163] op_sel_hi:[1,0]
    v_pk_fma_f32 v[106:107], v[106:107], v[160:161], v[8:9] op_sel_hi:[1,0,1]
    v_pk_mul_f32 v[8:9], v[132:133], v[162:163] op_sel_hi:[1,0]
    v_pk_fma_f32 v[108:109], v[108:109], v[160:161], v[8:9] op_sel_hi:[1,0,1]
    v_pk_mul_f32 v[8:9], v[134:135], v[162:163] op_sel_hi:[1,0]
    v_pk_fma_f32 v[110:111], v[110:111], v[160:161], v[8:9] op_sel_hi:[1,0,1]
    v_pk_mul_f32 v[8:9], v[136:137], v[162:163] op_sel_hi:[1,0]
    v_pk_fma_f32 v[112:113], v[112:113], v[160:161], v[8:9] op_sel_hi:[1,0,1]
    v_pk_mul_f32 v[8:9], v[138:139], v[162:163] op_sel_hi:[1,0]
    v_pk_fma_f32 v[114:115], v[114:115], v[160:161], v[8:9] op_sel_hi:[1,0,1]
    v_pk_mul_f32 v[8:9], v[140:141], v[162:163] op_sel_hi:[1,0]
    v_pk_fma_f32 v[116:117], v[116:117], v[160:161], v[8:9] op_sel_hi:[1,0,1]
    v_pk_mul_f32 v[8:9], v[142:143], v[162:163] op_sel_hi:[1,0]
    v_pk_fma_f32 v[118:119], v[118:119], v[160:161], v[8:9] op_sel_hi:[1,0,1]
    v_pk_mul_f32 v[8:9], v[144:145], v[162:163] op_sel_hi:[1,0]
    v_pk_fma_f32 v[120:121], v[120:121], v[160:161], v[8:9] op_sel_hi:[1,0,1]
    v_pk_mul_f32 v[8:9], v[146:147], v[162:163] op_sel_hi:[1,0]
    v_pk_fma_f32 v[122:123], v[122:123], v[160:161], v[8:9] op_sel_hi:[1,0,1]
    v_pk_mul_f32 v[8:9], v[148:149], v[162:163] op_sel_hi:[1,0]
    v_pk_fma_f32 v[124:125], v[124:125], v[160:161], v[8:9] op_sel_hi:[1,0,1]
    v_pk_mul_f32 v[8:9], v[150:151], v[162:163] op_sel_hi:[1,0]
    v_pk_fma_f32 v[126:127], v[126:127], v[160:161], v[8:9] op_sel_hi:[1,0,1]
    v_cvt_pk_bf16_f32 v32, v80, v81
    v_cvt_pk_bf16_f32 v33, v82, v83
    v_cvt_pk_bf16_f32 v34, v84, v85
    v_cvt_pk_bf16_f32 v35, v86, v87
    s_add_u32 s27, s42, 0
    s_nop 0
    v_permlane16_swap_b32 v32, v34
    v_permlane16_swap_b32 v33, v35
    buffer_store_dwordx4 v[32:35], v14, s[16:19], s27 offen
    v_cvt_pk_bf16_f32 v36, v88, v89
    v_cvt_pk_bf16_f32 v37, v90, v91
    v_cvt_pk_bf16_f32 v38, v92, v93
    v_cvt_pk_bf16_f32 v39, v94, v95
    s_add_u32 s27, s42, 64
    s_nop 0
    v_permlane16_swap_b32 v36, v38
    v_permlane16_swap_b32 v37, v39
    buffer_store_dwordx4 v[36:39], v14, s[16:19], s27 offen
    v_cvt_pk_bf16_f32 v40, v96, v97
    v_cvt_pk_bf16_f32 v41, v98, v99
    v_cvt_pk_bf16_f32 v42, v100, v101
    v_cvt_pk_bf16_f32 v43, v102, v103
    s_add_u32 s27, s42, 128
    s_nop 0
    v_permlane16_swap_b32 v40, v42
    v_permlane16_swap_b32 v41, v43
    buffer_store_dwordx4 v[40:43], v14, s[16:19], s27 offen
    v_cvt_pk_bf16_f32 v44, v104, v105
    v_cvt_pk_bf16_f32 v45, v106, v107
    v_cvt_pk_bf16_f32 v46, v108, v109
    v_cvt_pk_bf16_f32 v47, v110, v111
    s_add_u32 s27, s42, 32768
    s_nop 0
    v_permlane16_swap_b32 v44, v46
    v_permlane16_swap_b32 v45, v47
    buffer_store_dwordx4 v[44:47], v14, s[16:19], s27 offen
    v_cvt_pk_bf16_f32 v48, v112, v113
    v_cvt_pk_bf16_f32 v49, v114, v115
    v_cvt_pk_bf16_f32 v50, v116, v117
    v_cvt_pk_bf16_f32 v51, v118, v119
    s_add_u32 s27, s42, 32832
    s_nop 0
    v_permlane16_swap_b32 v48, v50
    v_permlane16_swap_b32 v49, v51
    buffer_store_dwordx4 v[48:51], v14, s[16:19], s27 offen
    v_cvt_pk_bf16_f32 v52, v120, v121
    v_cvt_pk_bf16_f32 v53, v122, v123
    v_cvt_pk_bf16_f32 v54, v124, v125
    v_cvt_pk_bf16_f32 v55, v126, v127
    s_add_u32 s27, s42, 32896
    s_nop 0
    v_permlane16_swap_b32 v52, v54
    v_permlane16_swap_b32 v53, v55
    buffer_store_dwordx4 v[52:55], v14, s[16:19], s27 offen
    s_endpgm
k1_qkv_kernel_var1:
    s_cmp_gt_u32 s26, 960
    s_cbranch_scc1 k1_qkv_kernel_var2
    s_barrier
    ds_read_b128 v[16:19], v12 offset:0
    ds_read_b128 v[20:23], v12 offset:2048
    ds_read_b64_tr_b16 v[32:33], v10 offset:16384
    ds_read_b64_tr_b16 v[34:35], v10 offset:16640
    ds_read_b64_tr_b16 v[36:37], v11 offset:16384
    ds_read_b64_tr_b16 v[38:39], v11 offset:16640
    ds_read_b64_tr_b16 v[40:41], v10 offset:20480
    ds_read_b64_tr_b16 v[42:43], v10 offset:20736
    s_waitcnt lgkmcnt(6)
    ds_read_b64_tr_b16 v[44:45], v11 offset:20480
    ds_read_b64_tr_b16 v[46:47], v11 offset:20736
    ds_read_b64_tr_b16 v[48:49], v10 offset:24576
    ds_read_b64_tr_b16 v[50:51], v10 offset:24832
    ds_read_b64_tr_b16 v[52:53], v11 offset:24576
    ds_read_b64_tr_b16 v[54:55], v11 offset:24832
    ds_read_b64_tr_b16 v[136:137], v14 offset:16384
    ds_read_b64_tr_b16 v[138:139], v14 offset:16640
    ds_read_b64_tr_b16 v[140:141], v15 offset:16384
    ds_read_b64_tr_b16 v[142:143], v15 offset:16640
    s_waitcnt lgkmcnt(0)
    ds_read_b128 v[24:27], v13 offset:0
    v_mfma_f32_16x16x32_bf16 v[80:83], v[32:35], v[16:19], v[80:83]
    ds_read_b128 v[28:31], v13 offset:2048
    v_mfma_f32_16x16x32_bf16 v[104:107], v[32:35], v[20:23], v[104:107]
    ds_read_b64_tr_b16 v[56:57], v10 offset:18432
    v_mfma_f32_16x16x32_bf16 v[152:155], v[168:171], v[16:19], v[152:155]
    ds_read_b64_tr_b16 v[58:59], v10 offset:18688
    v_mfma_f32_16x16x32_bf16 v[156:159], v[16:19], v[16:19], v[156:159]
    ds_read_b64_tr_b16 v[60:61], v11 offset:18432
    v_mfma_f32_16x16x32_bf16 v[84:87], v[36:39], v[16:19], v[84:87]
    ds_read_b64_tr_b16 v[62:63], v11 offset:18688
    v_mfma_f32_16x16x32_bf16 v[108:111], v[36:39], v[20:23], v[108:111]
    ds_read_b64_tr_b16 v[64:65], v10 offset:22528
    v_mfma_f32_16x16x32_bf16 v[160:163], v[168:171], v[20:23], v[160:163]
    ds_read_b64_tr_b16 v[66:67], v10 offset:22784
    v_mfma_f32_16x16x32_bf16 v[164:167], v[20:23], v[20:23], v[164:167]
    s_waitcnt lgkmcnt(6)
    v_mfma_f32_16x16x32_bf16 v[88:91], v[40:43], v[16:19], v[88:91]
    ds_read_b64_tr_b16 v[68:69], v11 offset:22528
    v_mfma_f32_16x16x32_bf16 v[112:115], v[40:43], v[20:23], v[112:115]
    ds_read_b64_tr_b16 v[70:71], v11 offset:22784
    v_mfma_f32_16x16x32_bf16 v[128:131], v[168:171], v[136:139], v[128:131]
    ds_read_b64_tr_b16 v[72:73], v10 offset:26624
    v_mfma_f32_16x16x32_bf16 v[92:95], v[44:47], v[16:19], v[92:95]
    ds_read_b64_tr_b16 v[74:75], v10 offset:26880
    v_mfma_f32_16x16x32_bf16 v[116:119], v[44:47], v[20:23], v[116:119]
    ds_read_b64_tr_b16 v[76:77], v11 offset:26624
    v_mfma_f32_16x16x32_bf16 v[132:135], v[168:171], v[140:143], v[132:135]
    ds_read_b64_tr_b16 v[78:79], v11 offset:26880
    v_mfma_f32_16x16x32_bf16 v[96:99], v[16:19], v[48:51], v[96:99]
    ds_read_b64_tr_b16 v[144:145], v14 offset:18432
    v_mfma_f32_16x16x32_bf16 v[120:123], v[20:23], v[48:51], v[120:123]
    ds_read_b64_tr_b16 v[146:147], v14 offset:18688
    v_mfma_f32_16x16x32_bf16 v[100:103], v[16:19], v[52:55], v[100:103]
    ds_read_b64_tr_b16 v[148:149], v15 offset:18432
    ds_read_b64_tr_b16 v[150:151], v15 offset:18688
    v_mfma_f32_16x16x32_bf16 v[124:127], v[20:23], v[52:55], v[124:127]
    s_waitcnt lgkmcnt(0)
    s_barrier
    v_add_u32 v10, 28672, v10
    v_add_u32 v11, 28672, v11
    v_add_u32 v12, 28672, v12
    v_add_u32 v13, 28672, v13
    v_add_u32 v14, 28672, v14
    v_add_u32 v15, 28672, v15
    ds_read_b128 v[16:19], v12 offset:0
    v_mfma_f32_16x16x32_bf16 v[80:83], v[56:59], v[24:27], v[80:83]
    ds_read_b128 v[20:23], v12 offset:2048
    v_mfma_f32_16x16x32_bf16 v[104:107], v[56:59], v[28:31], v[104:107]
    ds_read_b64_tr_b16 v[32:33], v10 offset:16384
    v_mfma_f32_16x16x32_bf16 v[152:155], v[168:171], v[24:27], v[152:155]
    ds_read_b64_tr_b16 v[34:35], v10 offset:16640
    v_mfma_f32_16x16x32_bf16 v[156:159], v[24:27], v[24:27], v[156:159]
    ds_read_b64_tr_b16 v[36:37], v11 offset:16384
    v_mfma_f32_16x16x32_bf16 v[84:87], v[60:63], v[24:27], v[84:87]
    ds_read_b64_tr_b16 v[38:39], v11 offset:16640
    v_mfma_f32_16x16x32_bf16 v[108:111], v[60:63], v[28:31], v[108:111]
    ds_read_b64_tr_b16 v[40:41], v10 offset:20480
    v_mfma_f32_16x16x32_bf16 v[160:163], v[168:171], v[28:31], v[160:163]
    ds_read_b64_tr_b16 v[42:43], v10 offset:20736
    v_mfma_f32_16x16x32_bf16 v[164:167], v[28:31], v[28:31], v[164:167]
    s_waitcnt lgkmcnt(6)
    v_mfma_f32_16x16x32_bf16 v[88:91], v[64:67], v[24:27], v[88:91]
    ds_read_b64_tr_b16 v[44:45], v11 offset:20480
    v_mfma_f32_16x16x32_bf16 v[112:115], v[64:67], v[28:31], v[112:115]
    ds_read_b64_tr_b16 v[46:47], v11 offset:20736
    v_mfma_f32_16x16x32_bf16 v[128:131], v[168:171], v[144:147], v[128:131]
    ds_read_b64_tr_b16 v[48:49], v10 offset:24576
    v_mfma_f32_16x16x32_bf16 v[92:95], v[68:71], v[24:27], v[92:95]
    ds_read_b64_tr_b16 v[50:51], v10 offset:24832
    v_mfma_f32_16x16x32_bf16 v[116:119], v[68:71], v[28:31], v[116:119]
    ds_read_b64_tr_b16 v[52:53], v11 offset:24576
    v_mfma_f32_16x16x32_bf16 v[132:135], v[168:171], v[148:151], v[132:135]
    ds_read_b64_tr_b16 v[54:55], v11 offset:24832
    v_mfma_f32_16x16x32_bf16 v[96:99], v[24:27], v[72:75], v[96:99]
    ds_read_b64_tr_b16 v[136:137], v14 offset:16384
    v_mfma_f32_16x16x32_bf16 v[120:123], v[28:31], v[72:75], v[120:123]
    ds_read_b64_tr_b16 v[138:139], v14 offset:16640
    v_mfma_f32_16x16x32_bf16 v[100:103], v[24:27], v[76:79], v[100:103]
    ds_read_b64_tr_b16 v[140:141], v15 offset:16384
    ds_read_b64_tr_b16 v[142:143], v15 offset:16640
    v_mfma_f32_16x16x32_bf16 v[124:127], v[28:31], v[76:79], v[124:127]
    s_waitcnt lgkmcnt(0)
    ds_read_b128 v[24:27], v13 offset:0
    v_mfma_f32_16x16x32_bf16 v[80:83], v[32:35], v[16:19], v[80:83]
    ds_read_b128 v[28:31], v13 offset:2048
    v_mfma_f32_16x16x32_bf16 v[104:107], v[32:35], v[20:23], v[104:107]
    ds_read_b64_tr_b16 v[56:57], v10 offset:18432
    v_mfma_f32_16x16x32_bf16 v[152:155], v[168:171], v[16:19], v[152:155]
    ds_read_b64_tr_b16 v[58:59], v10 offset:18688
    v_mfma_f32_16x16x32_bf16 v[156:159], v[16:19], v[16:19], v[156:159]
    ds_read_b64_tr_b16 v[60:61], v11 offset:18432
    v_mfma_f32_16x16x32_bf16 v[84:87], v[36:39], v[16:19], v[84:87]
    ds_read_b64_tr_b16 v[62:63], v11 offset:18688
    v_mfma_f32_16x16x32_bf16 v[108:111], v[36:39], v[20:23], v[108:111]
    ds_read_b64_tr_b16 v[64:65], v10 offset:22528
    v_mfma_f32_16x16x32_bf16 v[160:163], v[168:171], v[20:23], v[160:163]
    ds_read_b64_tr_b16 v[66:67], v10 offset:22784
    v_mfma_f32_16x16x32_bf16 v[164:167], v[20:23], v[20:23], v[164:167]
    s_waitcnt lgkmcnt(6)
    v_mfma_f32_16x16x32_bf16 v[88:91], v[40:43], v[16:19], v[88:91]
    ds_read_b64_tr_b16 v[68:69], v11 offset:22528
    v_mfma_f32_16x16x32_bf16 v[112:115], v[40:43], v[20:23], v[112:115]
    ds_read_b64_tr_b16 v[70:71], v11 offset:22784
    v_mfma_f32_16x16x32_bf16 v[128:131], v[168:171], v[136:139], v[128:131]
    ds_read_b64_tr_b16 v[72:73], v10 offset:26624
    v_mfma_f32_16x16x32_bf16 v[92:95], v[44:47], v[16:19], v[92:95]
    ds_read_b64_tr_b16 v[74:75], v10 offset:26880
    v_mfma_f32_16x16x32_bf16 v[116:119], v[44:47], v[20:23], v[116:119]
    ds_read_b64_tr_b16 v[76:77], v11 offset:26624
    v_mfma_f32_16x16x32_bf16 v[132:135], v[168:171], v[140:143], v[132:135]
    ds_read_b64_tr_b16 v[78:79], v11 offset:26880
    v_mfma_f32_16x16x32_bf16 v[96:99], v[16:19], v[48:51], v[96:99]
    ds_read_b64_tr_b16 v[144:145], v14 offset:18432
    v_mfma_f32_16x16x32_bf16 v[120:123], v[20:23], v[48:51], v[120:123]
    ds_read_b64_tr_b16 v[146:147], v14 offset:18688
    v_mfma_f32_16x16x32_bf16 v[100:103], v[16:19], v[52:55], v[100:103]
    ds_read_b64_tr_b16 v[148:149], v15 offset:18432
    ds_read_b64_tr_b16 v[150:151], v15 offset:18688
    v_mfma_f32_16x16x32_bf16 v[124:127], v[20:23], v[52:55], v[124:127]
    s_waitcnt lgkmcnt(0)
    s_barrier
    v_add_u32 v10, 28672, v10
    v_add_u32 v11, 28672, v11
    v_add_u32 v12, 28672, v12
    v_add_u32 v13, 28672, v13
    v_add_u32 v14, 28672, v14
    v_add_u32 v15, 28672, v15
    ds_read_b128 v[16:19], v12 offset:0
    v_mfma_f32_16x16x32_bf16 v[80:83], v[56:59], v[24:27], v[80:83]
    ds_read_b128 v[20:23], v12 offset:2048
    v_mfma_f32_16x16x32_bf16 v[104:107], v[56:59], v[28:31], v[104:107]
    ds_read_b64_tr_b16 v[32:33], v10 offset:16384
    v_mfma_f32_16x16x32_bf16 v[152:155], v[168:171], v[24:27], v[152:155]
    ds_read_b64_tr_b16 v[34:35], v10 offset:16640
    v_mfma_f32_16x16x32_bf16 v[156:159], v[24:27], v[24:27], v[156:159]
    ds_read_b64_tr_b16 v[36:37], v11 offset:16384
    v_mfma_f32_16x16x32_bf16 v[84:87], v[60:63], v[24:27], v[84:87]
    ds_read_b64_tr_b16 v[38:39], v11 offset:16640
    v_mfma_f32_16x16x32_bf16 v[108:111], v[60:63], v[28:31], v[108:111]
    ds_read_b64_tr_b16 v[40:41], v10 offset:20480
    v_mfma_f32_16x16x32_bf16 v[160:163], v[168:171], v[28:31], v[160:163]
    ds_read_b64_tr_b16 v[42:43], v10 offset:20736
    v_mfma_f32_16x16x32_bf16 v[164:167], v[28:31], v[28:31], v[164:167]
    s_waitcnt lgkmcnt(6)
    v_mfma_f32_16x16x32_bf16 v[88:91], v[64:67], v[24:27], v[88:91]
    ds_read_b64_tr_b16 v[44:45], v11 offset:20480
    v_mfma_f32_16x16x32_bf16 v[112:115], v[64:67], v[28:31], v[112:115]
    ds_read_b64_tr_b16 v[46:47], v11 offset:20736
    v_mfma_f32_16x16x32_bf16 v[128:131], v[168:171], v[144:147], v[128:131]
    ds_read_b64_tr_b16 v[48:49], v10 offset:24576
    v_mfma_f32_16x16x32_bf16 v[92:95], v[68:71], v[24:27], v[92:95]
    ds_read_b64_tr_b16 v[50:51], v10 offset:24832
    v_mfma_f32_16x16x32_bf16 v[116:119], v[68:71], v[28:31], v[116:119]
    ds_read_b64_tr_b16 v[52:53], v11 offset:24576
    v_mfma_f32_16x16x32_bf16 v[132:135], v[168:171], v[148:151], v[132:135]
    ds_read_b64_tr_b16 v[54:55], v11 offset:24832
    v_mfma_f32_16x16x32_bf16 v[96:99], v[24:27], v[72:75], v[96:99]
    ds_read_b64_tr_b16 v[136:137], v14 offset:16384
    v_mfma_f32_16x16x32_bf16 v[120:123], v[28:31], v[72:75], v[120:123]
    ds_read_b64_tr_b16 v[138:139], v14 offset:16640
    v_mfma_f32_16x16x32_bf16 v[100:103], v[24:27], v[76:79], v[100:103]
    ds_read_b64_tr_b16 v[140:141], v15 offset:16384
    ds_read_b64_tr_b16 v[142:143], v15 offset:16640
    v_mfma_f32_16x16x32_bf16 v[124:127], v[28:31], v[76:79], v[124:127]
    s_waitcnt lgkmcnt(0)
    ds_read_b128 v[24:27], v13 offset:0
    v_mfma_f32_16x16x32_bf16 v[80:83], v[32:35], v[16:19], v[80:83]
    ds_read_b128 v[28:31], v13 offset:2048
    v_mfma_f32_16x16x32_bf16 v[104:107], v[32:35], v[20:23], v[104:107]
    ds_read_b64_tr_b16 v[56:57], v10 offset:18432
    v_mfma_f32_16x16x32_bf16 v[152:155], v[168:171], v[16:19], v[152:155]
    ds_read_b64_tr_b16 v[58:59], v10 offset:18688
    v_mfma_f32_16x16x32_bf16 v[156:159], v[16:19], v[16:19], v[156:159]
    ds_read_b64_tr_b16 v[60:61], v11 offset:18432
    v_mfma_f32_16x16x32_bf16 v[84:87], v[36:39], v[16:19], v[84:87]
    ds_read_b64_tr_b16 v[62:63], v11 offset:18688
    v_mfma_f32_16x16x32_bf16 v[108:111], v[36:39], v[20:23], v[108:111]
    ds_read_b64_tr_b16 v[64:65], v10 offset:22528
    v_mfma_f32_16x16x32_bf16 v[160:163], v[168:171], v[20:23], v[160:163]
    ds_read_b64_tr_b16 v[66:67], v10 offset:22784
    v_mfma_f32_16x16x32_bf16 v[164:167], v[20:23], v[20:23], v[164:167]
    s_waitcnt lgkmcnt(6)
    v_mfma_f32_16x16x32_bf16 v[88:91], v[40:43], v[16:19], v[88:91]
    ds_read_b64_tr_b16 v[68:69], v11 offset:22528
    v_mfma_f32_16x16x32_bf16 v[112:115], v[40:43], v[20:23], v[112:115]
    ds_read_b64_tr_b16 v[70:71], v11 offset:22784
    v_mfma_f32_16x16x32_bf16 v[128:131], v[168:171], v[136:139], v[128:131]
    ds_read_b64_tr_b16 v[72:73], v10 offset:26624
    v_mfma_f32_16x16x32_bf16 v[92:95], v[44:47], v[16:19], v[92:95]
    ds_read_b64_tr_b16 v[74:75], v10 offset:26880
    v_mfma_f32_16x16x32_bf16 v[116:119], v[44:47], v[20:23], v[116:119]
    ds_read_b64_tr_b16 v[76:77], v11 offset:26624
    v_mfma_f32_16x16x32_bf16 v[132:135], v[168:171], v[140:143], v[132:135]
    ds_read_b64_tr_b16 v[78:79], v11 offset:26880
    v_mfma_f32_16x16x32_bf16 v[96:99], v[16:19], v[48:51], v[96:99]
    ds_read_b64_tr_b16 v[144:145], v14 offset:18432
    v_mfma_f32_16x16x32_bf16 v[120:123], v[20:23], v[48:51], v[120:123]
    ds_read_b64_tr_b16 v[146:147], v14 offset:18688
    v_mfma_f32_16x16x32_bf16 v[100:103], v[16:19], v[52:55], v[100:103]
    ds_read_b64_tr_b16 v[148:149], v15 offset:18432
    ds_read_b64_tr_b16 v[150:151], v15 offset:18688
    v_mfma_f32_16x16x32_bf16 v[124:127], v[20:23], v[52:55], v[124:127]
    s_waitcnt lgkmcnt(0)
    s_barrier
    v_add_u32 v10, 28672, v10
    v_add_u32 v11, 28672, v11
    v_add_u32 v12, 28672, v12
    v_add_u32 v13, 28672, v13
    v_add_u32 v14, 28672, v14
    v_add_u32 v15, 28672, v15
    ds_read_b128 v[16:19], v12 offset:0
    v_mfma_f32_16x16x32_bf16 v[80:83], v[56:59], v[24:27], v[80:83]
    ds_read_b128 v[20:23], v12 offset:2048
    v_mfma_f32_16x16x32_bf16 v[104:107], v[56:59], v[28:31], v[104:107]
    ds_read_b64_tr_b16 v[32:33], v10 offset:16384
    v_mfma_f32_16x16x32_bf16 v[152:155], v[168:171], v[24:27], v[152:155]
    ds_read_b64_tr_b16 v[34:35], v10 offset:16640
    v_mfma_f32_16x16x32_bf16 v[156:159], v[24:27], v[24:27], v[156:159]
    ds_read_b64_tr_b16 v[36:37], v11 offset:16384
    v_mfma_f32_16x16x32_bf16 v[84:87], v[60:63], v[24:27], v[84:87]
    ds_read_b64_tr_b16 v[38:39], v11 offset:16640
    v_mfma_f32_16x16x32_bf16 v[108:111], v[60:63], v[28:31], v[108:111]
    ds_read_b64_tr_b16 v[40:41], v10 offset:20480
    v_mfma_f32_16x16x32_bf16 v[160:163], v[168:171], v[28:31], v[160:163]
    ds_read_b64_tr_b16 v[42:43], v10 offset:20736
    v_mfma_f32_16x16x32_bf16 v[164:167], v[28:31], v[28:31], v[164:167]
    s_waitcnt lgkmcnt(6)
    v_mfma_f32_16x16x32_bf16 v[88:91], v[64:67], v[24:27], v[88:91]
    ds_read_b64_tr_b16 v[44:45], v11 offset:20480
    v_mfma_f32_16x16x32_bf16 v[112:115], v[64:67], v[28:31], v[112:115]
    ds_read_b64_tr_b16 v[46:47], v11 offset:20736
    v_mfma_f32_16x16x32_bf16 v[128:131], v[168:171], v[144:147], v[128:131]
    ds_read_b64_tr_b16 v[48:49], v10 offset:24576
    v_mfma_f32_16x16x32_bf16 v[92:95], v[68:71], v[24:27], v[92:95]
    ds_read_b64_tr_b16 v[50:51], v10 offset:24832
    v_mfma_f32_16x16x32_bf16 v[116:119], v[68:71], v[28:31], v[116:119]
    ds_read_b64_tr_b16 v[52:53], v11 offset:24576
    v_mfma_f32_16x16x32_bf16 v[132:135], v[168:171], v[148:151], v[132:135]
    ds_read_b64_tr_b16 v[54:55], v11 offset:24832
    v_mfma_f32_16x16x32_bf16 v[96:99], v[24:27], v[72:75], v[96:99]
    ds_read_b64_tr_b16 v[136:137], v14 offset:16384
    v_mfma_f32_16x16x32_bf16 v[120:123], v[28:31], v[72:75], v[120:123]
    ds_read_b64_tr_b16 v[138:139], v14 offset:16640
    v_mfma_f32_16x16x32_bf16 v[100:103], v[24:27], v[76:79], v[100:103]
    ds_read_b64_tr_b16 v[140:141], v15 offset:16384
    ds_read_b64_tr_b16 v[142:143], v15 offset:16640
    v_mfma_f32_16x16x32_bf16 v[124:127], v[28:31], v[76:79], v[124:127]
    s_waitcnt lgkmcnt(0)
    ds_read_b128 v[24:27], v13 offset:0
    v_mfma_f32_16x16x32_bf16 v[80:83], v[32:35], v[16:19], v[80:83]
    ds_read_b128 v[28:31], v13 offset:2048
    v_mfma_f32_16x16x32_bf16 v[104:107], v[32:35], v[20:23], v[104:107]
    ds_read_b64_tr_b16 v[56:57], v10 offset:18432
    v_mfma_f32_16x16x32_bf16 v[152:155], v[168:171], v[16:19], v[152:155]
    ds_read_b64_tr_b16 v[58:59], v10 offset:18688
    v_mfma_f32_16x16x32_bf16 v[156:159], v[16:19], v[16:19], v[156:159]
    ds_read_b64_tr_b16 v[60:61], v11 offset:18432
    v_mfma_f32_16x16x32_bf16 v[84:87], v[36:39], v[16:19], v[84:87]
    ds_read_b64_tr_b16 v[62:63], v11 offset:18688
    v_mfma_f32_16x16x32_bf16 v[108:111], v[36:39], v[20:23], v[108:111]
    ds_read_b64_tr_b16 v[64:65], v10 offset:22528
    v_mfma_f32_16x16x32_bf16 v[160:163], v[168:171], v[20:23], v[160:163]
    ds_read_b64_tr_b16 v[66:67], v10 offset:22784
    v_mfma_f32_16x16x32_bf16 v[164:167], v[20:23], v[20:23], v[164:167]
    s_waitcnt lgkmcnt(6)
    v_mfma_f32_16x16x32_bf16 v[88:91], v[40:43], v[16:19], v[88:91]
    ds_read_b64_tr_b16 v[68:69], v11 offset:22528
    v_mfma_f32_16x16x32_bf16 v[112:115], v[40:43], v[20:23], v[112:115]
    ds_read_b64_tr_b16 v[70:71], v11 offset:22784
    v_mfma_f32_16x16x32_bf16 v[128:131], v[168:171], v[136:139], v[128:131]
    ds_read_b64_tr_b16 v[72:73], v10 offset:26624
    v_mfma_f32_16x16x32_bf16 v[92:95], v[44:47], v[16:19], v[92:95]
    ds_read_b64_tr_b16 v[74:75], v10 offset:26880
    v_mfma_f32_16x16x32_bf16 v[116:119], v[44:47], v[20:23], v[116:119]
    ds_read_b64_tr_b16 v[76:77], v11 offset:26624
    v_mfma_f32_16x16x32_bf16 v[132:135], v[168:171], v[140:143], v[132:135]
    ds_read_b64_tr_b16 v[78:79], v11 offset:26880
    v_mfma_f32_16x16x32_bf16 v[96:99], v[16:19], v[48:51], v[96:99]
    ds_read_b64_tr_b16 v[144:145], v14 offset:18432
    v_mfma_f32_16x16x32_bf16 v[120:123], v[20:23], v[48:51], v[120:123]
    ds_read_b64_tr_b16 v[146:147], v14 offset:18688
    v_mfma_f32_16x16x32_bf16 v[100:103], v[16:19], v[52:55], v[100:103]
    ds_read_b64_tr_b16 v[148:149], v15 offset:18432
    ds_read_b64_tr_b16 v[150:151], v15 offset:18688
    v_mfma_f32_16x16x32_bf16 v[124:127], v[20:23], v[52:55], v[124:127]
    s_waitcnt lgkmcnt(0)
    s_barrier
    v_add_u32 v10, 28672, v10
    v_add_u32 v11, 28672, v11
    v_add_u32 v12, 28672, v12
    v_add_u32 v13, 28672, v13
    v_add_u32 v14, 28672, v14
    v_add_u32 v15, 28672, v15
    ds_read_b128 v[16:19], v12 offset:0
    v_mfma_f32_16x16x32_bf16 v[80:83], v[56:59], v[24:27], v[80:83]
    ds_read_b128 v[20:23], v12 offset:2048
    v_mfma_f32_16x16x32_bf16 v[104:107], v[56:59], v[28:31], v[104:107]
    ds_read_b64_tr_b16 v[32:33], v10 offset:16384
    v_mfma_f32_16x16x32_bf16 v[152:155], v[168:171], v[24:27], v[152:155]
    ds_read_b64_tr_b16 v[34:35], v10 offset:16640
    v_mfma_f32_16x16x32_bf16 v[156:159], v[24:27], v[24:27], v[156:159]
    ds_read_b64_tr_b16 v[36:37], v11 offset:16384
    v_mfma_f32_16x16x32_bf16 v[84:87], v[60:63], v[24:27], v[84:87]
    ds_read_b64_tr_b16 v[38:39], v11 offset:16640
    v_mfma_f32_16x16x32_bf16 v[108:111], v[60:63], v[28:31], v[108:111]
    ds_read_b64_tr_b16 v[40:41], v10 offset:20480
    v_mfma_f32_16x16x32_bf16 v[160:163], v[168:171], v[28:31], v[160:163]
    ds_read_b64_tr_b16 v[42:43], v10 offset:20736
    v_mfma_f32_16x16x32_bf16 v[164:167], v[28:31], v[28:31], v[164:167]
    s_waitcnt lgkmcnt(6)
    v_mfma_f32_16x16x32_bf16 v[88:91], v[64:67], v[24:27], v[88:91]
    ds_read_b64_tr_b16 v[44:45], v11 offset:20480
    v_mfma_f32_16x16x32_bf16 v[112:115], v[64:67], v[28:31], v[112:115]
    ds_read_b64_tr_b16 v[46:47], v11 offset:20736
    v_mfma_f32_16x16x32_bf16 v[128:131], v[168:171], v[144:147], v[128:131]
    ds_read_b64_tr_b16 v[48:49], v10 offset:24576
    v_mfma_f32_16x16x32_bf16 v[92:95], v[68:71], v[24:27], v[92:95]
    ds_read_b64_tr_b16 v[50:51], v10 offset:24832
    v_mfma_f32_16x16x32_bf16 v[116:119], v[68:71], v[28:31], v[116:119]
    ds_read_b64_tr_b16 v[52:53], v11 offset:24576
    v_mfma_f32_16x16x32_bf16 v[132:135], v[168:171], v[148:151], v[132:135]
    ds_read_b64_tr_b16 v[54:55], v11 offset:24832
    v_mfma_f32_16x16x32_bf16 v[96:99], v[24:27], v[72:75], v[96:99]
    ds_read_b64_tr_b16 v[136:137], v14 offset:16384
    v_mfma_f32_16x16x32_bf16 v[120:123], v[28:31], v[72:75], v[120:123]
    ds_read_b64_tr_b16 v[138:139], v14 offset:16640
    v_mfma_f32_16x16x32_bf16 v[100:103], v[24:27], v[76:79], v[100:103]
    ds_read_b64_tr_b16 v[140:141], v15 offset:16384
    ds_read_b64_tr_b16 v[142:143], v15 offset:16640
    v_mfma_f32_16x16x32_bf16 v[124:127], v[28:31], v[76:79], v[124:127]
    s_waitcnt lgkmcnt(0)
    ds_read_b128 v[24:27], v13 offset:0
    v_mfma_f32_16x16x32_bf16 v[80:83], v[32:35], v[16:19], v[80:83]
    ds_read_b128 v[28:31], v13 offset:2048
    v_mfma_f32_16x16x32_bf16 v[104:107], v[32:35], v[20:23], v[104:107]
    ds_read_b64_tr_b16 v[56:57], v10 offset:18432
    v_mfma_f32_16x16x32_bf16 v[152:155], v[168:171], v[16:19], v[152:155]
    ds_read_b64_tr_b16 v[58:59], v10 offset:18688
    v_mfma_f32_16x16x32_bf16 v[156:159], v[16:19], v[16:19], v[156:159]
    ds_read_b64_tr_b16 v[60:61], v11 offset:18432
    v_mfma_f32_16x16x32_bf16 v[84:87], v[36:39], v[16:19], v[84:87]
    ds_read_b64_tr_b16 v[62:63], v11 offset:18688
    v_mfma_f32_16x16x32_bf16 v[108:111], v[36:39], v[20:23], v[108:111]
    ds_read_b64_tr_b16 v[64:65], v10 offset:22528
    v_mfma_f32_16x16x32_bf16 v[160:163], v[168:171], v[20:23], v[160:163]
    ds_read_b64_tr_b16 v[66:67], v10 offset:22784
    v_mfma_f32_16x16x32_bf16 v[164:167], v[20:23], v[20:23], v[164:167]
    s_waitcnt lgkmcnt(6)
    v_mfma_f32_16x16x32_bf16 v[88:91], v[40:43], v[16:19], v[88:91]
    ds_read_b64_tr_b16 v[68:69], v11 offset:22528
    v_mfma_f32_16x16x32_bf16 v[112:115], v[40:43], v[20:23], v[112:115]
    ds_read_b64_tr_b16 v[70:71], v11 offset:22784
    v_mfma_f32_16x16x32_bf16 v[128:131], v[168:171], v[136:139], v[128:131]
    ds_read_b64_tr_b16 v[72:73], v10 offset:26624
    v_mfma_f32_16x16x32_bf16 v[92:95], v[44:47], v[16:19], v[92:95]
    ds_read_b64_tr_b16 v[74:75], v10 offset:26880
    v_mfma_f32_16x16x32_bf16 v[116:119], v[44:47], v[20:23], v[116:119]
    ds_read_b64_tr_b16 v[76:77], v11 offset:26624
    v_mfma_f32_16x16x32_bf16 v[132:135], v[168:171], v[140:143], v[132:135]
    ds_read_b64_tr_b16 v[78:79], v11 offset:26880
    v_mfma_f32_16x16x32_bf16 v[96:99], v[16:19], v[48:51], v[96:99]
    ds_read_b64_tr_b16 v[144:145], v14 offset:18432
    v_mfma_f32_16x16x32_bf16 v[120:123], v[20:23], v[48:51], v[120:123]
    ds_read_b64_tr_b16 v[146:147], v14 offset:18688
    v_mfma_f32_16x16x32_bf16 v[100:103], v[16:19], v[52:55], v[100:103]
    ds_read_b64_tr_b16 v[148:149], v15 offset:18432
    ds_read_b64_tr_b16 v[150:151], v15 offset:18688
    v_mfma_f32_16x16x32_bf16 v[124:127], v[20:23], v[52:55], v[124:127]
    s_waitcnt lgkmcnt(0)
    s_barrier
    v_add_u32 v10, 4294852608, v10
    v_add_u32 v11, 4294852608, v11
    v_add_u32 v12, 4294852608, v12
    v_add_u32 v13, 4294852608, v13
    v_add_u32 v14, 4294852608, v14
    v_add_u32 v15, 4294852608, v15
    ds_read_b128 v[16:19], v12 offset:0
    v_mfma_f32_16x16x32_bf16 v[80:83], v[56:59], v[24:27], v[80:83]
    ds_read_b128 v[20:23], v12 offset:2048
    v_mfma_f32_16x16x32_bf16 v[104:107], v[56:59], v[28:31], v[104:107]
    ds_read_b64_tr_b16 v[32:33], v10 offset:16384
    v_mfma_f32_16x16x32_bf16 v[152:155], v[168:171], v[24:27], v[152:155]
    ds_read_b64_tr_b16 v[34:35], v10 offset:16640
    v_mfma_f32_16x16x32_bf16 v[156:159], v[24:27], v[24:27], v[156:159]
    ds_read_b64_tr_b16 v[36:37], v11 offset:16384
    v_mfma_f32_16x16x32_bf16 v[84:87], v[60:63], v[24:27], v[84:87]
    ds_read_b64_tr_b16 v[38:39], v11 offset:16640
    v_mfma_f32_16x16x32_bf16 v[108:111], v[60:63], v[28:31], v[108:111]
    ds_read_b64_tr_b16 v[40:41], v10 offset:20480
    v_mfma_f32_16x16x32_bf16 v[160:163], v[168:171], v[28:31], v[160:163]
    ds_read_b64_tr_b16 v[42:43], v10 offset:20736
    v_mfma_f32_16x16x32_bf16 v[164:167], v[28:31], v[28:31], v[164:167]
    s_waitcnt lgkmcnt(6)
    v_mfma_f32_16x16x32_bf16 v[88:91], v[64:67], v[24:27], v[88:91]
    ds_read_b64_tr_b16 v[44:45], v11 offset:20480
    v_mfma_f32_16x16x32_bf16 v[112:115], v[64:67], v[28:31], v[112:115]
    ds_read_b64_tr_b16 v[46:47], v11 offset:20736
    v_mfma_f32_16x16x32_bf16 v[128:131], v[168:171], v[144:147], v[128:131]
    ds_read_b64_tr_b16 v[48:49], v10 offset:24576
    v_mfma_f32_16x16x32_bf16 v[92:95], v[68:71], v[24:27], v[92:95]
    ds_read_b64_tr_b16 v[50:51], v10 offset:24832
    v_mfma_f32_16x16x32_bf16 v[116:119], v[68:71], v[28:31], v[116:119]
    ds_read_b64_tr_b16 v[52:53], v11 offset:24576
    v_mfma_f32_16x16x32_bf16 v[132:135], v[168:171], v[148:151], v[132:135]
    ds_read_b64_tr_b16 v[54:55], v11 offset:24832
    v_mfma_f32_16x16x32_bf16 v[96:99], v[24:27], v[72:75], v[96:99]
    ds_read_b64_tr_b16 v[136:137], v14 offset:16384
    v_mfma_f32_16x16x32_bf16 v[120:123], v[28:31], v[72:75], v[120:123]
    ds_read_b64_tr_b16 v[138:139], v14 offset:16640
    v_mfma_f32_16x16x32_bf16 v[100:103], v[24:27], v[76:79], v[100:103]
    ds_read_b64_tr_b16 v[140:141], v15 offset:16384
    ds_read_b64_tr_b16 v[142:143], v15 offset:16640
    v_mfma_f32_16x16x32_bf16 v[124:127], v[28:31], v[76:79], v[124:127]
    s_waitcnt lgkmcnt(0)
    ds_read_b128 v[24:27], v13 offset:0
    v_mfma_f32_16x16x32_bf16 v[80:83], v[32:35], v[16:19], v[80:83]
    ds_read_b128 v[28:31], v13 offset:2048
    v_mfma_f32_16x16x32_bf16 v[104:107], v[32:35], v[20:23], v[104:107]
    ds_read_b64_tr_b16 v[56:57], v10 offset:18432
    v_mfma_f32_16x16x32_bf16 v[152:155], v[168:171], v[16:19], v[152:155]
    ds_read_b64_tr_b16 v[58:59], v10 offset:18688
    v_mfma_f32_16x16x32_bf16 v[156:159], v[16:19], v[16:19], v[156:159]
    ds_read_b64_tr_b16 v[60:61], v11 offset:18432
    v_mfma_f32_16x16x32_bf16 v[84:87], v[36:39], v[16:19], v[84:87]
    ds_read_b64_tr_b16 v[62:63], v11 offset:18688
    v_mfma_f32_16x16x32_bf16 v[108:111], v[36:39], v[20:23], v[108:111]
    ds_read_b64_tr_b16 v[64:65], v10 offset:22528
    v_mfma_f32_16x16x32_bf16 v[160:163], v[168:171], v[20:23], v[160:163]
    ds_read_b64_tr_b16 v[66:67], v10 offset:22784
    v_mfma_f32_16x16x32_bf16 v[164:167], v[20:23], v[20:23], v[164:167]
    s_waitcnt lgkmcnt(6)
    v_mfma_f32_16x16x32_bf16 v[88:91], v[40:43], v[16:19], v[88:91]
    ds_read_b64_tr_b16 v[68:69], v11 offset:22528
    v_mfma_f32_16x16x32_bf16 v[112:115], v[40:43], v[20:23], v[112:115]
    ds_read_b64_tr_b16 v[70:71], v11 offset:22784
    v_mfma_f32_16x16x32_bf16 v[128:131], v[168:171], v[136:139], v[128:131]
    ds_read_b64_tr_b16 v[72:73], v10 offset:26624
    v_mfma_f32_16x16x32_bf16 v[92:95], v[44:47], v[16:19], v[92:95]
    ds_read_b64_tr_b16 v[74:75], v10 offset:26880
    v_mfma_f32_16x16x32_bf16 v[116:119], v[44:47], v[20:23], v[116:119]
    ds_read_b64_tr_b16 v[76:77], v11 offset:26624
    v_mfma_f32_16x16x32_bf16 v[132:135], v[168:171], v[140:143], v[132:135]
    ds_read_b64_tr_b16 v[78:79], v11 offset:26880
    v_mfma_f32_16x16x32_bf16 v[96:99], v[16:19], v[48:51], v[96:99]
    ds_read_b64_tr_b16 v[144:145], v14 offset:18432
    v_mfma_f32_16x16x32_bf16 v[120:123], v[20:23], v[48:51], v[120:123]
    ds_read_b64_tr_b16 v[146:147], v14 offset:18688
    v_mfma_f32_16x16x32_bf16 v[100:103], v[16:19], v[52:55], v[100:103]
    ds_read_b64_tr_b16 v[148:149], v15 offset:18432
    ds_read_b64_tr_b16 v[150:151], v15 offset:18688
    v_mfma_f32_16x16x32_bf16 v[124:127], v[20:23], v[52:55], v[124:127]
    s_waitcnt lgkmcnt(0)
    s_barrier
    v_add_u32 v10, 28672, v10
    v_add_u32 v11, 28672, v11
    v_add_u32 v12, 28672, v12
    v_add_u32 v13, 28672, v13
    v_add_u32 v14, 28672, v14
    v_add_u32 v15, 28672, v15
    ds_read_b128 v[16:19], v12 offset:0
    v_mfma_f32_16x16x32_bf16 v[80:83], v[56:59], v[24:27], v[80:83]
    ds_read_b128 v[20:23], v12 offset:2048
    v_mfma_f32_16x16x32_bf16 v[104:107], v[56:59], v[28:31], v[104:107]
    ds_read_b64_tr_b16 v[32:33], v10 offset:16384
    v_mfma_f32_16x16x32_bf16 v[152:155], v[168:171], v[24:27], v[152:155]
    ds_read_b64_tr_b16 v[34:35], v10 offset:16640
    v_mfma_f32_16x16x32_bf16 v[156:159], v[24:27], v[24:27], v[156:159]
    ds_read_b64_tr_b16 v[36:37], v11 offset:16384
    v_mfma_f32_16x16x32_bf16 v[84:87], v[60:63], v[24:27], v[84:87]
    ds_read_b64_tr_b16 v[38:39], v11 offset:16640
    v_mfma_f32_16x16x32_bf16 v[108:111], v[60:63], v[28:31], v[108:111]
    ds_read_b64_tr_b16 v[40:41], v10 offset:20480
    v_mfma_f32_16x16x32_bf16 v[160:163], v[168:171], v[28:31], v[160:163]
    ds_read_b64_tr_b16 v[42:43], v10 offset:20736
    v_mfma_f32_16x16x32_bf16 v[164:167], v[28:31], v[28:31], v[164:167]
    s_waitcnt lgkmcnt(6)
    v_mfma_f32_16x16x32_bf16 v[88:91], v[64:67], v[24:27], v[88:91]
    ds_read_b64_tr_b16 v[44:45], v11 offset:20480
    v_mfma_f32_16x16x32_bf16 v[112:115], v[64:67], v[28:31], v[112:115]
    ds_read_b64_tr_b16 v[46:47], v11 offset:20736
    v_mfma_f32_16x16x32_bf16 v[128:131], v[168:171], v[144:147], v[128:131]
    ds_read_b64_tr_b16 v[48:49], v10 offset:24576
    v_mfma_f32_16x16x32_bf16 v[92:95], v[68:71], v[24:27], v[92:95]
    ds_read_b64_tr_b16 v[50:51], v10 offset:24832
    v_mfma_f32_16x16x32_bf16 v[116:119], v[68:71], v[28:31], v[116:119]
    ds_read_b64_tr_b16 v[52:53], v11 offset:24576
    v_mfma_f32_16x16x32_bf16 v[132:135], v[168:171], v[148:151], v[132:135]
    ds_read_b64_tr_b16 v[54:55], v11 offset:24832
    v_mfma_f32_16x16x32_bf16 v[96:99], v[24:27], v[72:75], v[96:99]
    ds_read_b64_tr_b16 v[136:137], v14 offset:16384
    v_mfma_f32_16x16x32_bf16 v[120:123], v[28:31], v[72:75], v[120:123]
    ds_read_b64_tr_b16 v[138:139], v14 offset:16640
    v_mfma_f32_16x16x32_bf16 v[100:103], v[24:27], v[76:79], v[100:103]
    ds_read_b64_tr_b16 v[140:141], v15 offset:16384
    ds_read_b64_tr_b16 v[142:143], v15 offset:16640
    v_mfma_f32_16x16x32_bf16 v[124:127], v[28:31], v[76:79], v[124:127]
    s_waitcnt lgkmcnt(0)
    ds_read_b128 v[24:27], v13 offset:0
    v_mfma_f32_16x16x32_bf16 v[80:83], v[32:35], v[16:19], v[80:83]
    ds_read_b128 v[28:31], v13 offset:2048
    v_mfma_f32_16x16x32_bf16 v[104:107], v[32:35], v[20:23], v[104:107]
    ds_read_b64_tr_b16 v[56:57], v10 offset:18432
    v_mfma_f32_16x16x32_bf16 v[152:155], v[168:171], v[16:19], v[152:155]
    ds_read_b64_tr_b16 v[58:59], v10 offset:18688
    v_mfma_f32_16x16x32_bf16 v[156:159], v[16:19], v[16:19], v[156:159]
    ds_read_b64_tr_b16 v[60:61], v11 offset:18432
    v_mfma_f32_16x16x32_bf16 v[84:87], v[36:39], v[16:19], v[84:87]
    ds_read_b64_tr_b16 v[62:63], v11 offset:18688
    v_mfma_f32_16x16x32_bf16 v[108:111], v[36:39], v[20:23], v[108:111]
    ds_read_b64_tr_b16 v[64:65], v10 offset:22528
    v_mfma_f32_16x16x32_bf16 v[160:163], v[168:171], v[20:23], v[160:163]
    ds_read_b64_tr_b16 v[66:67], v10 offset:22784
    v_mfma_f32_16x16x32_bf16 v[164:167], v[20:23], v[20:23], v[164:167]
    s_waitcnt lgkmcnt(6)
    v_mfma_f32_16x16x32_bf16 v[88:91], v[40:43], v[16:19], v[88:91]
    ds_read_b64_tr_b16 v[68:69], v11 offset:22528
    v_mfma_f32_16x16x32_bf16 v[112:115], v[40:43], v[20:23], v[112:115]
    ds_read_b64_tr_b16 v[70:71], v11 offset:22784
    v_mfma_f32_16x16x32_bf16 v[128:131], v[168:171], v[136:139], v[128:131]
    ds_read_b64_tr_b16 v[72:73], v10 offset:26624
    v_mfma_f32_16x16x32_bf16 v[92:95], v[44:47], v[16:19], v[92:95]
    ds_read_b64_tr_b16 v[74:75], v10 offset:26880
    v_mfma_f32_16x16x32_bf16 v[116:119], v[44:47], v[20:23], v[116:119]
    ds_read_b64_tr_b16 v[76:77], v11 offset:26624
    v_mfma_f32_16x16x32_bf16 v[132:135], v[168:171], v[140:143], v[132:135]
    ds_read_b64_tr_b16 v[78:79], v11 offset:26880
    v_mfma_f32_16x16x32_bf16 v[96:99], v[16:19], v[48:51], v[96:99]
    ds_read_b64_tr_b16 v[144:145], v14 offset:18432
    v_mfma_f32_16x16x32_bf16 v[120:123], v[20:23], v[48:51], v[120:123]
    ds_read_b64_tr_b16 v[146:147], v14 offset:18688
    v_mfma_f32_16x16x32_bf16 v[100:103], v[16:19], v[52:55], v[100:103]
    ds_read_b64_tr_b16 v[148:149], v15 offset:18432
    ds_read_b64_tr_b16 v[150:151], v15 offset:18688
    v_mfma_f32_16x16x32_bf16 v[124:127], v[20:23], v[52:55], v[124:127]
    s_waitcnt lgkmcnt(0)
    s_barrier
    v_add_u32 v10, 28672, v10
    v_add_u32 v11, 28672, v11
    v_add_u32 v12, 28672, v12
    v_add_u32 v13, 28672, v13
    v_add_u32 v14, 28672, v14
    v_add_u32 v15, 28672, v15
    ds_read_b128 v[16:19], v12 offset:0
    v_mfma_f32_16x16x32_bf16 v[80:83], v[56:59], v[24:27], v[80:83]
    ds_read_b128 v[20:23], v12 offset:2048
    v_mfma_f32_16x16x32_bf16 v[104:107], v[56:59], v[28:31], v[104:107]
    ds_read_b64_tr_b16 v[32:33], v10 offset:16384
    v_mfma_f32_16x16x32_bf16 v[152:155], v[168:171], v[24:27], v[152:155]
    ds_read_b64_tr_b16 v[34:35], v10 offset:16640
    v_mfma_f32_16x16x32_bf16 v[156:159], v[24:27], v[24:27], v[156:159]
    ds_read_b64_tr_b16 v[36:37], v11 offset:16384
    v_mfma_f32_16x16x32_bf16 v[84:87], v[60:63], v[24:27], v[84:87]
    ds_read_b64_tr_b16 v[38:39], v11 offset:16640
    v_mfma_f32_16x16x32_bf16 v[108:111], v[60:63], v[28:31], v[108:111]
    ds_read_b64_tr_b16 v[40:41], v10 offset:20480
    v_mfma_f32_16x16x32_bf16 v[160:163], v[168:171], v[28:31], v[160:163]
    ds_read_b64_tr_b16 v[42:43], v10 offset:20736
    v_mfma_f32_16x16x32_bf16 v[164:167], v[28:31], v[28:31], v[164:167]
    s_waitcnt lgkmcnt(6)
    v_mfma_f32_16x16x32_bf16 v[88:91], v[64:67], v[24:27], v[88:91]
    ds_read_b64_tr_b16 v[44:45], v11 offset:20480
    v_mfma_f32_16x16x32_bf16 v[112:115], v[64:67], v[28:31], v[112:115]
    ds_read_b64_tr_b16 v[46:47], v11 offset:20736
    v_mfma_f32_16x16x32_bf16 v[128:131], v[168:171], v[144:147], v[128:131]
    ds_read_b64_tr_b16 v[48:49], v10 offset:24576
    v_mfma_f32_16x16x32_bf16 v[92:95], v[68:71], v[24:27], v[92:95]
    ds_read_b64_tr_b16 v[50:51], v10 offset:24832
    v_mfma_f32_16x16x32_bf16 v[116:119], v[68:71], v[28:31], v[116:119]
    ds_read_b64_tr_b16 v[52:53], v11 offset:24576
    v_mfma_f32_16x16x32_bf16 v[132:135], v[168:171], v[148:151], v[132:135]
    ds_read_b64_tr_b16 v[54:55], v11 offset:24832
    v_mfma_f32_16x16x32_bf16 v[96:99], v[24:27], v[72:75], v[96:99]
    ds_read_b64_tr_b16 v[136:137], v14 offset:16384
    v_mfma_f32_16x16x32_bf16 v[120:123], v[28:31], v[72:75], v[120:123]
    ds_read_b64_tr_b16 v[138:139], v14 offset:16640
    v_mfma_f32_16x16x32_bf16 v[100:103], v[24:27], v[76:79], v[100:103]
    ds_read_b64_tr_b16 v[140:141], v15 offset:16384
    ds_read_b64_tr_b16 v[142:143], v15 offset:16640
    v_mfma_f32_16x16x32_bf16 v[124:127], v[28:31], v[76:79], v[124:127]
    s_waitcnt lgkmcnt(0)
    ds_read_b128 v[24:27], v13 offset:0
    v_mfma_f32_16x16x32_bf16 v[80:83], v[32:35], v[16:19], v[80:83]
    ds_read_b128 v[28:31], v13 offset:2048
    v_mfma_f32_16x16x32_bf16 v[104:107], v[32:35], v[20:23], v[104:107]
    ds_read_b64_tr_b16 v[56:57], v10 offset:18432
    v_mfma_f32_16x16x32_bf16 v[152:155], v[168:171], v[16:19], v[152:155]
    ds_read_b64_tr_b16 v[58:59], v10 offset:18688
    v_mfma_f32_16x16x32_bf16 v[156:159], v[16:19], v[16:19], v[156:159]
    ds_read_b64_tr_b16 v[60:61], v11 offset:18432
    v_mfma_f32_16x16x32_bf16 v[84:87], v[36:39], v[16:19], v[84:87]
    ds_read_b64_tr_b16 v[62:63], v11 offset:18688
    v_mfma_f32_16x16x32_bf16 v[108:111], v[36:39], v[20:23], v[108:111]
    ds_read_b64_tr_b16 v[64:65], v10 offset:22528
    v_mfma_f32_16x16x32_bf16 v[160:163], v[168:171], v[20:23], v[160:163]
    ds_read_b64_tr_b16 v[66:67], v10 offset:22784
    v_mfma_f32_16x16x32_bf16 v[164:167], v[20:23], v[20:23], v[164:167]
    s_waitcnt lgkmcnt(6)
    v_mfma_f32_16x16x32_bf16 v[88:91], v[40:43], v[16:19], v[88:91]
    ds_read_b64_tr_b16 v[68:69], v11 offset:22528
    v_mfma_f32_16x16x32_bf16 v[112:115], v[40:43], v[20:23], v[112:115]
    ds_read_b64_tr_b16 v[70:71], v11 offset:22784
    v_mfma_f32_16x16x32_bf16 v[128:131], v[168:171], v[136:139], v[128:131]
    ds_read_b64_tr_b16 v[72:73], v10 offset:26624
    v_mfma_f32_16x16x32_bf16 v[92:95], v[44:47], v[16:19], v[92:95]
    ds_read_b64_tr_b16 v[74:75], v10 offset:26880
    v_mfma_f32_16x16x32_bf16 v[116:119], v[44:47], v[20:23], v[116:119]
    ds_read_b64_tr_b16 v[76:77], v11 offset:26624
    v_mfma_f32_16x16x32_bf16 v[132:135], v[168:171], v[140:143], v[132:135]
    ds_read_b64_tr_b16 v[78:79], v11 offset:26880
    v_mfma_f32_16x16x32_bf16 v[96:99], v[16:19], v[48:51], v[96:99]
    ds_read_b64_tr_b16 v[144:145], v14 offset:18432
    v_mfma_f32_16x16x32_bf16 v[120:123], v[20:23], v[48:51], v[120:123]
    ds_read_b64_tr_b16 v[146:147], v14 offset:18688
    v_mfma_f32_16x16x32_bf16 v[100:103], v[16:19], v[52:55], v[100:103]
    ds_read_b64_tr_b16 v[148:149], v15 offset:18432
    ds_read_b64_tr_b16 v[150:151], v15 offset:18688
    v_mfma_f32_16x16x32_bf16 v[124:127], v[20:23], v[52:55], v[124:127]
    s_waitcnt lgkmcnt(0)
    s_barrier
    v_add_u32 v10, 28672, v10
    v_add_u32 v11, 28672, v11
    v_add_u32 v12, 28672, v12
    v_add_u32 v13, 28672, v13
    v_add_u32 v14, 28672, v14
    v_add_u32 v15, 28672, v15
    ds_read_b128 v[16:19], v12 offset:0
    v_mfma_f32_16x16x32_bf16 v[80:83], v[56:59], v[24:27], v[80:83]
    ds_read_b128 v[20:23], v12 offset:2048
    v_mfma_f32_16x16x32_bf16 v[104:107], v[56:59], v[28:31], v[104:107]
    ds_read_b64_tr_b16 v[32:33], v10 offset:16384
    v_mfma_f32_16x16x32_bf16 v[152:155], v[168:171], v[24:27], v[152:155]
    ds_read_b64_tr_b16 v[34:35], v10 offset:16640
    v_mfma_f32_16x16x32_bf16 v[156:159], v[24:27], v[24:27], v[156:159]
    ds_read_b64_tr_b16 v[36:37], v11 offset:16384
    v_mfma_f32_16x16x32_bf16 v[84:87], v[60:63], v[24:27], v[84:87]
    ds_read_b64_tr_b16 v[38:39], v11 offset:16640
    v_mfma_f32_16x16x32_bf16 v[108:111], v[60:63], v[28:31], v[108:111]
    ds_read_b64_tr_b16 v[40:41], v10 offset:20480
    v_mfma_f32_16x16x32_bf16 v[160:163], v[168:171], v[28:31], v[160:163]
    ds_read_b64_tr_b16 v[42:43], v10 offset:20736
    v_mfma_f32_16x16x32_bf16 v[164:167], v[28:31], v[28:31], v[164:167]
    s_waitcnt lgkmcnt(6)
    v_mfma_f32_16x16x32_bf16 v[88:91], v[64:67], v[24:27], v[88:91]
    ds_read_b64_tr_b16 v[44:45], v11 offset:20480
    v_mfma_f32_16x16x32_bf16 v[112:115], v[64:67], v[28:31], v[112:115]
    ds_read_b64_tr_b16 v[46:47], v11 offset:20736
    v_mfma_f32_16x16x32_bf16 v[128:131], v[168:171], v[144:147], v[128:131]
    ds_read_b64_tr_b16 v[48:49], v10 offset:24576
    v_mfma_f32_16x16x32_bf16 v[92:95], v[68:71], v[24:27], v[92:95]
    ds_read_b64_tr_b16 v[50:51], v10 offset:24832
    v_mfma_f32_16x16x32_bf16 v[116:119], v[68:71], v[28:31], v[116:119]
    ds_read_b64_tr_b16 v[52:53], v11 offset:24576
    v_mfma_f32_16x16x32_bf16 v[132:135], v[168:171], v[148:151], v[132:135]
    ds_read_b64_tr_b16 v[54:55], v11 offset:24832
    v_mfma_f32_16x16x32_bf16 v[96:99], v[24:27], v[72:75], v[96:99]
    ds_read_b64_tr_b16 v[136:137], v14 offset:16384
    v_mfma_f32_16x16x32_bf16 v[120:123], v[28:31], v[72:75], v[120:123]
    ds_read_b64_tr_b16 v[138:139], v14 offset:16640
    v_mfma_f32_16x16x32_bf16 v[100:103], v[24:27], v[76:79], v[100:103]
    ds_read_b64_tr_b16 v[140:141], v15 offset:16384
    ds_read_b64_tr_b16 v[142:143], v15 offset:16640
    v_mfma_f32_16x16x32_bf16 v[124:127], v[28:31], v[76:79], v[124:127]
    s_waitcnt lgkmcnt(0)
    s_nop 7
    v_and_b32 v8, 1, v4
    v_lshrrev_b32 v9, 1, v4
    v_lshlrev_b32 v8, 5, v8
    v_lshl_add_u32 v8, v9, 4, v8
    s_mov_b32 s27, 2048
    v_mul_lo_u32 v14, v3, s27
    v_add_u32 v14, v14, v8
    v_lshl_add_u32 v15, v3, 12, v8
    s_mul_i32 s42, s32, 2048
    s_lshl_b32 s28, s33, 1
    s_add_u32 s42, s42, s28
    s_add_u32 s43, s33, -960
    s_lshl_b32 s43, s43, 12
    s_lshl_b32 s28, s32, 1
    s_add_u32 s43, s43, s28
    s_add_u32 s43, s43, 4194304
    v_lshlrev_b32 v8, 2, v3
    v_add_u32 v9, s48, v8
    ds_write_b32 v9, v128 offset:1024
    v_add_u32 v9, s49, v8
    ds_write_b32 v9, v132 offset:1024
    s_waitcnt lgkmcnt(0)
    s_barrier
    v_lshlrev_b32 v8, 4, v4
    v_lshlrev_b32 v9, 2, v3
    ds_read_b128 v[128:131], v8 offset:1024
    ds_read_b128 v[132:135], v8 offset:1088
    ds_read_b128 v[136:139], v8 offset:1152
    ds_read_b128 v[140:143], v8 offset:1216
    ds_read_b32 v144, v9 offset:1280
    ds_read_b32 v148, v9 offset:1344
    v_lshlrev_b32 v8, 2, v4
    v_sub_u32 v8, v3, v8
    v_mov_b32 v33, 0
    v_cmp_eq_u32 vcc, 0, v8
    s_nop 1
    v_cndmask_b32 v33, v33, v156, vcc
    v_cmp_eq_u32 vcc, 1, v8
    s_nop 1
    v_cndmask_b32 v33, v33, v157, vcc
    v_cmp_eq_u32 vcc, 2, v8
    s_nop 1
    v_cndmask_b32 v33, v33, v158, vcc
    v_cmp_eq_u32 vcc, 3, v8
    s_nop 1
    v_cndmask_b32 v33, v33, v159, vcc
    v_mov_b32 v35, v33
    s_nop 1
    v_permlane16_swap_b32 v33, v35
    s_nop 1
    v_add_f32 v33, v33, v35
    v_mov_b32 v35, v33
    s_nop 1
    v_permlane32_swap_b32 v33, v35
    s_nop 1
    v_add_f32 v33, v33, v35
    v_mov_b32 v32, v152
    v_mul_f32 v32, 0x3b000000, v32
    v_mul_f32 v33, 0x3b000000, v33
    v_fma_f32 v34, -v32, v32, v33
    v_max_f32 v34, 0, v34
    v_cvt_pk_bf16_f32 v35, v32, v34
    s_nop 0
    v_lshlrev_b32 v32, 16, v35
    v_and_b32 v34, 0xffff0000, v35
    v_add_f32 v34, 0x3727c5ac, v34
    v_cvt_pk_bf16_f32 v35, v34, v34
    s_nop 0
    v_lshlrev_b32 v34, 16, v35
    v_sqrt_f32 v34, v34
    s_nop 0
    v_cvt_pk_bf16_f32 v35, v34, v34
    s_nop 0
    v_lshlrev_b32 v34, 16, v35
    v_rcp_f32 v152, v34
    s_nop 0
    v_mul_f32 v154, -v32, v152
    v_mov_b32 v33, 0
    v_cmp_eq_u32 vcc, 0, v8
    s_nop 1
    v_cndmask_b32 v33, v33, v164, vcc
    v_cmp_eq_u32 vcc, 1, v8
    s_nop 1
    v_cndmask_b32 v33, v33, v165, vcc
    v_cmp_eq_u32 vcc, 2, v8
    s_nop 1
    v_cndmask_b32 v33, v33, v166, vcc
    v_cmp_eq_u32 vcc, 3, v8
    s_nop 1
    v_cndmask_b32 v33, v33, v167, vcc
    v_mov_b32 v35, v33
    s_nop 1
    v_permlane16_swap_b32 v33, v35
    s_nop 1
    v_add_f32 v33, v33, v35
    v_mov_b32 v35, v33
    s_nop 1
    v_permlane32_swap_b32 v33, v35
    s_nop 1
    v_add_f32 v33, v33, v35
    v_mov_b32 v32, v160
    v_mul_f32 v32, 0x3b000000, v32
    v_mul_f32 v33, 0x3b000000, v33
    v_fma_f32 v34, -v32, v32, v33
    v_max_f32 v34, 0, v34
    v_cvt_pk_bf16_f32 v35, v32, v34
    s_nop 0
    v_lshlrev_b32 v32, 16, v35
    v_and_b32 v34, 0xffff0000, v35
    v_add_f32 v34, 0x3727c5ac, v34
    v_cvt_pk_bf16_f32 v35, v34, v34
    s_nop 0
    v_lshlrev_b32 v34, 16, v35
    v_sqrt_f32 v34, v34
    s_nop 0
    v_cvt_pk_bf16_f32 v35, v34, v34
    s_nop 0
    v_lshlrev_b32 v34, 16, v35
    v_rcp_f32 v160, v34
    s_nop 0
    v_mul_f32 v162, -v32, v160
    s_lshl_b32 s27, s24, 8
    v_lshlrev_b32 v8, 2, v3
    v_add_u32 v8, s27, v8
    ds_write_b32 v8, v152 offset:0
    ds_write_b32 v8, v154 offset:128
    ds_write_b32 v8, v160 offset:64
    ds_write_b32 v8, v162 offset:192
    v_lshlrev_b32 v8, 4, v4
    v_add_u32 v8, s27, v8
    s_waitcnt lgkmcnt(0)
    ds_read_b128 v[56:59], v8 offset:0
    ds_read_b128 v[60:63], v8 offset:128
    ds_read_b128 v[64:67], v8 offset:64
    ds_read_b128 v[68:71], v8 offset:192
    s_waitcnt lgkmcnt(0)
    s_waitcnt lgkmcnt(0)
    v_pk_mul_f32 v[8:9], v[128:129], v[154:155] op_sel_hi:[1,0]
    v_pk_fma_f32 v[80:81], v[80:81], v[152:153], v[8:9] op_sel_hi:[1,0,1]
    v_pk_mul_f32 v[8:9], v[130:131], v[154:155] op_sel_hi:[1,0]
    v_pk_fma_f32 v[82:83], v[82:83], v[152:153], v[8:9] op_sel_hi:[1,0,1]
    v_pk_mul_f32 v[8:9], v[132:133], v[154:155] op_sel_hi:[1,0]
    v_pk_fma_f32 v[84:85], v[84:85], v[152:153], v[8:9] op_sel_hi:[1,0,1]
    v_pk_mul_f32 v[8:9], v[134:135], v[154:155] op_sel_hi:[1,0]
    v_pk_fma_f32 v[86:87], v[86:87], v[152:153], v[8:9] op_sel_hi:[1,0,1]
    v_pk_mul_f32 v[8:9], v[136:137], v[154:155] op_sel_hi:[1,0]
    v_pk_fma_f32 v[88:89], v[88:89], v[152:153], v[8:9] op_sel_hi:[1,0,1]
    v_pk_mul_f32 v[8:9], v[138:139], v[154:155] op_sel_hi:[1,0]
    v_pk_fma_f32 v[90:91], v[90:91], v[152:153], v[8:9] op_sel_hi:[1,0,1]
    v_pk_mul_f32 v[8:9], v[140:141], v[154:155] op_sel_hi:[1,0]
    v_pk_fma_f32 v[92:93], v[92:93], v[152:153], v[8:9] op_sel_hi:[1,0,1]
    v_pk_mul_f32 v[8:9], v[142:143], v[154:155] op_sel_hi:[1,0]
    v_pk_fma_f32 v[94:95], v[94:95], v[152:153], v[8:9] op_sel_hi:[1,0,1]
    v_pk_mul_f32 v[8:9], v[60:61], v[144:145] op_sel_hi:[1,0]
    v_pk_fma_f32 v[96:97], v[96:97], v[56:57], v[8:9]
    v_pk_mul_f32 v[8:9], v[62:63], v[144:145] op_sel_hi:[1,0]
    v_pk_fma_f32 v[98:99], v[98:99], v[58:59], v[8:9]
    v_pk_mul_f32 v[8:9], v[60:61], v[148:149] op_sel_hi:[1,0]
    v_pk_fma_f32 v[100:101], v[100:101], v[56:57], v[8:9]
    v_pk_mul_f32 v[8:9], v[62:63], v[148:149] op_sel_hi:[1,0]
    v_pk_fma_f32 v[102:103], v[102:103], v[58:59], v[8:9]
    v_pk_mul_f32 v[8:9], v[128:129], v[162:163] op_sel_hi:[1,0]
    v_pk_fma_f32 v[104:105], v[104:105], v[160:161], v[8:9] op_sel_hi:[1,0,1]
    v_pk_mul_f32 v[8:9], v[130:131], v[162:163] op_sel_hi:[1,0]
    v_pk_fma_f32 v[106:107], v[106:107], v[160:161], v[8:9] op_sel_hi:[1,0,1]
    v_pk_mul_f32 v[8:9], v[132:133], v[162:163] op_sel_hi:[1,0]
    v_pk_fma_f32 v[108:109], v[108:109], v[160:161], v[8:9] op_sel_hi:[1,0,1]
    v_pk_mul_f32 v[8:9], v[134:135], v[162:163] op_sel_hi:[1,0]
    v_pk_fma_f32 v[110:111], v[110:111], v[160:161], v[8:9] op_sel_hi:[1,0,1]
    v_pk_mul_f32 v[8:9], v[136:137], v[162:163] op_sel_hi:[1,0]
    v_pk_fma_f32 v[112:113], v[112:113], v[160:161], v[8:9] op_sel_hi:[1,0,1]
    v_pk_mul_f32 v[8:9], v[138:139], v[162:163] op_sel_hi:[1,0]
    v_pk_fma_f32 v[114:115], v[114:115], v[160:161], v[8:9] op_sel_hi:[1,0,1]
    v_pk_mul_f32 v[8:9], v[140:141], v[162:163] op_sel_hi:[1,0]
    v_pk_fma_f32 v[116:117], v[116:117], v[160:161], v[8:9] op_sel_hi:[1,0,1]
    v_pk_mul_f32 v[8:9], v[142:143], v[162:163] op_sel_hi:[1,0]
    v_pk_fma_f32 v[118:119], v[118:119], v[160:161], v[8:9] op_sel_hi:[1,0,1]
    v_pk_mul_f32 v[8:9], v[68:69], v[144:145] op_sel_hi:[1,0]
    v_pk_fma_f32 v[120:121], v[120:121], v[64:65], v[8:9]
    v_pk_mul_f32 v[8:9], v[70:71], v[144:145] op_sel_hi:[1,0]
    v_pk_fma_f32 v[122:123], v[122:123], v[66:67], v[8:9]
    v_pk_mul_f32 v[8:9], v[68:69], v[148:149] op_sel_hi:[1,0]
    v_pk_fma_f32 v[124:125], v[124:125], v[64:65], v[8:9]
    v_pk_mul_f32 v[8:9], v[70:71], v[148:149] op_sel_hi:[1,0]
    v_pk_fma_f32 v[126:127], v[126:127], v[66:67], v[8:9]
    v_cvt_pk_bf16_f32 v32, v80, v81
    v_cvt_pk_bf16_f32 v33, v82, v83
    v_cvt_pk_bf16_f32 v34, v84, v85
    v_cvt_pk_bf16_f32 v35, v86, v87
    s_add_u32 s27, s42, 0
    s_nop 0
    v_permlane16_swap_b32 v32, v34
    v_permlane16_swap_b32 v33, v35
    buffer_store_dwordx4 v[32:35], v14, s[16:19], s27 offen
    v_cvt_pk_bf16_f32 v36, v88, v89
    v_cvt_pk_bf16_f32 v37, v90, v91
    v_cvt_pk_bf16_f32 v38, v92, v93
    v_cvt_pk_bf16_f32 v39, v94, v95
    s_add_u32 s27, s42, 64
    s_nop 0
    v_permlane16_swap_b32 v36, v38
    v_permlane16_swap_b32 v37, v39
    buffer_store_dwordx4 v[36:39], v14, s[16:19], s27 offen
    v_cvt_pk_bf16_f32 v40, v104, v105
    v_cvt_pk_bf16_f32 v41, v106, v107
    v_cvt_pk_bf16_f32 v42, v108, v109
    v_cvt_pk_bf16_f32 v43, v110, v111
    s_add_u32 s27, s42, 32768
    s_nop 0
    v_permlane16_swap_b32 v40, v42
    v_permlane16_swap_b32 v41, v43
    buffer_store_dwordx4 v[40:43], v14, s[16:19], s27 offen
    v_cvt_pk_bf16_f32 v44, v112, v113
    v_cvt_pk_bf16_f32 v45, v114, v115
    v_cvt_pk_bf16_f32 v46, v116, v117
    v_cvt_pk_bf16_f32 v47, v118, v119
    s_add_u32 s27, s42, 32832
    s_nop 0
    v_permlane16_swap_b32 v44, v46
    v_permlane16_swap_b32 v45, v47
    buffer_store_dwordx4 v[44:47], v14, s[16:19], s27 offen
    v_cvt_pk_bf16_f32 v48, v96, v97
    v_cvt_pk_bf16_f32 v49, v98, v99
    v_cvt_pk_bf16_f32 v50, v120, v121
    v_cvt_pk_bf16_f32 v51, v122, v123
    s_add_u32 s27, s43, 0
    s_nop 0
    v_permlane16_swap_b32 v48, v50
    v_permlane16_swap_b32 v49, v51
    buffer_store_dwordx4 v[48:51], v15, s[20:23], s27 offen
    v_cvt_pk_bf16_f32 v52, v100, v101
    v_cvt_pk_bf16_f32 v53, v102, v103
    v_cvt_pk_bf16_f32 v54, v124, v125
    v_cvt_pk_bf16_f32 v55, v126, v127
    s_add_u32 s27, s43, 65536
    s_nop 0
    v_permlane16_swap_b32 v52, v54
    v_permlane16_swap_b32 v53, v55
    buffer_store_dwordx4 v[52:55], v15, s[20:23], s27 offen
    s_endpgm
k1_qkv_kernel_var2:
    s_barrier
    ds_read_b128 v[16:19], v12 offset:0
    ds_read_b128 v[20:23], v12 offset:2048
    ds_read_b64_tr_b16 v[32:33], v10 offset:16384
    ds_read_b64_tr_b16 v[34:35], v10 offset:16640
    ds_read_b64_tr_b16 v[36:37], v11 offset:16384
    ds_read_b64_tr_b16 v[38:39], v11 offset:16640
    ds_read_b64_tr_b16 v[40:41], v10 offset:20480
    ds_read_b64_tr_b16 v[42:43], v10 offset:20736
    s_waitcnt lgkmcnt(6)
    ds_read_b64_tr_b16 v[44:45], v11 offset:20480
    ds_read_b64_tr_b16 v[46:47], v11 offset:20736
    ds_read_b64_tr_b16 v[48:49], v10 offset:24576
    ds_read_b64_tr_b16 v[50:51], v10 offset:24832
    ds_read_b64_tr_b16 v[52:53], v11 offset:24576
    ds_read_b64_tr_b16 v[54:55], v11 offset:24832
    ds_read_b64_tr_b16 v[136:137], v14 offset:16384
    ds_read_b64_tr_b16 v[138:139], v14 offset:16640
    ds_read_b64_tr_b16 v[140:141], v15 offset:16384
    ds_read_b64_tr_b16 v[142:143], v15 offset:16640
    s_waitcnt lgkmcnt(0)
    ds_read_b128 v[24:27], v13 offset:0
    v_mfma_f32_16x16x32_bf16 v[80:83], v[16:19], v[32:35], v[80:83]
    ds_read_b128 v[28:31], v13 offset:2048
    v_mfma_f32_16x16x32_bf16 v[104:107], v[20:23], v[32:35], v[104:107]
    ds_read_b64_tr_b16 v[56:57], v10 offset:18432
    v_mfma_f32_16x16x32_bf16 v[152:155], v[168:171], v[16:19], v[152:155]
    ds_read_b64_tr_b16 v[58:59], v10 offset:18688
    v_mfma_f32_16x16x32_bf16 v[156:159], v[16:19], v[16:19], v[156:159]
    ds_read_b64_tr_b16 v[60:61], v11 offset:18432
    v_mfma_f32_16x16x32_bf16 v[84:87], v[16:19], v[36:39], v[84:87]
    ds_read_b64_tr_b16 v[62:63], v11 offset:18688
    v_mfma_f32_16x16x32_bf16 v[108:111], v[20:23], v[36:39], v[108:111]
    ds_read_b64_tr_b16 v[64:65], v10 offset:22528
    v_mfma_f32_16x16x32_bf16 v[160:163], v[168:171], v[20:23], v[160:163]
    ds_read_b64_tr_b16 v[66:67], v10 offset:22784
    v_mfma_f32_16x16x32_bf16 v[164:167], v[20:23], v[20:23], v[164:167]
    s_waitcnt lgkmcnt(6)
    v_mfma_f32_16x16x32_bf16 v[88:91], v[16:19], v[40:43], v[88:91]
    ds_read_b64_tr_b16 v[68:69], v11 offset:22528
    v_mfma_f32_16x16x32_bf16 v[112:115], v[20:23], v[40:43], v[112:115]
    ds_read_b64_tr_b16 v[70:71], v11 offset:22784
    v_mfma_f32_16x16x32_bf16 v[128:131], v[168:171], v[136:139], v[128:131]
    ds_read_b64_tr_b16 v[72:73], v10 offset:26624
    v_mfma_f32_16x16x32_bf16 v[92:95], v[16:19], v[44:47], v[92:95]
    ds_read_b64_tr_b16 v[74:75], v10 offset:26880
    v_mfma_f32_16x16x32_bf16 v[116:119], v[20:23], v[44:47], v[116:119]
    ds_read_b64_tr_b16 v[76:77], v11 offset:26624
    v_mfma_f32_16x16x32_bf16 v[132:135], v[168:171], v[140:143], v[132:135]
    ds_read_b64_tr_b16 v[78:79], v11 offset:26880
    v_mfma_f32_16x16x32_bf16 v[96:99], v[16:19], v[48:51], v[96:99]
    ds_read_b64_tr_b16 v[144:145], v14 offset:18432
    v_mfma_f32_16x16x32_bf16 v[120:123], v[20:23], v[48:51], v[120:123]
    ds_read_b64_tr_b16 v[146:147], v14 offset:18688
    v_mfma_f32_16x16x32_bf16 v[100:103], v[16:19], v[52:55], v[100:103]
    ds_read_b64_tr_b16 v[148:149], v15 offset:18432
    ds_read_b64_tr_b16 v[150:151], v15 offset:18688
    v_mfma_f32_16x16x32_bf16 v[124:127], v[20:23], v[52:55], v[124:127]
    s_waitcnt lgkmcnt(0)
    s_barrier
    v_add_u32 v10, 28672, v10
    v_add_u32 v11, 28672, v11
    v_add_u32 v12, 28672, v12
    v_add_u32 v13, 28672, v13
    v_add_u32 v14, 28672, v14
    v_add_u32 v15, 28672, v15
    ds_read_b128 v[16:19], v12 offset:0
    v_mfma_f32_16x16x32_bf16 v[80:83], v[24:27], v[56:59], v[80:83]
    ds_read_b128 v[20:23], v12 offset:2048
    v_mfma_f32_16x16x32_bf16 v[104:107], v[28:31], v[56:59], v[104:107]
    ds_read_b64_tr_b16 v[32:33], v10 offset:16384
    v_mfma_f32_16x16x32_bf16 v[152:155], v[168:171], v[24:27], v[152:155]
    ds_read_b64_tr_b16 v[34:35], v10 offset:16640
    v_mfma_f32_16x16x32_bf16 v[156:159], v[24:27], v[24:27], v[156:159]
    ds_read_b64_tr_b16 v[36:37], v11 offset:16384
    v_mfma_f32_16x16x32_bf16 v[84:87], v[24:27], v[60:63], v[84:87]
    ds_read_b64_tr_b16 v[38:39], v11 offset:16640
    v_mfma_f32_16x16x32_bf16 v[108:111], v[28:31], v[60:63], v[108:111]
    ds_read_b64_tr_b16 v[40:41], v10 offset:20480
    v_mfma_f32_16x16x32_bf16 v[160:163], v[168:171], v[28:31], v[160:163]
    ds_read_b64_tr_b16 v[42:43], v10 offset:20736
    v_mfma_f32_16x16x32_bf16 v[164:167], v[28:31], v[28:31], v[164:167]
    s_waitcnt lgkmcnt(6)
    v_mfma_f32_16x16x32_bf16 v[88:91], v[24:27], v[64:67], v[88:91]
    ds_read_b64_tr_b16 v[44:45], v11 offset:20480
    v_mfma_f32_16x16x32_bf16 v[112:115], v[28:31], v[64:67], v[112:115]
    ds_read_b64_tr_b16 v[46:47], v11 offset:20736
    v_mfma_f32_16x16x32_bf16 v[128:131], v[168:171], v[144:147], v[128:131]
    ds_read_b64_tr_b16 v[48:49], v10 offset:24576
    v_mfma_f32_16x16x32_bf16 v[92:95], v[24:27], v[68:71], v[92:95]
    ds_read_b64_tr_b16 v[50:51], v10 offset:24832
    v_mfma_f32_16x16x32_bf16 v[116:119], v[28:31], v[68:71], v[116:119]
    ds_read_b64_tr_b16 v[52:53], v11 offset:24576
    v_mfma_f32_16x16x32_bf16 v[132:135], v[168:171], v[148:151], v[132:135]
    ds_read_b64_tr_b16 v[54:55], v11 offset:24832
    v_mfma_f32_16x16x32_bf16 v[96:99], v[24:27], v[72:75], v[96:99]
    ds_read_b64_tr_b16 v[136:137], v14 offset:16384
    v_mfma_f32_16x16x32_bf16 v[120:123], v[28:31], v[72:75], v[120:123]
    ds_read_b64_tr_b16 v[138:139], v14 offset:16640
    v_mfma_f32_16x16x32_bf16 v[100:103], v[24:27], v[76:79], v[100:103]
    ds_read_b64_tr_b16 v[140:141], v15 offset:16384
    ds_read_b64_tr_b16 v[142:143], v15 offset:16640
    v_mfma_f32_16x16x32_bf16 v[124:127], v[28:31], v[76:79], v[124:127]
    s_waitcnt lgkmcnt(0)
    ds_read_b128 v[24:27], v13 offset:0
    v_mfma_f32_16x16x32_bf16 v[80:83], v[16:19], v[32:35], v[80:83]
    ds_read_b128 v[28:31], v13 offset:2048
    v_mfma_f32_16x16x32_bf16 v[104:107], v[20:23], v[32:35], v[104:107]
    ds_read_b64_tr_b16 v[56:57], v10 offset:18432
    v_mfma_f32_16x16x32_bf16 v[152:155], v[168:171], v[16:19], v[152:155]
    ds_read_b64_tr_b16 v[58:59], v10 offset:18688
    v_mfma_f32_16x16x32_bf16 v[156:159], v[16:19], v[16:19], v[156:159]
    ds_read_b64_tr_b16 v[60:61], v11 offset:18432
    v_mfma_f32_16x16x32_bf16 v[84:87], v[16:19], v[36:39], v[84:87]
    ds_read_b64_tr_b16 v[62:63], v11 offset:18688
    v_mfma_f32_16x16x32_bf16 v[108:111], v[20:23], v[36:39], v[108:111]
    ds_read_b64_tr_b16 v[64:65], v10 offset:22528
    v_mfma_f32_16x16x32_bf16 v[160:163], v[168:171], v[20:23], v[160:163]
    ds_read_b64_tr_b16 v[66:67], v10 offset:22784
    v_mfma_f32_16x16x32_bf16 v[164:167], v[20:23], v[20:23], v[164:167]
    s_waitcnt lgkmcnt(6)
    v_mfma_f32_16x16x32_bf16 v[88:91], v[16:19], v[40:43], v[88:91]
    ds_read_b64_tr_b16 v[68:69], v11 offset:22528
    v_mfma_f32_16x16x32_bf16 v[112:115], v[20:23], v[40:43], v[112:115]
    ds_read_b64_tr_b16 v[70:71], v11 offset:22784
    v_mfma_f32_16x16x32_bf16 v[128:131], v[168:171], v[136:139], v[128:131]
    ds_read_b64_tr_b16 v[72:73], v10 offset:26624
    v_mfma_f32_16x16x32_bf16 v[92:95], v[16:19], v[44:47], v[92:95]
    ds_read_b64_tr_b16 v[74:75], v10 offset:26880
    v_mfma_f32_16x16x32_bf16 v[116:119], v[20:23], v[44:47], v[116:119]
    ds_read_b64_tr_b16 v[76:77], v11 offset:26624
    v_mfma_f32_16x16x32_bf16 v[132:135], v[168:171], v[140:143], v[132:135]
    ds_read_b64_tr_b16 v[78:79], v11 offset:26880
    v_mfma_f32_16x16x32_bf16 v[96:99], v[16:19], v[48:51], v[96:99]
    ds_read_b64_tr_b16 v[144:145], v14 offset:18432
    v_mfma_f32_16x16x32_bf16 v[120:123], v[20:23], v[48:51], v[120:123]
    ds_read_b64_tr_b16 v[146:147], v14 offset:18688
    v_mfma_f32_16x16x32_bf16 v[100:103], v[16:19], v[52:55], v[100:103]
    ds_read_b64_tr_b16 v[148:149], v15 offset:18432
    ds_read_b64_tr_b16 v[150:151], v15 offset:18688
    v_mfma_f32_16x16x32_bf16 v[124:127], v[20:23], v[52:55], v[124:127]
    s_waitcnt lgkmcnt(0)
    s_barrier
    v_add_u32 v10, 28672, v10
    v_add_u32 v11, 28672, v11
    v_add_u32 v12, 28672, v12
    v_add_u32 v13, 28672, v13
    v_add_u32 v14, 28672, v14
    v_add_u32 v15, 28672, v15
    ds_read_b128 v[16:19], v12 offset:0
    v_mfma_f32_16x16x32_bf16 v[80:83], v[24:27], v[56:59], v[80:83]
    ds_read_b128 v[20:23], v12 offset:2048
    v_mfma_f32_16x16x32_bf16 v[104:107], v[28:31], v[56:59], v[104:107]
    ds_read_b64_tr_b16 v[32:33], v10 offset:16384
    v_mfma_f32_16x16x32_bf16 v[152:155], v[168:171], v[24:27], v[152:155]
    ds_read_b64_tr_b16 v[34:35], v10 offset:16640
    v_mfma_f32_16x16x32_bf16 v[156:159], v[24:27], v[24:27], v[156:159]
    ds_read_b64_tr_b16 v[36:37], v11 offset:16384
    v_mfma_f32_16x16x32_bf16 v[84:87], v[24:27], v[60:63], v[84:87]
    ds_read_b64_tr_b16 v[38:39], v11 offset:16640
    v_mfma_f32_16x16x32_bf16 v[108:111], v[28:31], v[60:63], v[108:111]
    ds_read_b64_tr_b16 v[40:41], v10 offset:20480
    v_mfma_f32_16x16x32_bf16 v[160:163], v[168:171], v[28:31], v[160:163]
    ds_read_b64_tr_b16 v[42:43], v10 offset:20736
    v_mfma_f32_16x16x32_bf16 v[164:167], v[28:31], v[28:31], v[164:167]
    s_waitcnt lgkmcnt(6)
    v_mfma_f32_16x16x32_bf16 v[88:91], v[24:27], v[64:67], v[88:91]
    ds_read_b64_tr_b16 v[44:45], v11 offset:20480
    v_mfma_f32_16x16x32_bf16 v[112:115], v[28:31], v[64:67], v[112:115]
    ds_read_b64_tr_b16 v[46:47], v11 offset:20736
    v_mfma_f32_16x16x32_bf16 v[128:131], v[168:171], v[144:147], v[128:131]
    ds_read_b64_tr_b16 v[48:49], v10 offset:24576
    v_mfma_f32_16x16x32_bf16 v[92:95], v[24:27], v[68:71], v[92:95]
    ds_read_b64_tr_b16 v[50:51], v10 offset:24832
    v_mfma_f32_16x16x32_bf16 v[116:119], v[28:31], v[68:71], v[116:119]
    ds_read_b64_tr_b16 v[52:53], v11 offset:24576
    v_mfma_f32_16x16x32_bf16 v[132:135], v[168:171], v[148:151], v[132:135]
    ds_read_b64_tr_b16 v[54:55], v11 offset:24832
    v_mfma_f32_16x16x32_bf16 v[96:99], v[24:27], v[72:75], v[96:99]
    ds_read_b64_tr_b16 v[136:137], v14 offset:16384
    v_mfma_f32_16x16x32_bf16 v[120:123], v[28:31], v[72:75], v[120:123]
    ds_read_b64_tr_b16 v[138:139], v14 offset:16640
    v_mfma_f32_16x16x32_bf16 v[100:103], v[24:27], v[76:79], v[100:103]
    ds_read_b64_tr_b16 v[140:141], v15 offset:16384
    ds_read_b64_tr_b16 v[142:143], v15 offset:16640
    v_mfma_f32_16x16x32_bf16 v[124:127], v[28:31], v[76:79], v[124:127]
    s_waitcnt lgkmcnt(0)
    ds_read_b128 v[24:27], v13 offset:0
    v_mfma_f32_16x16x32_bf16 v[80:83], v[16:19], v[32:35], v[80:83]
    ds_read_b128 v[28:31], v13 offset:2048
    v_mfma_f32_16x16x32_bf16 v[104:107], v[20:23], v[32:35], v[104:107]
    ds_read_b64_tr_b16 v[56:57], v10 offset:18432
    v_mfma_f32_16x16x32_bf16 v[152:155], v[168:171], v[16:19], v[152:155]
    ds_read_b64_tr_b16 v[58:59], v10 offset:18688
    v_mfma_f32_16x16x32_bf16 v[156:159], v[16:19], v[16:19], v[156:159]
    ds_read_b64_tr_b16 v[60:61], v11 offset:18432
    v_mfma_f32_16x16x32_bf16 v[84:87], v[16:19], v[36:39], v[84:87]
    ds_read_b64_tr_b16 v[62:63], v11 offset:18688
    v_mfma_f32_16x16x32_bf16 v[108:111], v[20:23], v[36:39], v[108:111]
    ds_read_b64_tr_b16 v[64:65], v10 offset:22528
    v_mfma_f32_16x16x32_bf16 v[160:163], v[168:171], v[20:23], v[160:163]
    ds_read_b64_tr_b16 v[66:67], v10 offset:22784
    v_mfma_f32_16x16x32_bf16 v[164:167], v[20:23], v[20:23], v[164:167]
    s_waitcnt lgkmcnt(6)
    v_mfma_f32_16x16x32_bf16 v[88:91], v[16:19], v[40:43], v[88:91]
    ds_read_b64_tr_b16 v[68:69], v11 offset:22528
    v_mfma_f32_16x16x32_bf16 v[112:115], v[20:23], v[40:43], v[112:115]
    ds_read_b64_tr_b16 v[70:71], v11 offset:22784
    v_mfma_f32_16x16x32_bf16 v[128:131], v[168:171], v[136:139], v[128:131]
    ds_read_b64_tr_b16 v[72:73], v10 offset:26624
    v_mfma_f32_16x16x32_bf16 v[92:95], v[16:19], v[44:47], v[92:95]
    ds_read_b64_tr_b16 v[74:75], v10 offset:26880
    v_mfma_f32_16x16x32_bf16 v[116:119], v[20:23], v[44:47], v[116:119]
    ds_read_b64_tr_b16 v[76:77], v11 offset:26624
    v_mfma_f32_16x16x32_bf16 v[132:135], v[168:171], v[140:143], v[132:135]
    ds_read_b64_tr_b16 v[78:79], v11 offset:26880
    v_mfma_f32_16x16x32_bf16 v[96:99], v[16:19], v[48:51], v[96:99]
    ds_read_b64_tr_b16 v[144:145], v14 offset:18432
    v_mfma_f32_16x16x32_bf16 v[120:123], v[20:23], v[48:51], v[120:123]
    ds_read_b64_tr_b16 v[146:147], v14 offset:18688
    v_mfma_f32_16x16x32_bf16 v[100:103], v[16:19], v[52:55], v[100:103]
    ds_read_b64_tr_b16 v[148:149], v15 offset:18432
    ds_read_b64_tr_b16 v[150:151], v15 offset:18688
    v_mfma_f32_16x16x32_bf16 v[124:127], v[20:23], v[52:55], v[124:127]
    s_waitcnt lgkmcnt(0)
    s_barrier
    v_add_u32 v10, 28672, v10
    v_add_u32 v11, 28672, v11
    v_add_u32 v12, 28672, v12
    v_add_u32 v13, 28672, v13
    v_add_u32 v14, 28672, v14
    v_add_u32 v15, 28672, v15
    ds_read_b128 v[16:19], v12 offset:0
    v_mfma_f32_16x16x32_bf16 v[80:83], v[24:27], v[56:59], v[80:83]
    ds_read_b128 v[20:23], v12 offset:2048
    v_mfma_f32_16x16x32_bf16 v[104:107], v[28:31], v[56:59], v[104:107]
    ds_read_b64_tr_b16 v[32:33], v10 offset:16384
    v_mfma_f32_16x16x32_bf16 v[152:155], v[168:171], v[24:27], v[152:155]
    ds_read_b64_tr_b16 v[34:35], v10 offset:16640
    v_mfma_f32_16x16x32_bf16 v[156:159], v[24:27], v[24:27], v[156:159]
    ds_read_b64_tr_b16 v[36:37], v11 offset:16384
    v_mfma_f32_16x16x32_bf16 v[84:87], v[24:27], v[60:63], v[84:87]
    ds_read_b64_tr_b16 v[38:39], v11 offset:16640
    v_mfma_f32_16x16x32_bf16 v[108:111], v[28:31], v[60:63], v[108:111]
    ds_read_b64_tr_b16 v[40:41], v10 offset:20480
    v_mfma_f32_16x16x32_bf16 v[160:163], v[168:171], v[28:31], v[160:163]
    ds_read_b64_tr_b16 v[42:43], v10 offset:20736
    v_mfma_f32_16x16x32_bf16 v[164:167], v[28:31], v[28:31], v[164:167]
    s_waitcnt lgkmcnt(6)
    v_mfma_f32_16x16x32_bf16 v[88:91], v[24:27], v[64:67], v[88:91]
    ds_read_b64_tr_b16 v[44:45], v11 offset:20480
    v_mfma_f32_16x16x32_bf16 v[112:115], v[28:31], v[64:67], v[112:115]
    ds_read_b64_tr_b16 v[46:47], v11 offset:20736
    v_mfma_f32_16x16x32_bf16 v[128:131], v[168:171], v[144:147], v[128:131]
    ds_read_b64_tr_b16 v[48:49], v10 offset:24576
    v_mfma_f32_16x16x32_bf16 v[92:95], v[24:27], v[68:71], v[92:95]
    ds_read_b64_tr_b16 v[50:51], v10 offset:24832
    v_mfma_f32_16x16x32_bf16 v[116:119], v[28:31], v[68:71], v[116:119]
    ds_read_b64_tr_b16 v[52:53], v11 offset:24576
    v_mfma_f32_16x16x32_bf16 v[132:135], v[168:171], v[148:151], v[132:135]
    ds_read_b64_tr_b16 v[54:55], v11 offset:24832
    v_mfma_f32_16x16x32_bf16 v[96:99], v[24:27], v[72:75], v[96:99]
    ds_read_b64_tr_b16 v[136:137], v14 offset:16384
    v_mfma_f32_16x16x32_bf16 v[120:123], v[28:31], v[72:75], v[120:123]
    ds_read_b64_tr_b16 v[138:139], v14 offset:16640
    v_mfma_f32_16x16x32_bf16 v[100:103], v[24:27], v[76:79], v[100:103]
    ds_read_b64_tr_b16 v[140:141], v15 offset:16384
    ds_read_b64_tr_b16 v[142:143], v15 offset:16640
    v_mfma_f32_16x16x32_bf16 v[124:127], v[28:31], v[76:79], v[124:127]
    s_waitcnt lgkmcnt(0)
    ds_read_b128 v[24:27], v13 offset:0
    v_mfma_f32_16x16x32_bf16 v[80:83], v[16:19], v[32:35], v[80:83]
    ds_read_b128 v[28:31], v13 offset:2048
    v_mfma_f32_16x16x32_bf16 v[104:107], v[20:23], v[32:35], v[104:107]
    ds_read_b64_tr_b16 v[56:57], v10 offset:18432
    v_mfma_f32_16x16x32_bf16 v[152:155], v[168:171], v[16:19], v[152:155]
    ds_read_b64_tr_b16 v[58:59], v10 offset:18688
    v_mfma_f32_16x16x32_bf16 v[156:159], v[16:19], v[16:19], v[156:159]
    ds_read_b64_tr_b16 v[60:61], v11 offset:18432
    v_mfma_f32_16x16x32_bf16 v[84:87], v[16:19], v[36:39], v[84:87]
    ds_read_b64_tr_b16 v[62:63], v11 offset:18688
    v_mfma_f32_16x16x32_bf16 v[108:111], v[20:23], v[36:39], v[108:111]
    ds_read_b64_tr_b16 v[64:65], v10 offset:22528
    v_mfma_f32_16x16x32_bf16 v[160:163], v[168:171], v[20:23], v[160:163]
    ds_read_b64_tr_b16 v[66:67], v10 offset:22784
    v_mfma_f32_16x16x32_bf16 v[164:167], v[20:23], v[20:23], v[164:167]
    s_waitcnt lgkmcnt(6)
    v_mfma_f32_16x16x32_bf16 v[88:91], v[16:19], v[40:43], v[88:91]
    ds_read_b64_tr_b16 v[68:69], v11 offset:22528
    v_mfma_f32_16x16x32_bf16 v[112:115], v[20:23], v[40:43], v[112:115]
    ds_read_b64_tr_b16 v[70:71], v11 offset:22784
    v_mfma_f32_16x16x32_bf16 v[128:131], v[168:171], v[136:139], v[128:131]
    ds_read_b64_tr_b16 v[72:73], v10 offset:26624
    v_mfma_f32_16x16x32_bf16 v[92:95], v[16:19], v[44:47], v[92:95]
    ds_read_b64_tr_b16 v[74:75], v10 offset:26880
    v_mfma_f32_16x16x32_bf16 v[116:119], v[20:23], v[44:47], v[116:119]
    ds_read_b64_tr_b16 v[76:77], v11 offset:26624
    v_mfma_f32_16x16x32_bf16 v[132:135], v[168:171], v[140:143], v[132:135]
    ds_read_b64_tr_b16 v[78:79], v11 offset:26880
    v_mfma_f32_16x16x32_bf16 v[96:99], v[16:19], v[48:51], v[96:99]
    ds_read_b64_tr_b16 v[144:145], v14 offset:18432
    v_mfma_f32_16x16x32_bf16 v[120:123], v[20:23], v[48:51], v[120:123]
    ds_read_b64_tr_b16 v[146:147], v14 offset:18688
    v_mfma_f32_16x16x32_bf16 v[100:103], v[16:19], v[52:55], v[100:103]
    ds_read_b64_tr_b16 v[148:149], v15 offset:18432
    ds_read_b64_tr_b16 v[150:151], v15 offset:18688
    v_mfma_f32_16x16x32_bf16 v[124:127], v[20:23], v[52:55], v[124:127]
    s_waitcnt lgkmcnt(0)
    s_barrier
    v_add_u32 v10, 28672, v10
    v_add_u32 v11, 28672, v11
    v_add_u32 v12, 28672, v12
    v_add_u32 v13, 28672, v13
    v_add_u32 v14, 28672, v14
    v_add_u32 v15, 28672, v15
    ds_read_b128 v[16:19], v12 offset:0
    v_mfma_f32_16x16x32_bf16 v[80:83], v[24:27], v[56:59], v[80:83]
    ds_read_b128 v[20:23], v12 offset:2048
    v_mfma_f32_16x16x32_bf16 v[104:107], v[28:31], v[56:59], v[104:107]
    ds_read_b64_tr_b16 v[32:33], v10 offset:16384
    v_mfma_f32_16x16x32_bf16 v[152:155], v[168:171], v[24:27], v[152:155]
    ds_read_b64_tr_b16 v[34:35], v10 offset:16640
    v_mfma_f32_16x16x32_bf16 v[156:159], v[24:27], v[24:27], v[156:159]
    ds_read_b64_tr_b16 v[36:37], v11 offset:16384
    v_mfma_f32_16x16x32_bf16 v[84:87], v[24:27], v[60:63], v[84:87]
    ds_read_b64_tr_b16 v[38:39], v11 offset:16640
    v_mfma_f32_16x16x32_bf16 v[108:111], v[28:31], v[60:63], v[108:111]
    ds_read_b64_tr_b16 v[40:41], v10 offset:20480
    v_mfma_f32_16x16x32_bf16 v[160:163], v[168:171], v[28:31], v[160:163]
    ds_read_b64_tr_b16 v[42:43], v10 offset:20736
    v_mfma_f32_16x16x32_bf16 v[164:167], v[28:31], v[28:31], v[164:167]
    s_waitcnt lgkmcnt(6)
    v_mfma_f32_16x16x32_bf16 v[88:91], v[24:27], v[64:67], v[88:91]
    ds_read_b64_tr_b16 v[44:45], v11 offset:20480
    v_mfma_f32_16x16x32_bf16 v[112:115], v[28:31], v[64:67], v[112:115]
    ds_read_b64_tr_b16 v[46:47], v11 offset:20736
    v_mfma_f32_16x16x32_bf16 v[128:131], v[168:171], v[144:147], v[128:131]
    ds_read_b64_tr_b16 v[48:49], v10 offset:24576
    v_mfma_f32_16x16x32_bf16 v[92:95], v[24:27], v[68:71], v[92:95]
    ds_read_b64_tr_b16 v[50:51], v10 offset:24832
    v_mfma_f32_16x16x32_bf16 v[116:119], v[28:31], v[68:71], v[116:119]
    ds_read_b64_tr_b16 v[52:53], v11 offset:24576
    v_mfma_f32_16x16x32_bf16 v[132:135], v[168:171], v[148:151], v[132:135]
    ds_read_b64_tr_b16 v[54:55], v11 offset:24832
    v_mfma_f32_16x16x32_bf16 v[96:99], v[24:27], v[72:75], v[96:99]
    ds_read_b64_tr_b16 v[136:137], v14 offset:16384
    v_mfma_f32_16x16x32_bf16 v[120:123], v[28:31], v[72:75], v[120:123]
    ds_read_b64_tr_b16 v[138:139], v14 offset:16640
    v_mfma_f32_16x16x32_bf16 v[100:103], v[24:27], v[76:79], v[100:103]
    ds_read_b64_tr_b16 v[140:141], v15 offset:16384
    ds_read_b64_tr_b16 v[142:143], v15 offset:16640
    v_mfma_f32_16x16x32_bf16 v[124:127], v[28:31], v[76:79], v[124:127]
    s_waitcnt lgkmcnt(0)
    ds_read_b128 v[24:27], v13 offset:0
    v_mfma_f32_16x16x32_bf16 v[80:83], v[16:19], v[32:35], v[80:83]
    ds_read_b128 v[28:31], v13 offset:2048
    v_mfma_f32_16x16x32_bf16 v[104:107], v[20:23], v[32:35], v[104:107]
    ds_read_b64_tr_b16 v[56:57], v10 offset:18432
    v_mfma_f32_16x16x32_bf16 v[152:155], v[168:171], v[16:19], v[152:155]
    ds_read_b64_tr_b16 v[58:59], v10 offset:18688
    v_mfma_f32_16x16x32_bf16 v[156:159], v[16:19], v[16:19], v[156:159]
    ds_read_b64_tr_b16 v[60:61], v11 offset:18432
    v_mfma_f32_16x16x32_bf16 v[84:87], v[16:19], v[36:39], v[84:87]
    ds_read_b64_tr_b16 v[62:63], v11 offset:18688
    v_mfma_f32_16x16x32_bf16 v[108:111], v[20:23], v[36:39], v[108:111]
    ds_read_b64_tr_b16 v[64:65], v10 offset:22528
    v_mfma_f32_16x16x32_bf16 v[160:163], v[168:171], v[20:23], v[160:163]
    ds_read_b64_tr_b16 v[66:67], v10 offset:22784
    v_mfma_f32_16x16x32_bf16 v[164:167], v[20:23], v[20:23], v[164:167]
    s_waitcnt lgkmcnt(6)
    v_mfma_f32_16x16x32_bf16 v[88:91], v[16:19], v[40:43], v[88:91]
    ds_read_b64_tr_b16 v[68:69], v11 offset:22528
    v_mfma_f32_16x16x32_bf16 v[112:115], v[20:23], v[40:43], v[112:115]
    ds_read_b64_tr_b16 v[70:71], v11 offset:22784
    v_mfma_f32_16x16x32_bf16 v[128:131], v[168:171], v[136:139], v[128:131]
    ds_read_b64_tr_b16 v[72:73], v10 offset:26624
    v_mfma_f32_16x16x32_bf16 v[92:95], v[16:19], v[44:47], v[92:95]
    ds_read_b64_tr_b16 v[74:75], v10 offset:26880
    v_mfma_f32_16x16x32_bf16 v[116:119], v[20:23], v[44:47], v[116:119]
    ds_read_b64_tr_b16 v[76:77], v11 offset:26624
    v_mfma_f32_16x16x32_bf16 v[132:135], v[168:171], v[140:143], v[132:135]
    ds_read_b64_tr_b16 v[78:79], v11 offset:26880
    v_mfma_f32_16x16x32_bf16 v[96:99], v[16:19], v[48:51], v[96:99]
    ds_read_b64_tr_b16 v[144:145], v14 offset:18432
    v_mfma_f32_16x16x32_bf16 v[120:123], v[20:23], v[48:51], v[120:123]
    ds_read_b64_tr_b16 v[146:147], v14 offset:18688
    v_mfma_f32_16x16x32_bf16 v[100:103], v[16:19], v[52:55], v[100:103]
    ds_read_b64_tr_b16 v[148:149], v15 offset:18432
    ds_read_b64_tr_b16 v[150:151], v15 offset:18688
    v_mfma_f32_16x16x32_bf16 v[124:127], v[20:23], v[52:55], v[124:127]
    s_waitcnt lgkmcnt(0)
    s_barrier
    v_add_u32 v10, 4294852608, v10
    v_add_u32 v11, 4294852608, v11
    v_add_u32 v12, 4294852608, v12
    v_add_u32 v13, 4294852608, v13
    v_add_u32 v14, 4294852608, v14
    v_add_u32 v15, 4294852608, v15
    ds_read_b128 v[16:19], v12 offset:0
    v_mfma_f32_16x16x32_bf16 v[80:83], v[24:27], v[56:59], v[80:83]
    ds_read_b128 v[20:23], v12 offset:2048
    v_mfma_f32_16x16x32_bf16 v[104:107], v[28:31], v[56:59], v[104:107]
    ds_read_b64_tr_b16 v[32:33], v10 offset:16384
    v_mfma_f32_16x16x32_bf16 v[152:155], v[168:171], v[24:27], v[152:155]
    ds_read_b64_tr_b16 v[34:35], v10 offset:16640
    v_mfma_f32_16x16x32_bf16 v[156:159], v[24:27], v[24:27], v[156:159]
    ds_read_b64_tr_b16 v[36:37], v11 offset:16384
    v_mfma_f32_16x16x32_bf16 v[84:87], v[24:27], v[60:63], v[84:87]
    ds_read_b64_tr_b16 v[38:39], v11 offset:16640
    v_mfma_f32_16x16x32_bf16 v[108:111], v[28:31], v[60:63], v[108:111]
    ds_read_b64_tr_b16 v[40:41], v10 offset:20480
    v_mfma_f32_16x16x32_bf16 v[160:163], v[168:171], v[28:31], v[160:163]
    ds_read_b64_tr_b16 v[42:43], v10 offset:20736
    v_mfma_f32_16x16x32_bf16 v[164:167], v[28:31], v[28:31], v[164:167]
    s_waitcnt lgkmcnt(6)
    v_mfma_f32_16x16x32_bf16 v[88:91], v[24:27], v[64:67], v[88:91]
    ds_read_b64_tr_b16 v[44:45], v11 offset:20480
    v_mfma_f32_16x16x32_bf16 v[112:115], v[28:31], v[64:67], v[112:115]
    ds_read_b64_tr_b16 v[46:47], v11 offset:20736
    v_mfma_f32_16x16x32_bf16 v[128:131], v[168:171], v[144:147], v[128:131]
    ds_read_b64_tr_b16 v[48:49], v10 offset:24576
    v_mfma_f32_16x16x32_bf16 v[92:95], v[24:27], v[68:71], v[92:95]
    ds_read_b64_tr_b16 v[50:51], v10 offset:24832
    v_mfma_f32_16x16x32_bf16 v[116:119], v[28:31], v[68:71], v[116:119]
    ds_read_b64_tr_b16 v[52:53], v11 offset:24576
    v_mfma_f32_16x16x32_bf16 v[132:135], v[168:171], v[148:151], v[132:135]
    ds_read_b64_tr_b16 v[54:55], v11 offset:24832
    v_mfma_f32_16x16x32_bf16 v[96:99], v[24:27], v[72:75], v[96:99]
    ds_read_b64_tr_b16 v[136:137], v14 offset:16384
    v_mfma_f32_16x16x32_bf16 v[120:123], v[28:31], v[72:75], v[120:123]
    ds_read_b64_tr_b16 v[138:139], v14 offset:16640
    v_mfma_f32_16x16x32_bf16 v[100:103], v[24:27], v[76:79], v[100:103]
    ds_read_b64_tr_b16 v[140:141], v15 offset:16384
    ds_read_b64_tr_b16 v[142:143], v15 offset:16640
    v_mfma_f32_16x16x32_bf16 v[124:127], v[28:31], v[76:79], v[124:127]
    s_waitcnt lgkmcnt(0)
    ds_read_b128 v[24:27], v13 offset:0
    v_mfma_f32_16x16x32_bf16 v[80:83], v[16:19], v[32:35], v[80:83]
    ds_read_b128 v[28:31], v13 offset:2048
    v_mfma_f32_16x16x32_bf16 v[104:107], v[20:23], v[32:35], v[104:107]
    ds_read_b64_tr_b16 v[56:57], v10 offset:18432
    v_mfma_f32_16x16x32_bf16 v[152:155], v[168:171], v[16:19], v[152:155]
    ds_read_b64_tr_b16 v[58:59], v10 offset:18688
    v_mfma_f32_16x16x32_bf16 v[156:159], v[16:19], v[16:19], v[156:159]
    ds_read_b64_tr_b16 v[60:61], v11 offset:18432
    v_mfma_f32_16x16x32_bf16 v[84:87], v[16:19], v[36:39], v[84:87]
    ds_read_b64_tr_b16 v[62:63], v11 offset:18688
    v_mfma_f32_16x16x32_bf16 v[108:111], v[20:23], v[36:39], v[108:111]
    ds_read_b64_tr_b16 v[64:65], v10 offset:22528
    v_mfma_f32_16x16x32_bf16 v[160:163], v[168:171], v[20:23], v[160:163]
    ds_read_b64_tr_b16 v[66:67], v10 offset:22784
    v_mfma_f32_16x16x32_bf16 v[164:167], v[20:23], v[20:23], v[164:167]
    s_waitcnt lgkmcnt(6)
    v_mfma_f32_16x16x32_bf16 v[88:91], v[16:19], v[40:43], v[88:91]
    ds_read_b64_tr_b16 v[68:69], v11 offset:22528
    v_mfma_f32_16x16x32_bf16 v[112:115], v[20:23], v[40:43], v[112:115]
    ds_read_b64_tr_b16 v[70:71], v11 offset:22784
    v_mfma_f32_16x16x32_bf16 v[128:131], v[168:171], v[136:139], v[128:131]
    ds_read_b64_tr_b16 v[72:73], v10 offset:26624
    v_mfma_f32_16x16x32_bf16 v[92:95], v[16:19], v[44:47], v[92:95]
    ds_read_b64_tr_b16 v[74:75], v10 offset:26880
    v_mfma_f32_16x16x32_bf16 v[116:119], v[20:23], v[44:47], v[116:119]
    ds_read_b64_tr_b16 v[76:77], v11 offset:26624
    v_mfma_f32_16x16x32_bf16 v[132:135], v[168:171], v[140:143], v[132:135]
    ds_read_b64_tr_b16 v[78:79], v11 offset:26880
    v_mfma_f32_16x16x32_bf16 v[96:99], v[16:19], v[48:51], v[96:99]
    ds_read_b64_tr_b16 v[144:145], v14 offset:18432
    v_mfma_f32_16x16x32_bf16 v[120:123], v[20:23], v[48:51], v[120:123]
    ds_read_b64_tr_b16 v[146:147], v14 offset:18688
    v_mfma_f32_16x16x32_bf16 v[100:103], v[16:19], v[52:55], v[100:103]
    ds_read_b64_tr_b16 v[148:149], v15 offset:18432
    ds_read_b64_tr_b16 v[150:151], v15 offset:18688
    v_mfma_f32_16x16x32_bf16 v[124:127], v[20:23], v[52:55], v[124:127]
    s_waitcnt lgkmcnt(0)
    s_barrier
    v_add_u32 v10, 28672, v10
    v_add_u32 v11, 28672, v11
    v_add_u32 v12, 28672, v12
    v_add_u32 v13, 28672, v13
    v_add_u32 v14, 28672, v14
    v_add_u32 v15, 28672, v15
    ds_read_b128 v[16:19], v12 offset:0
    v_mfma_f32_16x16x32_bf16 v[80:83], v[24:27], v[56:59], v[80:83]
    ds_read_b128 v[20:23], v12 offset:2048
    v_mfma_f32_16x16x32_bf16 v[104:107], v[28:31], v[56:59], v[104:107]
    ds_read_b64_tr_b16 v[32:33], v10 offset:16384
    v_mfma_f32_16x16x32_bf16 v[152:155], v[168:171], v[24:27], v[152:155]
    ds_read_b64_tr_b16 v[34:35], v10 offset:16640
    v_mfma_f32_16x16x32_bf16 v[156:159], v[24:27], v[24:27], v[156:159]
    ds_read_b64_tr_b16 v[36:37], v11 offset:16384
    v_mfma_f32_16x16x32_bf16 v[84:87], v[24:27], v[60:63], v[84:87]
    ds_read_b64_tr_b16 v[38:39], v11 offset:16640
    v_mfma_f32_16x16x32_bf16 v[108:111], v[28:31], v[60:63], v[108:111]
    ds_read_b64_tr_b16 v[40:41], v10 offset:20480
    v_mfma_f32_16x16x32_bf16 v[160:163], v[168:171], v[28:31], v[160:163]
    ds_read_b64_tr_b16 v[42:43], v10 offset:20736
    v_mfma_f32_16x16x32_bf16 v[164:167], v[28:31], v[28:31], v[164:167]
    s_waitcnt lgkmcnt(6)
    v_mfma_f32_16x16x32_bf16 v[88:91], v[24:27], v[64:67], v[88:91]
    ds_read_b64_tr_b16 v[44:45], v11 offset:20480
    v_mfma_f32_16x16x32_bf16 v[112:115], v[28:31], v[64:67], v[112:115]
    ds_read_b64_tr_b16 v[46:47], v11 offset:20736
    v_mfma_f32_16x16x32_bf16 v[128:131], v[168:171], v[144:147], v[128:131]
    ds_read_b64_tr_b16 v[48:49], v10 offset:24576
    v_mfma_f32_16x16x32_bf16 v[92:95], v[24:27], v[68:71], v[92:95]
    ds_read_b64_tr_b16 v[50:51], v10 offset:24832
    v_mfma_f32_16x16x32_bf16 v[116:119], v[28:31], v[68:71], v[116:119]
    ds_read_b64_tr_b16 v[52:53], v11 offset:24576
    v_mfma_f32_16x16x32_bf16 v[132:135], v[168:171], v[148:151], v[132:135]
    ds_read_b64_tr_b16 v[54:55], v11 offset:24832
    v_mfma_f32_16x16x32_bf16 v[96:99], v[24:27], v[72:75], v[96:99]
    ds_read_b64_tr_b16 v[136:137], v14 offset:16384
    v_mfma_f32_16x16x32_bf16 v[120:123], v[28:31], v[72:75], v[120:123]
    ds_read_b64_tr_b16 v[138:139], v14 offset:16640
    v_mfma_f32_16x16x32_bf16 v[100:103], v[24:27], v[76:79], v[100:103]
    ds_read_b64_tr_b16 v[140:141], v15 offset:16384
    ds_read_b64_tr_b16 v[142:143], v15 offset:16640
    v_mfma_f32_16x16x32_bf16 v[124:127], v[28:31], v[76:79], v[124:127]
    s_waitcnt lgkmcnt(0)
    ds_read_b128 v[24:27], v13 offset:0
    v_mfma_f32_16x16x32_bf16 v[80:83], v[16:19], v[32:35], v[80:83]
    ds_read_b128 v[28:31], v13 offset:2048
    v_mfma_f32_16x16x32_bf16 v[104:107], v[20:23], v[32:35], v[104:107]
    ds_read_b64_tr_b16 v[56:57], v10 offset:18432
    v_mfma_f32_16x16x32_bf16 v[152:155], v[168:171], v[16:19], v[152:155]
    ds_read_b64_tr_b16 v[58:59], v10 offset:18688
    v_mfma_f32_16x16x32_bf16 v[156:159], v[16:19], v[16:19], v[156:159]
    ds_read_b64_tr_b16 v[60:61], v11 offset:18432
    v_mfma_f32_16x16x32_bf16 v[84:87], v[16:19], v[36:39], v[84:87]
    ds_read_b64_tr_b16 v[62:63], v11 offset:18688
    v_mfma_f32_16x16x32_bf16 v[108:111], v[20:23], v[36:39], v[108:111]
    ds_read_b64_tr_b16 v[64:65], v10 offset:22528
    v_mfma_f32_16x16x32_bf16 v[160:163], v[168:171], v[20:23], v[160:163]
    ds_read_b64_tr_b16 v[66:67], v10 offset:22784
    v_mfma_f32_16x16x32_bf16 v[164:167], v[20:23], v[20:23], v[164:167]
    s_waitcnt lgkmcnt(6)
    v_mfma_f32_16x16x32_bf16 v[88:91], v[16:19], v[40:43], v[88:91]
    ds_read_b64_tr_b16 v[68:69], v11 offset:22528
    v_mfma_f32_16x16x32_bf16 v[112:115], v[20:23], v[40:43], v[112:115]
    ds_read_b64_tr_b16 v[70:71], v11 offset:22784
    v_mfma_f32_16x16x32_bf16 v[128:131], v[168:171], v[136:139], v[128:131]
    ds_read_b64_tr_b16 v[72:73], v10 offset:26624
    v_mfma_f32_16x16x32_bf16 v[92:95], v[16:19], v[44:47], v[92:95]
    ds_read_b64_tr_b16 v[74:75], v10 offset:26880
    v_mfma_f32_16x16x32_bf16 v[116:119], v[20:23], v[44:47], v[116:119]
    ds_read_b64_tr_b16 v[76:77], v11 offset:26624
    v_mfma_f32_16x16x32_bf16 v[132:135], v[168:171], v[140:143], v[132:135]
    ds_read_b64_tr_b16 v[78:79], v11 offset:26880
    v_mfma_f32_16x16x32_bf16 v[96:99], v[16:19], v[48:51], v[96:99]
    ds_read_b64_tr_b16 v[144:145], v14 offset:18432
    v_mfma_f32_16x16x32_bf16 v[120:123], v[20:23], v[48:51], v[120:123]
    ds_read_b64_tr_b16 v[146:147], v14 offset:18688
    v_mfma_f32_16x16x32_bf16 v[100:103], v[16:19], v[52:55], v[100:103]
    ds_read_b64_tr_b16 v[148:149], v15 offset:18432
    ds_read_b64_tr_b16 v[150:151], v15 offset:18688
    v_mfma_f32_16x16x32_bf16 v[124:127], v[20:23], v[52:55], v[124:127]
    s_waitcnt lgkmcnt(0)
    s_barrier
    v_add_u32 v10, 28672, v10
    v_add_u32 v11, 28672, v11
    v_add_u32 v12, 28672, v12
    v_add_u32 v13, 28672, v13
    v_add_u32 v14, 28672, v14
    v_add_u32 v15, 28672, v15
    ds_read_b128 v[16:19], v12 offset:0
    v_mfma_f32_16x16x32_bf16 v[80:83], v[24:27], v[56:59], v[80:83]
    ds_read_b128 v[20:23], v12 offset:2048
    v_mfma_f32_16x16x32_bf16 v[104:107], v[28:31], v[56:59], v[104:107]
    ds_read_b64_tr_b16 v[32:33], v10 offset:16384
    v_mfma_f32_16x16x32_bf16 v[152:155], v[168:171], v[24:27], v[152:155]
    ds_read_b64_tr_b16 v[34:35], v10 offset:16640
    v_mfma_f32_16x16x32_bf16 v[156:159], v[24:27], v[24:27], v[156:159]
    ds_read_b64_tr_b16 v[36:37], v11 offset:16384
    v_mfma_f32_16x16x32_bf16 v[84:87], v[24:27], v[60:63], v[84:87]
    ds_read_b64_tr_b16 v[38:39], v11 offset:16640
    v_mfma_f32_16x16x32_bf16 v[108:111], v[28:31], v[60:63], v[108:111]
    ds_read_b64_tr_b16 v[40:41], v10 offset:20480
    v_mfma_f32_16x16x32_bf16 v[160:163], v[168:171], v[28:31], v[160:163]
    ds_read_b64_tr_b16 v[42:43], v10 offset:20736
    v_mfma_f32_16x16x32_bf16 v[164:167], v[28:31], v[28:31], v[164:167]
    s_waitcnt lgkmcnt(6)
    v_mfma_f32_16x16x32_bf16 v[88:91], v[24:27], v[64:67], v[88:91]
    ds_read_b64_tr_b16 v[44:45], v11 offset:20480
    v_mfma_f32_16x16x32_bf16 v[112:115], v[28:31], v[64:67], v[112:115]
    ds_read_b64_tr_b16 v[46:47], v11 offset:20736
    v_mfma_f32_16x16x32_bf16 v[128:131], v[168:171], v[144:147], v[128:131]
    ds_read_b64_tr_b16 v[48:49], v10 offset:24576
    v_mfma_f32_16x16x32_bf16 v[92:95], v[24:27], v[68:71], v[92:95]
    ds_read_b64_tr_b16 v[50:51], v10 offset:24832
    v_mfma_f32_16x16x32_bf16 v[116:119], v[28:31], v[68:71], v[116:119]
    ds_read_b64_tr_b16 v[52:53], v11 offset:24576
    v_mfma_f32_16x16x32_bf16 v[132:135], v[168:171], v[148:151], v[132:135]
    ds_read_b64_tr_b16 v[54:55], v11 offset:24832
    v_mfma_f32_16x16x32_bf16 v[96:99], v[24:27], v[72:75], v[96:99]
    ds_read_b64_tr_b16 v[136:137], v14 offset:16384
    v_mfma_f32_16x16x32_bf16 v[120:123], v[28:31], v[72:75], v[120:123]
    ds_read_b64_tr_b16 v[138:139], v14 offset:16640
    v_mfma_f32_16x16x32_bf16 v[100:103], v[24:27], v[76:79], v[100:103]
    ds_read_b64_tr_b16 v[140:141], v15 offset:16384
    ds_read_b64_tr_b16 v[142:143], v15 offset:16640
    v_mfma_f32_16x16x32_bf16 v[124:127], v[28:31], v[76:79], v[124:127]
    s_waitcnt lgkmcnt(0)
    ds_read_b128 v[24:27], v13 offset:0
    v_mfma_f32_16x16x32_bf16 v[80:83], v[16:19], v[32:35], v[80:83]
    ds_read_b128 v[28:31], v13 offset:2048
    v_mfma_f32_16x16x32_bf16 v[104:107], v[20:23], v[32:35], v[104:107]
    ds_read_b64_tr_b16 v[56:57], v10 offset:18432
    v_mfma_f32_16x16x32_bf16 v[152:155], v[168:171], v[16:19], v[152:155]
    ds_read_b64_tr_b16 v[58:59], v10 offset:18688
    v_mfma_f32_16x16x32_bf16 v[156:159], v[16:19], v[16:19], v[156:159]
    ds_read_b64_tr_b16 v[60:61], v11 offset:18432
    v_mfma_f32_16x16x32_bf16 v[84:87], v[16:19], v[36:39], v[84:87]
    ds_read_b64_tr_b16 v[62:63], v11 offset:18688
    v_mfma_f32_16x16x32_bf16 v[108:111], v[20:23], v[36:39], v[108:111]
    ds_read_b64_tr_b16 v[64:65], v10 offset:22528
    v_mfma_f32_16x16x32_bf16 v[160:163], v[168:171], v[20:23], v[160:163]
    ds_read_b64_tr_b16 v[66:67], v10 offset:22784
    v_mfma_f32_16x16x32_bf16 v[164:167], v[20:23], v[20:23], v[164:167]
    s_waitcnt lgkmcnt(6)
    v_mfma_f32_16x16x32_bf16 v[88:91], v[16:19], v[40:43], v[88:91]
    ds_read_b64_tr_b16 v[68:69], v11 offset:22528
    v_mfma_f32_16x16x32_bf16 v[112:115], v[20:23], v[40:43], v[112:115]
    ds_read_b64_tr_b16 v[70:71], v11 offset:22784
    v_mfma_f32_16x16x32_bf16 v[128:131], v[168:171], v[136:139], v[128:131]
    ds_read_b64_tr_b16 v[72:73], v10 offset:26624
    v_mfma_f32_16x16x32_bf16 v[92:95], v[16:19], v[44:47], v[92:95]
    ds_read_b64_tr_b16 v[74:75], v10 offset:26880
    v_mfma_f32_16x16x32_bf16 v[116:119], v[20:23], v[44:47], v[116:119]
    ds_read_b64_tr_b16 v[76:77], v11 offset:26624
    v_mfma_f32_16x16x32_bf16 v[132:135], v[168:171], v[140:143], v[132:135]
    ds_read_b64_tr_b16 v[78:79], v11 offset:26880
    v_mfma_f32_16x16x32_bf16 v[96:99], v[16:19], v[48:51], v[96:99]
    ds_read_b64_tr_b16 v[144:145], v14 offset:18432
    v_mfma_f32_16x16x32_bf16 v[120:123], v[20:23], v[48:51], v[120:123]
    ds_read_b64_tr_b16 v[146:147], v14 offset:18688
    v_mfma_f32_16x16x32_bf16 v[100:103], v[16:19], v[52:55], v[100:103]
    ds_read_b64_tr_b16 v[148:149], v15 offset:18432
    ds_read_b64_tr_b16 v[150:151], v15 offset:18688
    v_mfma_f32_16x16x32_bf16 v[124:127], v[20:23], v[52:55], v[124:127]
    s_waitcnt lgkmcnt(0)
    s_barrier
    v_add_u32 v10, 28672, v10
    v_add_u32 v11, 28672, v11
    v_add_u32 v12, 28672, v12
    v_add_u32 v13, 28672, v13
    v_add_u32 v14, 28672, v14
    v_add_u32 v15, 28672, v15
    ds_read_b128 v[16:19], v12 offset:0
    v_mfma_f32_16x16x32_bf16 v[80:83], v[24:27], v[56:59], v[80:83]
    ds_read_b128 v[20:23], v12 offset:2048
    v_mfma_f32_16x16x32_bf16 v[104:107], v[28:31], v[56:59], v[104:107]
    ds_read_b64_tr_b16 v[32:33], v10 offset:16384
    v_mfma_f32_16x16x32_bf16 v[152:155], v[168:171], v[24:27], v[152:155]
    ds_read_b64_tr_b16 v[34:35], v10 offset:16640
    v_mfma_f32_16x16x32_bf16 v[156:159], v[24:27], v[24:27], v[156:159]
    ds_read_b64_tr_b16 v[36:37], v11 offset:16384
    v_mfma_f32_16x16x32_bf16 v[84:87], v[24:27], v[60:63], v[84:87]
    ds_read_b64_tr_b16 v[38:39], v11 offset:16640
    v_mfma_f32_16x16x32_bf16 v[108:111], v[28:31], v[60:63], v[108:111]
    ds_read_b64_tr_b16 v[40:41], v10 offset:20480
    v_mfma_f32_16x16x32_bf16 v[160:163], v[168:171], v[28:31], v[160:163]
    ds_read_b64_tr_b16 v[42:43], v10 offset:20736
    v_mfma_f32_16x16x32_bf16 v[164:167], v[28:31], v[28:31], v[164:167]
    s_waitcnt lgkmcnt(6)
    v_mfma_f32_16x16x32_bf16 v[88:91], v[24:27], v[64:67], v[88:91]
    ds_read_b64_tr_b16 v[44:45], v11 offset:20480
    v_mfma_f32_16x16x32_bf16 v[112:115], v[28:31], v[64:67], v[112:115]
    ds_read_b64_tr_b16 v[46:47], v11 offset:20736
    v_mfma_f32_16x16x32_bf16 v[128:131], v[168:171], v[144:147], v[128:131]
    ds_read_b64_tr_b16 v[48:49], v10 offset:24576
    v_mfma_f32_16x16x32_bf16 v[92:95], v[24:27], v[68:71], v[92:95]
    ds_read_b64_tr_b16 v[50:51], v10 offset:24832
    v_mfma_f32_16x16x32_bf16 v[116:119], v[28:31], v[68:71], v[116:119]
    ds_read_b64_tr_b16 v[52:53], v11 offset:24576
    v_mfma_f32_16x16x32_bf16 v[132:135], v[168:171], v[148:151], v[132:135]
    ds_read_b64_tr_b16 v[54:55], v11 offset:24832
    v_mfma_f32_16x16x32_bf16 v[96:99], v[24:27], v[72:75], v[96:99]
    ds_read_b64_tr_b16 v[136:137], v14 offset:16384
    v_mfma_f32_16x16x32_bf16 v[120:123], v[28:31], v[72:75], v[120:123]
    ds_read_b64_tr_b16 v[138:139], v14 offset:16640
    v_mfma_f32_16x16x32_bf16 v[100:103], v[24:27], v[76:79], v[100:103]
    ds_read_b64_tr_b16 v[140:141], v15 offset:16384
    ds_read_b64_tr_b16 v[142:143], v15 offset:16640
    v_mfma_f32_16x16x32_bf16 v[124:127], v[28:31], v[76:79], v[124:127]
    s_waitcnt lgkmcnt(0)
    s_nop 7
    v_and_b32 v8, 1, v4
    v_lshrrev_b32 v9, 1, v4
    v_lshlrev_b32 v8, 5, v8
    v_lshl_add_u32 v8, v9, 4, v8
    s_mov_b32 s27, 2048
    v_mul_lo_u32 v14, v3, s27
    v_add_u32 v14, v14, v8
    v_lshl_add_u32 v15, v3, 12, v8
    s_mul_i32 s42, s32, 2048
    s_lshl_b32 s28, s33, 1
    s_add_u32 s42, s42, s28
    s_add_u32 s43, s33, -1024
    s_lshl_b32 s43, s43, 12
    s_lshl_b32 s28, s32, 1
    s_add_u32 s43, s43, s28
    s_add_u32 s43, s43, 4194304
    v_lshlrev_b32 v8, 2, v3
    v_add_u32 v9, s48, v8
    ds_write_b32 v9, v128 offset:1024
    v_add_u32 v9, s49, v8
    ds_write_b32 v9, v132 offset:1024
    s_waitcnt lgkmcnt(0)
    s_barrier
    v_lshlrev_b32 v8, 4, v4
    v_lshlrev_b32 v9, 2, v3
    ds_read_b32 v128, v9 offset:1024
    ds_read_b32 v132, v9 offset:1088
    ds_read_b32 v136, v9 offset:1152
    ds_read_b32 v140, v9 offset:1216
    ds_read_b32 v144, v9 offset:1280
    ds_read_b32 v148, v9 offset:1344
    v_lshlrev_b32 v8, 2, v4
    v_sub_u32 v8, v3, v8
    v_mov_b32 v33, 0
    v_cmp_eq_u32 vcc, 0, v8
    s_nop 1
    v_cndmask_b32 v33, v33, v156, vcc
    v_cmp_eq_u32 vcc, 1, v8
    s_nop 1
    v_cndmask_b32 v33, v33, v157, vcc
    v_cmp_eq_u32 vcc, 2, v8
    s_nop 1
    v_cndmask_b32 v33, v33, v158, vcc
    v_cmp_eq_u32 vcc, 3, v8
    s_nop 1
    v_cndmask_b32 v33, v33, v159, vcc
    v_mov_b32 v35, v33
    s_nop 1
    v_permlane16_swap_b32 v33, v35
    s_nop 1
    v_add_f32 v33, v33, v35
    v_mov_b32 v35, v33
    s_nop 1
    v_permlane32_swap_b32 v33, v35
    s_nop 1
    v_add_f32 v33, v33, v35
    v_mov_b32 v32, v152
    v_mul_f32 v32, 0x3b000000, v32
    v_mul_f32 v33, 0x3b000000, v33
    v_fma_f32 v34, -v32, v32, v33
    v_max_f32 v34, 0, v34
    v_cvt_pk_bf16_f32 v35, v32, v34
    s_nop 0
    v_lshlrev_b32 v32, 16, v35
    v_and_b32 v34, 0xffff0000, v35
    v_add_f32 v34, 0x3727c5ac, v34
    v_cvt_pk_bf16_f32 v35, v34, v34
    s_nop 0
    v_lshlrev_b32 v34, 16, v35
    v_sqrt_f32 v34, v34
    s_nop 0
    v_cvt_pk_bf16_f32 v35, v34, v34
    s_nop 0
    v_lshlrev_b32 v34, 16, v35
    v_rcp_f32 v152, v34
    s_nop 0
    v_mul_f32 v154, -v32, v152
    v_mov_b32 v33, 0
    v_cmp_eq_u32 vcc, 0, v8
    s_nop 1
    v_cndmask_b32 v33, v33, v164, vcc
    v_cmp_eq_u32 vcc, 1, v8
    s_nop 1
    v_cndmask_b32 v33, v33, v165, vcc
    v_cmp_eq_u32 vcc, 2, v8
    s_nop 1
    v_cndmask_b32 v33, v33, v166, vcc
    v_cmp_eq_u32 vcc, 3, v8
    s_nop 1
    v_cndmask_b32 v33, v33, v167, vcc
    v_mov_b32 v35, v33
    s_nop 1
    v_permlane16_swap_b32 v33, v35
    s_nop 1
    v_add_f32 v33, v33, v35
    v_mov_b32 v35, v33
    s_nop 1
    v_permlane32_swap_b32 v33, v35
    s_nop 1
    v_add_f32 v33, v33, v35
    v_mov_b32 v32, v160
    v_mul_f32 v32, 0x3b000000, v32
    v_mul_f32 v33, 0x3b000000, v33
    v_fma_f32 v34, -v32, v32, v33
    v_max_f32 v34, 0, v34
    v_cvt_pk_bf16_f32 v35, v32, v34
    s_nop 0
    v_lshlrev_b32 v32, 16, v35
    v_and_b32 v34, 0xffff0000, v35
    v_add_f32 v34, 0x3727c5ac, v34
    v_cvt_pk_bf16_f32 v35, v34, v34
    s_nop 0
    v_lshlrev_b32 v34, 16, v35
    v_sqrt_f32 v34, v34
    s_nop 0
    v_cvt_pk_bf16_f32 v35, v34, v34
    s_nop 0
    v_lshlrev_b32 v34, 16, v35
    v_rcp_f32 v160, v34
    s_nop 0
    v_mul_f32 v162, -v32, v160
    s_lshl_b32 s27, s24, 8
    v_lshlrev_b32 v8, 2, v3
    v_add_u32 v8, s27, v8
    ds_write_b32 v8, v152 offset:0
    ds_write_b32 v8, v154 offset:128
    ds_write_b32 v8, v160 offset:64
    ds_write_b32 v8, v162 offset:192
    v_lshlrev_b32 v8, 4, v4
    v_add_u32 v8, s27, v8
    s_waitcnt lgkmcnt(0)
    ds_read_b128 v[56:59], v8 offset:0
    ds_read_b128 v[60:63], v8 offset:128
    ds_read_b128 v[64:67], v8 offset:64
    ds_read_b128 v[68:71], v8 offset:192
    s_waitcnt lgkmcnt(0)
    s_waitcnt lgkmcnt(0)
    v_pk_mul_f32 v[8:9], v[60:61], v[128:129] op_sel_hi:[1,0]
    v_pk_fma_f32 v[80:81], v[80:81], v[56:57], v[8:9]
    v_pk_mul_f32 v[8:9], v[62:63], v[128:129] op_sel_hi:[1,0]
    v_pk_fma_f32 v[82:83], v[82:83], v[58:59], v[8:9]
    v_pk_mul_f32 v[8:9], v[60:61], v[132:133] op_sel_hi:[1,0]
    v_pk_fma_f32 v[84:85], v[84:85], v[56:57], v[8:9]
    v_pk_mul_f32 v[8:9], v[62:63], v[132:133] op_sel_hi:[1,0]
    v_pk_fma_f32 v[86:87], v[86:87], v[58:59], v[8:9]
    v_pk_mul_f32 v[8:9], v[60:61], v[136:137] op_sel_hi:[1,0]
    v_pk_fma_f32 v[88:89], v[88:89], v[56:57], v[8:9]
    v_pk_mul_f32 v[8:9], v[62:63], v[136:137] op_sel_hi:[1,0]
    v_pk_fma_f32 v[90:91], v[90:91], v[58:59], v[8:9]
    v_pk_mul_f32 v[8:9], v[60:61], v[140:141] op_sel_hi:[1,0]
    v_pk_fma_f32 v[92:93], v[92:93], v[56:57], v[8:9]
    v_pk_mul_f32 v[8:9], v[62:63], v[140:141] op_sel_hi:[1,0]
    v_pk_fma_f32 v[94:95], v[94:95], v[58:59], v[8:9]
    v_pk_mul_f32 v[8:9], v[60:61], v[144:145] op_sel_hi:[1,0]
    v_pk_fma_f32 v[96:97], v[96:97], v[56:57], v[8:9]
    v_pk_mul_f32 v[8:9], v[62:63], v[144:145] op_sel_hi:[1,0]
    v_pk_fma_f32 v[98:99], v[98:99], v[58:59], v[8:9]
    v_pk_mul_f32 v[8:9], v[60:61], v[148:149] op_sel_hi:[1,0]
    v_pk_fma_f32 v[100:101], v[100:101], v[56:57], v[8:9]
    v_pk_mul_f32 v[8:9], v[62:63], v[148:149] op_sel_hi:[1,0]
    v_pk_fma_f32 v[102:103], v[102:103], v[58:59], v[8:9]
    v_pk_mul_f32 v[8:9], v[68:69], v[128:129] op_sel_hi:[1,0]
    v_pk_fma_f32 v[104:105], v[104:105], v[64:65], v[8:9]
    v_pk_mul_f32 v[8:9], v[70:71], v[128:129] op_sel_hi:[1,0]
    v_pk_fma_f32 v[106:107], v[106:107], v[66:67], v[8:9]
    v_pk_mul_f32 v[8:9], v[68:69], v[132:133] op_sel_hi:[1,0]
    v_pk_fma_f32 v[108:109], v[108:109], v[64:65], v[8:9]
    v_pk_mul_f32 v[8:9], v[70:71], v[132:133] op_sel_hi:[1,0]
    v_pk_fma_f32 v[110:111], v[110:111], v[66:67], v[8:9]
    v_pk_mul_f32 v[8:9], v[68:69], v[136:137] op_sel_hi:[1,0]
    v_pk_fma_f32 v[112:113], v[112:113], v[64:65], v[8:9]
    v_pk_mul_f32 v[8:9], v[70:71], v[136:137] op_sel_hi:[1,0]
    v_pk_fma_f32 v[114:115], v[114:115], v[66:67], v[8:9]
    v_pk_mul_f32 v[8:9], v[68:69], v[140:141] op_sel_hi:[1,0]
    v_pk_fma_f32 v[116:117], v[116:117], v[64:65], v[8:9]
    v_pk_mul_f32 v[8:9], v[70:71], v[140:141] op_sel_hi:[1,0]
    v_pk_fma_f32 v[118:119], v[118:119], v[66:67], v[8:9]
    v_pk_mul_f32 v[8:9], v[68:69], v[144:145] op_sel_hi:[1,0]
    v_pk_fma_f32 v[120:121], v[120:121], v[64:65], v[8:9]
    v_pk_mul_f32 v[8:9], v[70:71], v[144:145] op_sel_hi:[1,0]
    v_pk_fma_f32 v[122:123], v[122:123], v[66:67], v[8:9]
    v_pk_mul_f32 v[8:9], v[68:69], v[148:149] op_sel_hi:[1,0]
    v_pk_fma_f32 v[124:125], v[124:125], v[64:65], v[8:9]
    v_pk_mul_f32 v[8:9], v[70:71], v[148:149] op_sel_hi:[1,0]
    v_pk_fma_f32 v[126:127], v[126:127], v[66:67], v[8:9]
    v_cvt_pk_bf16_f32 v32, v80, v81
    v_cvt_pk_bf16_f32 v33, v82, v83
    v_cvt_pk_bf16_f32 v34, v104, v105
    v_cvt_pk_bf16_f32 v35, v106, v107
    s_add_u32 s27, s43, 0
    s_nop 0
    v_permlane16_swap_b32 v32, v34
    v_permlane16_swap_b32 v33, v35
    buffer_store_dwordx4 v[32:35], v15, s[20:23], s27 offen
    v_cvt_pk_bf16_f32 v36, v84, v85
    v_cvt_pk_bf16_f32 v37, v86, v87
    v_cvt_pk_bf16_f32 v38, v108, v109
    v_cvt_pk_bf16_f32 v39, v110, v111
    s_add_u32 s27, s43, 65536
    s_nop 0
    v_permlane16_swap_b32 v36, v38
    v_permlane16_swap_b32 v37, v39
    buffer_store_dwordx4 v[36:39], v15, s[20:23], s27 offen
    v_cvt_pk_bf16_f32 v40, v88, v89
    v_cvt_pk_bf16_f32 v41, v90, v91
    v_cvt_pk_bf16_f32 v42, v112, v113
    v_cvt_pk_bf16_f32 v43, v114, v115
    s_add_u32 s27, s43, 131072
    s_nop 0
    v_permlane16_swap_b32 v40, v42
    v_permlane16_swap_b32 v41, v43
    buffer_store_dwordx4 v[40:43], v15, s[20:23], s27 offen
    v_cvt_pk_bf16_f32 v44, v92, v93
    v_cvt_pk_bf16_f32 v45, v94, v95
    v_cvt_pk_bf16_f32 v46, v116, v117
    v_cvt_pk_bf16_f32 v47, v118, v119
    s_add_u32 s27, s43, 196608
    s_nop 0
    v_permlane16_swap_b32 v44, v46
    v_permlane16_swap_b32 v45, v47
    buffer_store_dwordx4 v[44:47], v15, s[20:23], s27 offen
    v_cvt_pk_bf16_f32 v48, v96, v97
    v_cvt_pk_bf16_f32 v49, v98, v99
    v_cvt_pk_bf16_f32 v50, v120, v121
    v_cvt_pk_bf16_f32 v51, v122, v123
    s_add_u32 s27, s43, 262144
    s_nop 0
    v_permlane16_swap_b32 v48, v50
    v_permlane16_swap_b32 v49, v51
    buffer_store_dwordx4 v[48:51], v15, s[20:23], s27 offen
    v_cvt_pk_bf16_f32 v52, v100, v101
    v_cvt_pk_bf16_f32 v53, v102, v103
    v_cvt_pk_bf16_f32 v54, v124, v125
    v_cvt_pk_bf16_f32 v55, v126, v127
    s_add_u32 s27, s43, 327680
    s_nop 0
    v_permlane16_swap_b32 v52, v54
    v_permlane16_swap_b32 v53, v55
    buffer_store_dwordx4 v[52:55], v15, s[20:23], s27 offen
    s_endpgm
k1_qkv_kernel_loader:
    s_sub_u32 s24, s24, 4
    v_lshrrev_b32 v5, 3, v2
    v_and_b32 v6, 7, v2
    s_mov_b32 s27, 1024
    v_lshrrev_b32 v8, 1, v5
    v_xor_b32 v8, v8, v6
    v_mul_lo_u32 v7, v5, s27
    v_lshl_add_u32 v16, v8, 4, v7
    v_xor_b32 v9, 4, v8
    v_lshl_add_u32 v17, v9, 4, v7
    v_add_u32 v17, 7168, v17
    v_lshl_add_u32 v18, v8, 4, v7
    v_add_u32 v18, 14336, v18
    v_xor_b32 v9, 4, v8
    v_lshl_add_u32 v19, v9, 4, v7
    v_add_u32 v19, 21504, v19
    v_lshrrev_b32 v6, 2, v2
    s_mov_b32 s27, 3072
    v_mul_lo_u32 v6, v6, s27
    v_lshrrev_b32 v9, 5, v2
    v_lshlrev_b32 v9, 1, v9
    v_and_b32 v8, 3, v2
    v_xor_b32 v9, v9, v8
    v_lshl_add_u32 v20, v9, 4, v6
    v_add_u32 v21, 64, v20
    v_add_u32 v22, 128, v20
    s_mul_i32 s28, s24, 32
    s_add_u32 s42, s28, s25
    s_mul_i32 s42, s42, 1024
    s_add_u32 s42, s42, 0
    s_mul_i32 s30, s24, 4096
    s_add_u32 s30, s30, 2048
    s_and_b32 s28, s24, 3
    s_mul_i32 s43, s28, 49152
    s_lshl_b32 s29, s26, 1
    s_add_u32 s43, s43, s29
    s_lshl_b32 s31, s28, 10
    s_add_u32 s31, s31, 18432
    s_mov_b32 s44, 0
    s_mov_b32 s45, 0
    s_waitcnt lgkmcnt(0)
    s_mov_b32 s8, s4
    s_mov_b32 s9, s5
    s_mov_b32 s10, 2097152
    s_mov_b32 s11, 0x00020000
    s_mov_b32 s12, s6
    s_mov_b32 s13, s7
    s_mov_b32 s14, 1572864
    s_mov_b32 s15, 0x00020000
    s_add_u32 m0, s30, s44
    s_add_u32 s27, s31, s44
    buffer_load_dwordx4 v16, s[8:11], s42 offen offset:0 lds
    buffer_load_dwordx4 v17, s[8:11], s42 offen offset:1024 lds
    buffer_load_dwordx4 v18, s[8:11], s42 offen offset:2048 lds
    buffer_load_dwordx4 v19, s[8:11], s42 offen offset:3072 lds
    s_add_u32 m0, s27, 0
    s_add_u32 s42, s42, 128
    buffer_load_dwordx4 v20, s[12:15], s43 offen lds
    s_add_u32 m0, s27, 4096
    s_nop 0
    buffer_load_dwordx4 v21, s[12:15], s43 offen lds
    s_add_u32 m0, s27, 8192
    s_nop 0
    buffer_load_dwordx4 v22, s[12:15], s43 offen lds
    s_add_u32 s43, s43, 196608
    s_add_u32 s44, s44, 28672
    s_add_u32 s45, s45, 1
    s_cmp_eq_u32 s45, 5
    s_cselect_b32 s44, 0, s44
    s_cselect_b32 s45, 0, s45
    s_add_u32 m0, s30, s44
    s_add_u32 s27, s31, s44
    buffer_load_dwordx4 v16, s[8:11], s42 offen offset:0 lds
    buffer_load_dwordx4 v17, s[8:11], s42 offen offset:1024 lds
    buffer_load_dwordx4 v18, s[8:11], s42 offen offset:2048 lds
    buffer_load_dwordx4 v19, s[8:11], s42 offen offset:3072 lds
    s_add_u32 m0, s27, 0
    s_add_u32 s42, s42, 128
    buffer_load_dwordx4 v20, s[12:15], s43 offen lds
    s_add_u32 m0, s27, 4096
    s_nop 0
    buffer_load_dwordx4 v21, s[12:15], s43 offen lds
    s_add_u32 m0, s27, 8192
    s_nop 0
    buffer_load_dwordx4 v22, s[12:15], s43 offen lds
    s_add_u32 s43, s43, 196608
    s_add_u32 s44, s44, 28672
    s_add_u32 s45, s45, 1
    s_cmp_eq_u32 s45, 5
    s_cselect_b32 s44, 0, s44
    s_cselect_b32 s45, 0, s45
    s_waitcnt vmcnt(7)
    s_barrier
    s_add_u32 m0, s30, s44
    s_add_u32 s27, s31, s44
    buffer_load_dwordx4 v16, s[8:11], s42 offen offset:0 lds
    buffer_load_dwordx4 v17, s[8:11], s42 offen offset:1024 lds
    buffer_load_dwordx4 v18, s[8:11], s42 offen offset:2048 lds
    buffer_load_dwordx4 v19, s[8:11], s42 offen offset:3072 lds
    s_add_u32 m0, s27, 0
    s_add_u32 s42, s42, 128
    buffer_load_dwordx4 v20, s[12:15], s43 offen lds
    s_add_u32 m0, s27, 4096
    s_nop 0
    buffer_load_dwordx4 v21, s[12:15], s43 offen lds
    s_add_u32 m0, s27, 8192
    s_nop 0
    buffer_load_dwordx4 v22, s[12:15], s43 offen lds
    s_add_u32 s43, s43, 196608
    s_add_u32 s44, s44, 28672
    s_add_u32 s45, s45, 1
    s_cmp_eq_u32 s45, 5
    s_cselect_b32 s44, 0, s44
    s_cselect_b32 s45, 0, s45
    s_add_u32 m0, s30, s44
    s_add_u32 s27, s31, s44
    buffer_load_dwordx4 v16, s[8:11], s42 offen offset:0 lds
    buffer_load_dwordx4 v17, s[8:11], s42 offen offset:1024 lds
    buffer_load_dwordx4 v18, s[8:11], s42 offen offset:2048 lds
    buffer_load_dwordx4 v19, s[8:11], s42 offen offset:3072 lds
    s_add_u32 m0, s27, 0
    s_add_u32 s42, s42, 128
    buffer_load_dwordx4 v20, s[12:15], s43 offen lds
    s_add_u32 m0, s27, 4096
    s_nop 0
    buffer_load_dwordx4 v21, s[12:15], s43 offen lds
    s_add_u32 m0, s27, 8192
    s_nop 0
    buffer_load_dwordx4 v22, s[12:15], s43 offen lds
    s_add_u32 s43, s43, 196608
    s_add_u32 s44, s44, 28672
    s_add_u32 s45, s45, 1
    s_cmp_eq_u32 s45, 5
    s_cselect_b32 s44, 0, s44
    s_cselect_b32 s45, 0, s45
    s_waitcnt vmcnt(14)
    s_barrier
    s_add_u32 m0, s30, s44
    s_add_u32 s27, s31, s44
    buffer_load_dwordx4 v16, s[8:11], s42 offen offset:0 lds
    buffer_load_dwordx4 v17, s[8:11], s42 offen offset:1024 lds
    buffer_load_dwordx4 v18, s[8:11], s42 offen offset:2048 lds
    buffer_load_dwordx4 v19, s[8:11], s42 offen offset:3072 lds
    s_add_u32 m0, s27, 0
    s_add_u32 s42, s42, 128
    buffer_load_dwordx4 v20, s[12:15], s43 offen lds
    s_add_u32 m0, s27, 4096
    s_nop 0
    buffer_load_dwordx4 v21, s[12:15], s43 offen lds
    s_add_u32 m0, s27, 8192
    s_nop 0
    buffer_load_dwordx4 v22, s[12:15], s43 offen lds
    s_add_u32 s43, s43, 196608
    s_add_u32 s44, s44, 28672
    s_add_u32 s45, s45, 1
    s_cmp_eq_u32 s45, 5
    s_cselect_b32 s44, 0, s44
    s_cselect_b32 s45, 0, s45
    s_add_u32 m0, s30, s44
    s_add_u32 s27, s31, s44
    buffer_load_dwordx4 v16, s[8:11], s42 offen offset:0 lds
    buffer_load_dwordx4 v17, s[8:11], s42 offen offset:1024 lds
    buffer_load_dwordx4 v18, s[8:11], s42 offen offset:2048 lds
    buffer_load_dwordx4 v19, s[8:11], s42 offen offset:3072 lds
    s_add_u32 m0, s27, 0
    s_add_u32 s42, s42, 128
    buffer_load_dwordx4 v20, s[12:15], s43 offen lds
    s_add_u32 m0, s27, 4096
    s_nop 0
    buffer_load_dwordx4 v21, s[12:15], s43 offen lds
    s_add_u32 m0, s27, 8192
    s_nop 0
    buffer_load_dwordx4 v22, s[12:15], s43 offen lds
    s_add_u32 s43, s43, 196608
    s_add_u32 s44, s44, 28672
    s_add_u32 s45, s45, 1
    s_cmp_eq_u32 s45, 5
    s_cselect_b32 s44, 0, s44
    s_cselect_b32 s45, 0, s45
    s_waitcnt vmcnt(21)
    s_barrier
    s_add_u32 m0, s30, s44
    s_add_u32 s27, s31, s44
    buffer_load_dwordx4 v16, s[8:11], s42 offen offset:0 lds
    buffer_load_dwordx4 v17, s[8:11], s42 offen offset:1024 lds
    buffer_load_dwordx4 v18, s[8:11], s42 offen offset:2048 lds
    buffer_load_dwordx4 v19, s[8:11], s42 offen offset:3072 lds
    s_add_u32 m0, s27, 0
    s_add_u32 s42, s42, 128
    buffer_load_dwordx4 v20, s[12:15], s43 offen lds
    s_add_u32 m0, s27, 4096
    s_nop 0
    buffer_load_dwordx4 v21, s[12:15], s43 offen lds
    s_add_u32 m0, s27, 8192
    s_nop 0
    buffer_load_dwordx4 v22, s[12:15], s43 offen lds
    s_add_u32 s43, s43, 196608
    s_add_u32 s44, s44, 28672
    s_add_u32 s45, s45, 1
    s_cmp_eq_u32 s45, 5
    s_cselect_b32 s44, 0, s44
    s_cselect_b32 s45, 0, s45
    s_waitcnt vmcnt(21)
    s_barrier
    s_add_u32 m0, s30, s44
    s_add_u32 s27, s31, s44
    buffer_load_dwordx4 v16, s[8:11], s42 offen offset:0 lds
    buffer_load_dwordx4 v17, s[8:11], s42 offen offset:1024 lds
    buffer_load_dwordx4 v18, s[8:11], s42 offen offset:2048 lds
    buffer_load_dwordx4 v19, s[8:11], s42 offen offset:3072 lds
    s_add_u32 m0, s27, 0
    s_add_u32 s42, s42, 128
    buffer_load_dwordx4 v20, s[12:15], s43 offen lds
    s_add_u32 m0, s27, 4096
    s_nop 0
    buffer_load_dwordx4 v21, s[12:15], s43 offen lds
    s_add_u32 m0, s27, 8192
    s_nop 0
    buffer_load_dwordx4 v22, s[12:15], s43 offen lds
    s_add_u32 s43, s43, 196608
    s_add_u32 s44, s44, 28672
    s_add_u32 s45, s45, 1
    s_cmp_eq_u32 s45, 5
    s_cselect_b32 s44, 0, s44
    s_cselect_b32 s45, 0, s45
    s_load_dwordx2 s[36:37], s[0:1], 16
    s_lshr_b32 s27, s2, 3
    s_mul_i32 s27, s27, 4
    s_add_u32 s27, s27, s24
    s_mul_i32 s27, s27, 4096
    v_lshlrev_b32 v28, 4, v2
    s_waitcnt lgkmcnt(0)
    s_mov_b32 s16, s36
    s_mov_b32 s17, s37
    s_mov_b32 s18, 524288
    s_mov_b32 s19, 0x00020000
    buffer_load_dwordx4 v[24:27], v28, s[16:19], s27 offen offset:0
    buffer_load_dwordx4 v[24:27], v28, s[16:19], s27 offen offset:1024
    buffer_load_dwordx4 v[24:27], v28, s[16:19], s27 offen offset:2048
    buffer_load_dwordx4 v[24:27], v28, s[16:19], s27 offen offset:3072
    s_waitcnt vmcnt(25)
    s_barrier
    s_waitcnt vmcnt(18)
    s_barrier
    s_waitcnt vmcnt(11)
    s_barrier
    s_waitcnt vmcnt(4)
    s_barrier
    s_barrier
k1_qkv_kernel_end:
    s_endpgm
.globl k2_attn_kernel
.p2align 8
.type k2_attn_kernel,@function
k2_attn_kernel:
    s_cmp_ge_u32 s2, 256
    s_cbranch_scc1 k2_attn_kernel_end
    s_load_dwordx2 s[4:5], s[0:1], 64
    v_lshrrev_b32 v1, 6, v0
    v_and_b32 v2, 63, v0
    s_and_b32 s25, s2, 7
    v_readfirstlane_b32 s24, v1
    v_and_b32 v3, 15, v2
    v_lshrrev_b32 v4, 4, v2
    s_lshl_b32 s25, s25, 2
    s_lshr_b32 s27, s2, 6
    s_add_u32 s25, s25, s27
    s_lshl_b32 s25, s25, 6
    s_bfe_u32 s26, s2, 0x30003
    s_sub_i32 s30, s25, 256
    s_waitcnt lgkmcnt(0)
    s_mov_b32 s8, s4
    s_mov_b32 s9, s5
    s_mov_b32 s10, 4194304
    s_mov_b32 s11, 0x00020000
    s_mov_b32 s12, s4
    s_mov_b32 s13, s5
    s_mov_b32 s14, 6291456
    s_mov_b32 s15, 0x00020000
    s_mov_b32 s16, s4
    s_mov_b32 s17, s5
    s_mov_b32 s18, 8388608
    s_mov_b32 s19, 0x00020000
    s_cmp_ge_u32 s24, 8
    s_cbranch_scc1 k2_attn_kernel_ldv
    v_lshrrev_b32 v5, 3, v2
    v_and_b32 v6, 7, v2
    s_mul_i32 s27, s24, 40
    s_lshl_b32 s28, s26, 7
    s_add_u32 s40, s28, 1024
    s_lshl_b32 s29, s27, 7
    v_add_u32 v7, s27, v5
    v_add_u32 v9, 0, v7
    v_bfe_u32 v8, v9, 1, 3
    v_xor_b32 v8, v8, v6
    v_add_u32 v9, s30, v9
    v_max_i32 v9, 0, v9
    v_lshlrev_b32 v9, 11, v9
    s_add_u32 m0, s29, 0
    v_lshl_add_u32 v9, v8, 4, v9
    buffer_load_dwordx4 v9, s[8:11], s40 offen lds
    v_add_u32 v9, 8, v7
    v_bfe_u32 v8, v9, 1, 3
    v_xor_b32 v8, v8, v6
    v_add_u32 v9, s30, v9
    v_max_i32 v9, 0, v9
    v_lshlrev_b32 v9, 11, v9
    s_add_u32 m0, s29, 1024
    v_lshl_add_u32 v9, v8, 4, v9
    buffer_load_dwordx4 v9, s[8:11], s40 offen lds
    v_add_u32 v9, 16, v7
    v_bfe_u32 v8, v9, 1, 3
    v_xor_b32 v8, v8, v6
    v_add_u32 v9, s30, v9
    v_max_i32 v9, 0, v9
    v_lshlrev_b32 v9, 11, v9
    s_add_u32 m0, s29, 2048
    v_lshl_add_u32 v9, v8, 4, v9
    buffer_load_dwordx4 v9, s[8:11], s40 offen lds
    v_add_u32 v9, 24, v7
    v_bfe_u32 v8, v9, 1, 3
    v_xor_b32 v8, v8, v6
    v_add_u32 v9, s30, v9
    v_max_i32 v9, 0, v9
    v_lshlrev_b32 v9, 11, v9
    s_add_u32 m0, s29, 3072
    v_lshl_add_u32 v9, v8, 4, v9
    buffer_load_dwordx4 v9, s[8:11], s40 offen lds
    v_add_u32 v9, 32, v7
    v_bfe_u32 v8, v9, 1, 3
    v_xor_b32 v8, v8, v6
    v_add_u32 v9, s30, v9
    v_max_i32 v9, 0, v9
    v_lshlrev_b32 v9, 11, v9
    s_add_u32 m0, s29, 4096
    v_lshl_add_u32 v9, v8, 4, v9
    buffer_load_dwordx4 v9, s[8:11], s40 offen lds
    s_lshl_b32 s27, s24, 3
    v_add_u32 v7, s27, v5
    v_bfe_u32 v8, v7, 1, 3
    v_xor_b32 v8, v8, v6
    v_add_u32 v7, s25, v7
    v_lshlrev_b32 v7, 11, v7
    s_lshl_b32 s29, s24, 10
    s_add_u32 m0, s29, 81920
    v_lshl_add_u32 v7, v8, 4, v7
    buffer_load_dwordx4 v7, s[8:11], s28 offen lds
    s_branch k2_attn_kernel_ldone
k2_attn_kernel_ldv:
    s_lshl_b32 s28, s26, 18
    s_add_u32 s28, s28, 4194304
    s_sub_u32 s27, s24, 8
    s_mul_i32 s27, s27, 320
    s_mov_b32 s41, 1639
    s_lshl_b32 s29, s27, 4
    v_add_u32 v5, s27, v2
    v_add_u32 v7, 0, v5
    v_mul_lo_u32 v8, v7, s41
    v_lshrrev_b32 v8, 16, v8
    v_mul_u32_u24 v9, 40, v8
    v_sub_u32 v9, v7, v9
    v_bfe_u32 v10, v8, 1, 3
    v_xor_b32 v9, v9, v10
    v_lshlrev_b32 v9, 3, v9
    v_add_u32 v9, s30, v9
    v_max_i32 v9, 0, v9
    v_lshlrev_b32 v9, 1, v9
    s_add_u32 m0, s29, 40960
    v_lshl_add_u32 v9, v8, 12, v9
    buffer_load_dwordx4 v9, s[12:15], s28 offen lds
    v_add_u32 v7, 64, v5
    v_mul_lo_u32 v8, v7, s41
    v_lshrrev_b32 v8, 16, v8
    v_mul_u32_u24 v9, 40, v8
    v_sub_u32 v9, v7, v9
    v_bfe_u32 v10, v8, 1, 3
    v_xor_b32 v9, v9, v10
    v_lshlrev_b32 v9, 3, v9
    v_add_u32 v9, s30, v9
    v_max_i32 v9, 0, v9
    v_lshlrev_b32 v9, 1, v9
    s_add_u32 m0, s29, 41984
    v_lshl_add_u32 v9, v8, 12, v9
    buffer_load_dwordx4 v9, s[12:15], s28 offen lds
    v_add_u32 v7, 128, v5
    v_mul_lo_u32 v8, v7, s41
    v_lshrrev_b32 v8, 16, v8
    v_mul_u32_u24 v9, 40, v8
    v_sub_u32 v9, v7, v9
    v_bfe_u32 v10, v8, 1, 3
    v_xor_b32 v9, v9, v10
    v_lshlrev_b32 v9, 3, v9
    v_add_u32 v9, s30, v9
    v_max_i32 v9, 0, v9
    v_lshlrev_b32 v9, 1, v9
    s_add_u32 m0, s29, 43008
    v_lshl_add_u32 v9, v8, 12, v9
    buffer_load_dwordx4 v9, s[12:15], s28 offen lds
    v_add_u32 v7, 192, v5
    v_mul_lo_u32 v8, v7, s41
    v_lshrrev_b32 v8, 16, v8
    v_mul_u32_u24 v9, 40, v8
    v_sub_u32 v9, v7, v9
    v_bfe_u32 v10, v8, 1, 3
    v_xor_b32 v9, v9, v10
    v_lshlrev_b32 v9, 3, v9
    v_add_u32 v9, s30, v9
    v_max_i32 v9, 0, v9
    v_lshlrev_b32 v9, 1, v9
    s_add_u32 m0, s29, 44032
    v_lshl_add_u32 v9, v8, 12, v9
    buffer_load_dwordx4 v9, s[12:15], s28 offen lds
    v_add_u32 v7, 256, v5
    v_mul_lo_u32 v8, v7, s41
    v_lshrrev_b32 v8, 16, v8
    v_mul_u32_u24 v9, 40, v8
    v_sub_u32 v9, v7, v9
    v_bfe_u32 v10, v8, 1, 3
    v_xor_b32 v9, v9, v10
    v_lshlrev_b32 v9, 3, v9
    v_add_u32 v9, s30, v9
    v_max_i32 v9, 0, v9
    v_lshlrev_b32 v9, 1, v9
    s_add_u32 m0, s29, 45056
    v_lshl_add_u32 v9, v8, 12, v9
    buffer_load_dwordx4 v9, s[12:15], s28 offen lds
k2_attn_kernel_ldone:
    v_lshlrev_b32 v7, 2, v4
    s_mov_b32 s42, 0xf149f2ca
    v_mov_b32 v10, s42
    v_add_u32 v11, 0, v7
    v_cmp_le_u32 vcc, v11, v3
    v_mov_b32 v20, 0
    s_nop 0
    v_cndmask_b32 v12, v10, 0, vcc
    v_cndmask_b32 v16, 0, v10, vcc
    v_add_u32 v11, 1, v7
    v_cmp_le_u32 vcc, v11, v3
    v_mov_b32 v21, 0
    s_nop 0
    v_cndmask_b32 v13, v10, 0, vcc
    v_cndmask_b32 v17, 0, v10, vcc
    v_add_u32 v11, 2, v7
    v_cmp_le_u32 vcc, v11, v3
    v_mov_b32 v22, 0
    s_nop 0
    v_cndmask_b32 v14, v10, 0, vcc
    v_cndmask_b32 v18, 0, v10, vcc
    v_add_u32 v11, 3, v7
    v_cmp_le_u32 vcc, v11, v3
    v_mov_b32 v23, 0
    s_nop 0
    v_cndmask_b32 v15, v10, 0, vcc
    v_cndmask_b32 v19, 0, v10, vcc
    v_lshlrev_b32 v31, 10, v3
    v_lshl_add_u32 v31, v4, 3, v31
    s_and_b32 s32, s24, 3
    s_lshr_b32 s31, s24, 2
    s_lshl_b32 s27, s32, 1
    v_lshrrev_b32 v11, 1, v4
    v_add_u32 v7, s27, v11
    v_lshrrev_b32 v8, 1, v3
    v_xor_b32 v7, v7, v8
    v_lshlrev_b32 v7, 4, v7
    v_lshl_add_u32 v7, v3, 7, v7
    v_and_b32 v9, 1, v4
    v_lshl_add_u32 v7, v9, 3, v7
    s_lshl_b32 s27, s31, 11
    v_add_u32 v28, s27, v7
    v_add_u32 v29, 81920, v28
    s_mul_i32 s27, s32, 10240
    s_add_u32 s27, s27, 40960
    v_mul_u32_u24 v30, 640, v3
    v_add_u32 v30, s27, v30
    v_lshl_add_u32 v30, v9, 3, v30
    s_lshl_b32 s27, s31, 1
    v_add_u32 v11, s27, v11
    s_lshl_b32 s28, s31, 4
    s_add_i32 s28, s28, s30
    s_waitcnt vmcnt(0)
    s_barrier
    s_cmp_lt_u32 s25, 256
    s_cbranch_scc1 k2_attn_kernel_edge
    ds_read_b64 v[24:25], v29
    ds_read_b64 v[100:101], v28 offset:32768
    ds_read_b64 v[102:103], v28 offset:30720
    ds_read_b64 v[104:105], v28 offset:28672
    ds_read_b64 v[106:107], v28 offset:26624
    ds_read_b64 v[108:109], v28 offset:24576
    ds_read_b64 v[110:111], v28 offset:22528
    ds_read_b64 v[112:113], v28 offset:20480
    ds_read_b64 v[114:115], v28 offset:18432
    ds_read_b64 v[116:117], v28 offset:16384
    s_waitcnt lgkmcnt(0)
    v_mfma_f32_16x16x16_bf16 v[96:99], v[100:101], v[24:25], v[12:15]
    v_mfma_f32_16x16x16_bf16 v[92:95], v[102:103], v[24:25], v[20:23]
    v_mfma_f32_16x16x16_bf16 v[88:91], v[104:105], v[24:25], v[20:23]
    v_mfma_f32_16x16x16_bf16 v[84:87], v[106:107], v[24:25], v[20:23]
    v_mfma_f32_16x16x16_bf16 v[80:83], v[108:109], v[24:25], v[20:23]
    v_mfma_f32_16x16x16_bf16 v[76:79], v[110:111], v[24:25], v[20:23]
    v_mfma_f32_16x16x16_bf16 v[72:75], v[112:113], v[24:25], v[20:23]
    v_mfma_f32_16x16x16_bf16 v[68:71], v[114:115], v[24:25], v[20:23]
    v_mfma_f32_16x16x16_bf16 v[64:67], v[116:117], v[24:25], v[20:23]
    s_nop 1
    ds_read_b64 v[100:101], v28 offset:14336
    ds_read_b64 v[102:103], v28 offset:12288
    ds_read_b64 v[104:105], v28 offset:10240
    ds_read_b64 v[106:107], v28 offset:8192
    ds_read_b64 v[108:109], v28 offset:6144
    ds_read_b64 v[110:111], v28 offset:4096
    ds_read_b64 v[112:113], v28 offset:2048
    ds_read_b64 v[114:115], v28 offset:0
    s_waitcnt lgkmcnt(0)
    v_mfma_f32_16x16x16_bf16 v[60:63], v[100:101], v[24:25], v[20:23]
    v_mfma_f32_16x16x16_bf16 v[56:59], v[102:103], v[24:25], v[20:23]
    v_mfma_f32_16x16x16_bf16 v[52:55], v[104:105], v[24:25], v[20:23]
    v_mfma_f32_16x16x16_bf16 v[48:51], v[106:107], v[24:25], v[20:23]
    v_mfma_f32_16x16x16_bf16 v[44:47], v[108:109], v[24:25], v[20:23]
    v_mfma_f32_16x16x16_bf16 v[40:43], v[110:111], v[24:25], v[20:23]
    v_mfma_f32_16x16x16_bf16 v[36:39], v[112:113], v[24:25], v[20:23]
    v_mfma_f32_16x16x16_bf16 v[32:35], v[114:115], v[24:25], v[16:19]
    s_nop 1
    v_add_u32 v9, 0, v11
    v_xor_b32 v9, v9, v8
    v_lshl_add_u32 v9, v9, 4, v30
    ds_read_b64 v[100:101], v9
    v_add_u32 v9, 2, v11
    v_xor_b32 v9, v9, v8
    v_lshl_add_u32 v9, v9, 4, v30
    ds_read_b64 v[102:103], v9
    v_add_u32 v9, 4, v11
    v_xor_b32 v9, v9, v8
    v_lshl_add_u32 v9, v9, 4, v30
    ds_read_b64 v[104:105], v9
    v_add_u32 v9, 6, v11
    v_xor_b32 v9, v9, v8
    v_lshl_add_u32 v9, v9, 4, v30
    ds_read_b64 v[106:107], v9
    v_add_u32 v9, 8, v11
    v_xor_b32 v9, v9, v8
    v_lshl_add_u32 v9, v9, 4, v30
    ds_read_b64 v[108:109], v9
    v_add_u32 v9, 10, v11
    v_xor_b32 v9, v9, v8
    v_lshl_add_u32 v9, v9, 4, v30
    ds_read_b64 v[110:111], v9
    v_add_u32 v9, 12, v11
    v_xor_b32 v9, v9, v8
    v_lshl_add_u32 v9, v9, 4, v30
    ds_read_b64 v[112:113], v9
    v_add_u32 v9, 14, v11
    v_xor_b32 v9, v9, v8
    v_lshl_add_u32 v9, v9, 4, v30
    ds_read_b64 v[114:115], v9
    v_add_u32 v9, 16, v11
    v_xor_b32 v9, v9, v8
    v_lshl_add_u32 v9, v9, 4, v30
    ds_read_b64 v[116:117], v9
    v_max3_f32 v26, v96, v97, v98
    v_max3_f32 v27, v99, v92, v93
    v_max3_f32 v26, v26, v94, v95
    v_max3_f32 v27, v27, v88, v89
    v_max3_f32 v26, v26, v90, v91
    v_max3_f32 v27, v27, v84, v85
    v_max3_f32 v26, v26, v86, v87
    v_max3_f32 v27, v27, v80, v81
    v_max3_f32 v26, v26, v82, v83
    v_max3_f32 v27, v27, v76, v77
    v_max3_f32 v26, v26, v78, v79
    v_max3_f32 v27, v27, v72, v73
    v_max3_f32 v26, v26, v74, v75
    v_max3_f32 v27, v27, v68, v69
    v_max3_f32 v26, v26, v70, v71
    v_max3_f32 v27, v27, v64, v65
    v_max3_f32 v26, v26, v66, v67
    v_max3_f32 v27, v27, v60, v61
    v_max3_f32 v26, v26, v62, v63
    v_max3_f32 v27, v27, v56, v57
    v_max3_f32 v26, v26, v58, v59
    v_max3_f32 v27, v27, v52, v53
    v_max3_f32 v26, v26, v54, v55
    v_max3_f32 v27, v27, v48, v49
    v_max3_f32 v26, v26, v50, v51
    v_max3_f32 v27, v27, v44, v45
    v_max3_f32 v26, v26, v46, v47
    v_max3_f32 v27, v27, v40, v41
    v_max3_f32 v26, v26, v42, v43
    v_max3_f32 v27, v27, v36, v37
    v_max3_f32 v26, v26, v38, v39
    v_max3_f32 v27, v27, v32, v33
    v_max3_f32 v26, v26, v34, v35
    v_max_f32 v26, v26, v27
    v_mov_b32 v27, v26
    s_nop 1
    v_permlane16_swap_b32 v26, v27
    s_nop 1
    v_max_f32 v26, v26, v27
    v_mov_b32 v27, v26
    s_nop 1
    v_permlane32_swap_b32 v26, v27
    s_nop 1
    v_max_f32 v26, v26, v27
    s_mov_b32 s41, 0x3eb8aa3b
    v_mul_f32 v24, s41, v26
    v_sub_f32 v24, 0, v24
    v_mov_b32 v26, s41
    v_pk_fma_f32 v[32:33], v[32:33], v[26:27], v[24:25] op_sel_hi:[1,0,0]
    v_pk_fma_f32 v[34:35], v[34:35], v[26:27], v[24:25] op_sel_hi:[1,0,0]
    v_exp_f32 v32, v32
    v_exp_f32 v33, v33
    v_exp_f32 v34, v34
    v_exp_f32 v35, v35
    v_pk_fma_f32 v[36:37], v[36:37], v[26:27], v[24:25] op_sel_hi:[1,0,0]
    v_pk_fma_f32 v[38:39], v[38:39], v[26:27], v[24:25] op_sel_hi:[1,0,0]
    v_exp_f32 v36, v36
    v_exp_f32 v37, v37
    v_exp_f32 v38, v38
    v_exp_f32 v39, v39
    v_cvt_pk_bf16_f32 v32, v32, v33
    v_cvt_pk_bf16_f32 v33, v34, v35
    v_pk_fma_f32 v[40:41], v[40:41], v[26:27], v[24:25] op_sel_hi:[1,0,0]
    v_pk_fma_f32 v[42:43], v[42:43], v[26:27], v[24:25] op_sel_hi:[1,0,0]
    v_exp_f32 v40, v40
    v_exp_f32 v41, v41
    v_exp_f32 v42, v42
    v_exp_f32 v43, v43
    v_cvt_pk_bf16_f32 v34, v36, v37
    v_cvt_pk_bf16_f32 v35, v38, v39
    v_pk_fma_f32 v[44:45], v[44:45], v[26:27], v[24:25] op_sel_hi:[1,0,0]
    v_pk_fma_f32 v[46:47], v[46:47], v[26:27], v[24:25] op_sel_hi:[1,0,0]
    v_exp_f32 v44, v44
    v_exp_f32 v45, v45
    v_exp_f32 v46, v46
    v_exp_f32 v47, v47
    v_cvt_pk_bf16_f32 v36, v40, v41
    v_cvt_pk_bf16_f32 v37, v42, v43
    v_pk_fma_f32 v[48:49], v[48:49], v[26:27], v[24:25] op_sel_hi:[1,0,0]
    v_pk_fma_f32 v[50:51], v[50:51], v[26:27], v[24:25] op_sel_hi:[1,0,0]
    v_exp_f32 v48, v48
    v_exp_f32 v49, v49
    v_exp_f32 v50, v50
    v_exp_f32 v51, v51
    v_cvt_pk_bf16_f32 v38, v44, v45
    v_cvt_pk_bf16_f32 v39, v46, v47
    v_pk_fma_f32 v[52:53], v[52:53], v[26:27], v[24:25] op_sel_hi:[1,0,0]
    v_pk_fma_f32 v[54:55], v[54:55], v[26:27], v[24:25] op_sel_hi:[1,0,0]
    v_exp_f32 v52, v52
    v_exp_f32 v53, v53
    v_exp_f32 v54, v54
    v_exp_f32 v55, v55
    v_cvt_pk_bf16_f32 v40, v48, v49
    v_cvt_pk_bf16_f32 v41, v50, v51
    v_pk_fma_f32 v[56:57], v[56:57], v[26:27], v[24:25] op_sel_hi:[1,0,0]
    v_pk_fma_f32 v[58:59], v[58:59], v[26:27], v[24:25] op_sel_hi:[1,0,0]
    v_exp_f32 v56, v56
    v_exp_f32 v57, v57
    v_exp_f32 v58, v58
    v_exp_f32 v59, v59
    v_cvt_pk_bf16_f32 v42, v52, v53
    v_cvt_pk_bf16_f32 v43, v54, v55
    v_pk_fma_f32 v[60:61], v[60:61], v[26:27], v[24:25] op_sel_hi:[1,0,0]
    v_pk_fma_f32 v[62:63], v[62:63], v[26:27], v[24:25] op_sel_hi:[1,0,0]
    v_exp_f32 v60, v60
    v_exp_f32 v61, v61
    v_exp_f32 v62, v62
    v_exp_f32 v63, v63
    v_cvt_pk_bf16_f32 v44, v56, v57
    v_cvt_pk_bf16_f32 v45, v58, v59
    v_pk_fma_f32 v[64:65], v[64:65], v[26:27], v[24:25] op_sel_hi:[1,0,0]
    v_pk_fma_f32 v[66:67], v[66:67], v[26:27], v[24:25] op_sel_hi:[1,0,0]
    v_exp_f32 v64, v64
    v_exp_f32 v65, v65
    v_exp_f32 v66, v66
    v_exp_f32 v67, v67
    v_cvt_pk_bf16_f32 v46, v60, v61
    v_cvt_pk_bf16_f32 v47, v62, v63
    v_pk_fma_f32 v[68:69], v[68:69], v[26:27], v[24:25] op_sel_hi:[1,0,0]
    v_pk_fma_f32 v[70:71], v[70:71], v[26:27], v[24:25] op_sel_hi:[1,0,0]
    v_exp_f32 v68, v68
    v_exp_f32 v69, v69
    v_exp_f32 v70, v70
    v_exp_f32 v71, v71
    v_cvt_pk_bf16_f32 v48, v64, v65
    v_cvt_pk_bf16_f32 v49, v66, v67
    v_pk_fma_f32 v[72:73], v[72:73], v[26:27], v[24:25] op_sel_hi:[1,0,0]
    v_pk_fma_f32 v[74:75], v[74:75], v[26:27], v[24:25] op_sel_hi:[1,0,0]
    v_exp_f32 v72, v72
    v_exp_f32 v73, v73
    v_exp_f32 v74, v74
    v_exp_f32 v75, v75
    v_cvt_pk_bf16_f32 v50, v68, v69
    v_cvt_pk_bf16_f32 v51, v70, v71
    v_pk_fma_f32 v[76:77], v[76:77], v[26:27], v[24:25] op_sel_hi:[1,0,0]
    v_pk_fma_f32 v[78:79], v[78:79], v[26:27], v[24:25] op_sel_hi:[1,0,0]
    v_exp_f32 v76, v76
    v_exp_f32 v77, v77
    v_exp_f32 v78, v78
    v_exp_f32 v79, v79
    v_cvt_pk_bf16_f32 v52, v72, v73
    v_cvt_pk_bf16_f32 v53, v74, v75
    v_pk_fma_f32 v[80:81], v[80:81], v[26:27], v[24:25] op_sel_hi:[1,0,0]
    v_pk_fma_f32 v[82:83], v[82:83], v[26:27], v[24:25] op_sel_hi:[1,0,0]
    v_exp_f32 v80, v80
    v_exp_f32 v81, v81
    v_exp_f32 v82, v82
    v_exp_f32 v83, v83
    v_cvt_pk_bf16_f32 v54, v76, v77
    v_cvt_pk_bf16_f32 v55, v78, v79
    v_pk_fma_f32 v[84:85], v[84:85], v[26:27], v[24:25] op_sel_hi:[1,0,0]
    v_pk_fma_f32 v[86:87], v[86:87], v[26:27], v[24:25] op_sel_hi:[1,0,0]
    v_exp_f32 v84, v84
    v_exp_f32 v85, v85
    v_exp_f32 v86, v86
    v_exp_f32 v87, v87
    v_cvt_pk_bf16_f32 v56, v80, v81
    v_cvt_pk_bf16_f32 v57, v82, v83
    v_pk_fma_f32 v[88:89], v[88:89], v[26:27], v[24:25] op_sel_hi:[1,0,0]
    v_pk_fma_f32 v[90:91], v[90:91], v[26:27], v[24:25] op_sel_hi:[1,0,0]
    v_exp_f32 v88, v88
    v_exp_f32 v89, v89
    v_exp_f32 v90, v90
    v_exp_f32 v91, v91
    v_cvt_pk_bf16_f32 v58, v84, v85
    v_cvt_pk_bf16_f32 v59, v86, v87
    v_pk_fma_f32 v[92:93], v[92:93], v[26:27], v[24:25] op_sel_hi:[1,0,0]
    v_pk_fma_f32 v[94:95], v[94:95], v[26:27], v[24:25] op_sel_hi:[1,0,0]
    v_exp_f32 v92, v92
    v_exp_f32 v93, v93
    v_exp_f32 v94, v94
    v_exp_f32 v95, v95
    v_cvt_pk_bf16_f32 v60, v88, v89
    v_cvt_pk_bf16_f32 v61, v90, v91
    v_pk_fma_f32 v[96:97], v[96:97], v[26:27], v[24:25] op_sel_hi:[1,0,0]
    v_pk_fma_f32 v[98:99], v[98:99], v[26:27], v[24:25] op_sel_hi:[1,0,0]
    v_exp_f32 v96, v96
    v_exp_f32 v97, v97
    v_exp_f32 v98, v98
    v_exp_f32 v99, v99
    v_cvt_pk_bf16_f32 v62, v92, v93
    v_cvt_pk_bf16_f32 v63, v94, v95
    s_nop 0
    v_cvt_pk_bf16_f32 v64, v96, v97
    v_cvt_pk_bf16_f32 v65, v98, v99
    v_add_u32 v9, 18, v11
    v_xor_b32 v9, v9, v8
    v_lshl_add_u32 v9, v9, 4, v30
    ds_read_b64 v[70:71], v9
    v_add_u32 v9, 20, v11
    v_xor_b32 v9, v9, v8
    v_lshl_add_u32 v9, v9, 4, v30
    ds_read_b64 v[72:73], v9
    v_add_u32 v9, 22, v11
    v_xor_b32 v9, v9, v8
    v_lshl_add_u32 v9, v9, 4, v30
    ds_read_b64 v[74:75], v9
    v_add_u32 v9, 24, v11
    v_xor_b32 v9, v9, v8
    v_lshl_add_u32 v9, v9, 4, v30
    ds_read_b64 v[76:77], v9
    v_add_u32 v9, 26, v11
    v_xor_b32 v9, v9, v8
    v_lshl_add_u32 v9, v9, 4, v30
    ds_read_b64 v[78:79], v9
    v_add_u32 v9, 28, v11
    v_xor_b32 v9, v9, v8
    v_lshl_add_u32 v9, v9, 4, v30
    ds_read_b64 v[80:81], v9
    v_add_u32 v9, 30, v11
    v_xor_b32 v9, v9, v8
    v_lshl_add_u32 v9, v9, 4, v30
    ds_read_b64 v[82:83], v9
    v_add_u32 v9, 32, v11
    v_xor_b32 v9, v9, v8
    v_lshl_add_u32 v9, v9, 4, v30
    ds_read_b64 v[84:85], v9
    s_mov_b32 s41, 0x3f803f80
    v_mov_b32 v12, s41
    v_mov_b32 v16, 0
    v_mov_b32 v20, 0
    v_mov_b32 v13, s41
    v_mov_b32 v17, 0
    v_mov_b32 v21, 0
    v_mov_b32 v14, s41
    v_mov_b32 v18, 0
    v_mov_b32 v22, 0
    v_mov_b32 v15, s41
    v_mov_b32 v19, 0
    v_mov_b32 v23, 0
    s_waitcnt lgkmcnt(8)
    v_mov_b32 v68, v116
    v_mov_b32 v69, v117
    s_nop 1
    v_mfma_f32_16x16x32_bf16 v[16:19], v[100:103], v[32:35], v[16:19]
    v_mfma_f32_16x16x32_bf16 v[20:23], v[12:15], v[32:35], v[20:23]
    v_mfma_f32_16x16x32_bf16 v[16:19], v[104:107], v[36:39], v[16:19]
    v_mfma_f32_16x16x32_bf16 v[20:23], v[12:15], v[36:39], v[20:23]
    v_mfma_f32_16x16x32_bf16 v[16:19], v[108:111], v[40:43], v[16:19]
    v_mfma_f32_16x16x32_bf16 v[20:23], v[12:15], v[40:43], v[20:23]
    v_mfma_f32_16x16x32_bf16 v[16:19], v[112:115], v[44:47], v[16:19]
    v_mfma_f32_16x16x32_bf16 v[20:23], v[12:15], v[44:47], v[20:23]
    s_waitcnt lgkmcnt(0)
    v_mfma_f32_16x16x32_bf16 v[16:19], v[68:71], v[48:51], v[16:19]
    v_mfma_f32_16x16x32_bf16 v[20:23], v[12:15], v[48:51], v[20:23]
    v_mfma_f32_16x16x32_bf16 v[16:19], v[72:75], v[52:55], v[16:19]
    v_mfma_f32_16x16x32_bf16 v[20:23], v[12:15], v[52:55], v[20:23]
    v_mfma_f32_16x16x32_bf16 v[16:19], v[76:79], v[56:59], v[16:19]
    v_mfma_f32_16x16x32_bf16 v[20:23], v[12:15], v[56:59], v[20:23]
    v_mfma_f32_16x16x32_bf16 v[16:19], v[80:83], v[60:63], v[16:19]
    v_mfma_f32_16x16x32_bf16 v[20:23], v[12:15], v[60:63], v[20:23]
    s_nop 3
    v_mfma_f32_16x16x16_bf16 v[16:19], v[84:85], v[64:65], v[16:19]
    v_mfma_f32_16x16x16_bf16 v[20:23], v[12:13], v[64:65], v[20:23]
    s_lshl_b32 s27, s31, 4
    s_add_u32 s27, s27, s25
    s_lshl_b32 s27, s27, 10
    s_lshl_b32 s28, s26, 2
    s_add_u32 s28, s28, s32
    s_lshl_b32 s28, s28, 5
    s_add_u32 s27, s27, s28
    s_add_u32 s27, s27, 6291456
    s_nop 3
    v_rcp_f32 v20, v20
    s_nop 0
    v_mul_f32 v16, v16, v20
    v_mul_f32 v17, v17, v20
    v_mul_f32 v18, v18, v20
    v_mul_f32 v19, v19, v20
    v_cvt_pk_bf16_f32 v12, v16, v17
    v_cvt_pk_bf16_f32 v13, v18, v19
    buffer_store_dwordx2 v[12:13], v31, s[16:19], s27 offen
    s_endpgm
k2_attn_kernel_edge:
    ds_read_b64 v[24:25], v29
    ds_read_b64 v[100:101], v28 offset:32768
    ds_read_b64 v[102:103], v28 offset:30720
    ds_read_b64 v[104:105], v28 offset:28672
    ds_read_b64 v[106:107], v28 offset:26624
    ds_read_b64 v[108:109], v28 offset:24576
    ds_read_b64 v[110:111], v28 offset:22528
    ds_read_b64 v[112:113], v28 offset:20480
    ds_read_b64 v[114:115], v28 offset:18432
    ds_read_b64 v[116:117], v28 offset:16384
    s_waitcnt lgkmcnt(0)
    v_mfma_f32_16x16x16_bf16 v[96:99], v[100:101], v[24:25], v[12:15]
    s_add_i32 s27, s28, 240
    s_cmp_ge_i32 s27, 0
    s_cbranch_scc1 k2_attn_kernel_eok15
    s_nop 2
    v_mov_b32 v20, v10
    v_mov_b32 v16, v10
    v_mov_b32 v21, v10
    v_mov_b32 v17, v10
    v_mov_b32 v22, v10
    v_mov_b32 v18, v10
    v_mov_b32 v23, v10
    v_mov_b32 v19, v10
    s_nop 1
k2_attn_kernel_eok15:
    v_mfma_f32_16x16x16_bf16 v[92:95], v[102:103], v[24:25], v[20:23]
    s_add_i32 s27, s28, 224
    s_cmp_ge_i32 s27, 0
    s_cbranch_scc1 k2_attn_kernel_eok14
    s_nop 2
    v_mov_b32 v20, v10
    v_mov_b32 v16, v10
    v_mov_b32 v21, v10
    v_mov_b32 v17, v10
    v_mov_b32 v22, v10
    v_mov_b32 v18, v10
    v_mov_b32 v23, v10
    v_mov_b32 v19, v10
    s_nop 1
k2_attn_kernel_eok14:
    v_mfma_f32_16x16x16_bf16 v[88:91], v[104:105], v[24:25], v[20:23]
    s_add_i32 s27, s28, 208
    s_cmp_ge_i32 s27, 0
    s_cbranch_scc1 k2_attn_kernel_eok13
    s_nop 2
    v_mov_b32 v20, v10
    v_mov_b32 v16, v10
    v_mov_b32 v21, v10
    v_mov_b32 v17, v10
    v_mov_b32 v22, v10
    v_mov_b32 v18, v10
    v_mov_b32 v23, v10
    v_mov_b32 v19, v10
    s_nop 1
k2_attn_kernel_eok13:
    v_mfma_f32_16x16x16_bf16 v[84:87], v[106:107], v[24:25], v[20:23]
    s_add_i32 s27, s28, 192
    s_cmp_ge_i32 s27, 0
    s_cbranch_scc1 k2_attn_kernel_eok12
    s_nop 2
    v_mov_b32 v20, v10
    v_mov_b32 v16, v10
    v_mov_b32 v21, v10
    v_mov_b32 v17, v10
    v_mov_b32 v22, v10
    v_mov_b32 v18, v10
    v_mov_b32 v23, v10
    v_mov_b32 v19, v10
    s_nop 1
k2_attn_kernel_eok12:
    v_mfma_f32_16x16x16_bf16 v[80:83], v[108:109], v[24:25], v[20:23]
    s_add_i32 s27, s28, 176
    s_cmp_ge_i32 s27, 0
    s_cbranch_scc1 k2_attn_kernel_eok11
    s_nop 2
    v_mov_b32 v20, v10
    v_mov_b32 v16, v10
    v_mov_b32 v21, v10
    v_mov_b32 v17, v10
    v_mov_b32 v22, v10
    v_mov_b32 v18, v10
    v_mov_b32 v23, v10
    v_mov_b32 v19, v10
    s_nop 1
k2_attn_kernel_eok11:
    v_mfma_f32_16x16x16_bf16 v[76:79], v[110:111], v[24:25], v[20:23]
    s_add_i32 s27, s28, 160
    s_cmp_ge_i32 s27, 0
    s_cbranch_scc1 k2_attn_kernel_eok10
    s_nop 2
    v_mov_b32 v20, v10
    v_mov_b32 v16, v10
    v_mov_b32 v21, v10
    v_mov_b32 v17, v10
    v_mov_b32 v22, v10
    v_mov_b32 v18, v10
    v_mov_b32 v23, v10
    v_mov_b32 v19, v10
    s_nop 1
k2_attn_kernel_eok10:
    v_mfma_f32_16x16x16_bf16 v[72:75], v[112:113], v[24:25], v[20:23]
    s_add_i32 s27, s28, 144
    s_cmp_ge_i32 s27, 0
    s_cbranch_scc1 k2_attn_kernel_eok9
    s_nop 2
    v_mov_b32 v20, v10
    v_mov_b32 v16, v10
    v_mov_b32 v21, v10
    v_mov_b32 v17, v10
    v_mov_b32 v22, v10
    v_mov_b32 v18, v10
    v_mov_b32 v23, v10
    v_mov_b32 v19, v10
    s_nop 1
k2_attn_kernel_eok9:
    v_mfma_f32_16x16x16_bf16 v[68:71], v[114:115], v[24:25], v[20:23]
    s_add_i32 s27, s28, 128
    s_cmp_ge_i32 s27, 0
    s_cbranch_scc1 k2_attn_kernel_eok8
    s_nop 2
    v_mov_b32 v20, v10
    v_mov_b32 v16, v10
    v_mov_b32 v21, v10
    v_mov_b32 v17, v10
    v_mov_b32 v22, v10
    v_mov_b32 v18, v10
    v_mov_b32 v23, v10
    v_mov_b32 v19, v10
    s_nop 1
k2_attn_kernel_eok8:
    v_mfma_f32_16x16x16_bf16 v[64:67], v[116:117], v[24:25], v[20:23]
    s_nop 1
    ds_read_b64 v[100:101], v28 offset:14336
    ds_read_b64 v[102:103], v28 offset:12288
    ds_read_b64 v[104:105], v28 offset:10240
    ds_read_b64 v[106:107], v28 offset:8192
    ds_read_b64 v[108:109], v28 offset:6144
    ds_read_b64 v[110:111], v28 offset:4096
    ds_read_b64 v[112:113], v28 offset:2048
    ds_read_b64 v[114:115], v28 offset:0
    s_waitcnt lgkmcnt(0)
    s_add_i32 s27, s28, 112
    s_cmp_ge_i32 s27, 0
    s_cbranch_scc1 k2_attn_kernel_eok7
    s_nop 2
    v_mov_b32 v20, v10
    v_mov_b32 v16, v10
    v_mov_b32 v21, v10
    v_mov_b32 v17, v10
    v_mov_b32 v22, v10
    v_mov_b32 v18, v10
    v_mov_b32 v23, v10
    v_mov_b32 v19, v10
    s_nop 1
k2_attn_kernel_eok7:
    v_mfma_f32_16x16x16_bf16 v[60:63], v[100:101], v[24:25], v[20:23]
    s_add_i32 s27, s28, 96
    s_cmp_ge_i32 s27, 0
    s_cbranch_scc1 k2_attn_kernel_eok6
    s_nop 2
    v_mov_b32 v20, v10
    v_mov_b32 v16, v10
    v_mov_b32 v21, v10
    v_mov_b32 v17, v10
    v_mov_b32 v22, v10
    v_mov_b32 v18, v10
    v_mov_b32 v23, v10
    v_mov_b32 v19, v10
    s_nop 1
k2_attn_kernel_eok6:
    v_mfma_f32_16x16x16_bf16 v[56:59], v[102:103], v[24:25], v[20:23]
    s_add_i32 s27, s28, 80
    s_cmp_ge_i32 s27, 0
    s_cbranch_scc1 k2_attn_kernel_eok5
    s_nop 2
    v_mov_b32 v20, v10
    v_mov_b32 v16, v10
    v_mov_b32 v21, v10
    v_mov_b32 v17, v10
    v_mov_b32 v22, v10
    v_mov_b32 v18, v10
    v_mov_b32 v23, v10
    v_mov_b32 v19, v10
    s_nop 1
k2_attn_kernel_eok5:
    v_mfma_f32_16x16x16_bf16 v[52:55], v[104:105], v[24:25], v[20:23]
    s_add_i32 s27, s28, 64
    s_cmp_ge_i32 s27, 0
    s_cbranch_scc1 k2_attn_kernel_eok4
    s_nop 2
    v_mov_b32 v20, v10
    v_mov_b32 v16, v10
    v_mov_b32 v21, v10
    v_mov_b32 v17, v10
    v_mov_b32 v22, v10
    v_mov_b32 v18, v10
    v_mov_b32 v23, v10
    v_mov_b32 v19, v10
    s_nop 1
k2_attn_kernel_eok4:
    v_mfma_f32_16x16x16_bf16 v[48:51], v[106:107], v[24:25], v[20:23]
    s_add_i32 s27, s28, 48
    s_cmp_ge_i32 s27, 0
    s_cbranch_scc1 k2_attn_kernel_eok3
    s_nop 2
    v_mov_b32 v20, v10
    v_mov_b32 v16, v10
    v_mov_b32 v21, v10
    v_mov_b32 v17, v10
    v_mov_b32 v22, v10
    v_mov_b32 v18, v10
    v_mov_b32 v23, v10
    v_mov_b32 v19, v10
    s_nop 1
k2_attn_kernel_eok3:
    v_mfma_f32_16x16x16_bf16 v[44:47], v[108:109], v[24:25], v[20:23]
    s_add_i32 s27, s28, 32
    s_cmp_ge_i32 s27, 0
    s_cbranch_scc1 k2_attn_kernel_eok2
    s_nop 2
    v_mov_b32 v20, v10
    v_mov_b32 v16, v10
    v_mov_b32 v21, v10
    v_mov_b32 v17, v10
    v_mov_b32 v22, v10
    v_mov_b32 v18, v10
    v_mov_b32 v23, v10
    v_mov_b32 v19, v10
    s_nop 1
k2_attn_kernel_eok2:
    v_mfma_f32_16x16x16_bf16 v[40:43], v[110:111], v[24:25], v[20:23]
    s_add_i32 s27, s28, 16
    s_cmp_ge_i32 s27, 0
    s_cbranch_scc1 k2_attn_kernel_eok1
    s_nop 2
    v_mov_b32 v20, v10
    v_mov_b32 v16, v10
    v_mov_b32 v21, v10
    v_mov_b32 v17, v10
    v_mov_b32 v22, v10
    v_mov_b32 v18, v10
    v_mov_b32 v23, v10
    v_mov_b32 v19, v10
    s_nop 1
k2_attn_kernel_eok1:
    v_mfma_f32_16x16x16_bf16 v[36:39], v[112:113], v[24:25], v[20:23]
    s_add_i32 s27, s28, 0
    s_cmp_ge_i32 s27, 0
    s_cbranch_scc1 k2_attn_kernel_eok0
    s_nop 2
    v_mov_b32 v20, v10
    v_mov_b32 v16, v10
    v_mov_b32 v21, v10
    v_mov_b32 v17, v10
    v_mov_b32 v22, v10
    v_mov_b32 v18, v10
    v_mov_b32 v23, v10
    v_mov_b32 v19, v10
    s_nop 1
k2_attn_kernel_eok0:
    v_mfma_f32_16x16x16_bf16 v[32:35], v[114:115], v[24:25], v[16:19]
    s_nop 1
    v_add_u32 v9, 0, v11
    v_xor_b32 v9, v9, v8
    v_lshl_add_u32 v9, v9, 4, v30
    ds_read_b64 v[100:101], v9
    v_add_u32 v9, 2, v11
    v_xor_b32 v9, v9, v8
    v_lshl_add_u32 v9, v9, 4, v30
    ds_read_b64 v[102:103], v9
    v_add_u32 v9, 4, v11
    v_xor_b32 v9, v9, v8
    v_lshl_add_u32 v9, v9, 4, v30
    ds_read_b64 v[104:105], v9
    v_add_u32 v9, 6, v11
    v_xor_b32 v9, v9, v8
    v_lshl_add_u32 v9, v9, 4, v30
    ds_read_b64 v[106:107], v9
    v_add_u32 v9, 8, v11
    v_xor_b32 v9, v9, v8
    v_lshl_add_u32 v9, v9, 4, v30
    ds_read_b64 v[108:109], v9
    v_add_u32 v9, 10, v11
    v_xor_b32 v9, v9, v8
    v_lshl_add_u32 v9, v9, 4, v30
    ds_read_b64 v[110:111], v9
    v_add_u32 v9, 12, v11
    v_xor_b32 v9, v9, v8
    v_lshl_add_u32 v9, v9, 4, v30
    ds_read_b64 v[112:113], v9
    v_add_u32 v9, 14, v11
    v_xor_b32 v9, v9, v8
    v_lshl_add_u32 v9, v9, 4, v30
    ds_read_b64 v[114:115], v9
    v_add_u32 v9, 16, v11
    v_xor_b32 v9, v9, v8
    v_lshl_add_u32 v9, v9, 4, v30
    ds_read_b64 v[116:117], v9
    v_max3_f32 v26, v96, v97, v98
    v_max3_f32 v27, v99, v92, v93
    v_max3_f32 v26, v26, v94, v95
    v_max3_f32 v27, v27, v88, v89
    v_max3_f32 v26, v26, v90, v91
    v_max3_f32 v27, v27, v84, v85
    v_max3_f32 v26, v26, v86, v87
    v_max3_f32 v27, v27, v80, v81
    v_max3_f32 v26, v26, v82, v83
    v_max3_f32 v27, v27, v76, v77
    v_max3_f32 v26, v26, v78, v79
    v_max3_f32 v27, v27, v72, v73
    v_max3_f32 v26, v26, v74, v75
    v_max3_f32 v27, v27, v68, v69
    v_max3_f32 v26, v26, v70, v71
    v_max3_f32 v27, v27, v64, v65
    v_max3_f32 v26, v26, v66, v67
    v_max3_f32 v27, v27, v60, v61
    v_max3_f32 v26, v26, v62, v63
    v_max3_f32 v27, v27, v56, v57
    v_max3_f32 v26, v26, v58, v59
    v_max3_f32 v27, v27, v52, v53
    v_max3_f32 v26, v26, v54, v55
    v_max3_f32 v27, v27, v48, v49
    v_max3_f32 v26, v26, v50, v51
    v_max3_f32 v27, v27, v44, v45
    v_max3_f32 v26, v26, v46, v47
    v_max3_f32 v27, v27, v40, v41
    v_max3_f32 v26, v26, v42, v43
    v_max3_f32 v27, v27, v36, v37
    v_max3_f32 v26, v26, v38, v39
    v_max3_f32 v27, v27, v32, v33
    v_max3_f32 v26, v26, v34, v35
    v_max_f32 v26, v26, v27
    v_mov_b32 v27, v26
    s_nop 1
    v_permlane16_swap_b32 v26, v27
    s_nop 1
    v_max_f32 v26, v26, v27
    v_mov_b32 v27, v26
    s_nop 1
    v_permlane32_swap_b32 v26, v27
    s_nop 1
    v_max_f32 v26, v26, v27
    s_mov_b32 s41, 0x3eb8aa3b
    v_mul_f32 v24, s41, v26
    v_sub_f32 v24, 0, v24
    v_mov_b32 v26, s41
    v_pk_fma_f32 v[32:33], v[32:33], v[26:27], v[24:25] op_sel_hi:[1,0,0]
    v_pk_fma_f32 v[34:35], v[34:35], v[26:27], v[24:25] op_sel_hi:[1,0,0]
    v_exp_f32 v32, v32
    v_exp_f32 v33, v33
    v_exp_f32 v34, v34
    v_exp_f32 v35, v35
    v_pk_fma_f32 v[36:37], v[36:37], v[26:27], v[24:25] op_sel_hi:[1,0,0]
    v_pk_fma_f32 v[38:39], v[38:39], v[26:27], v[24:25] op_sel_hi:[1,0,0]
    v_exp_f32 v36, v36
    v_exp_f32 v37, v37
    v_exp_f32 v38, v38
    v_exp_f32 v39, v39
    v_cvt_pk_bf16_f32 v32, v32, v33
    v_cvt_pk_bf16_f32 v33, v34, v35
    v_pk_fma_f32 v[40:41], v[40:41], v[26:27], v[24:25] op_sel_hi:[1,0,0]
    v_pk_fma_f32 v[42:43], v[42:43], v[26:27], v[24:25] op_sel_hi:[1,0,0]
    v_exp_f32 v40, v40
    v_exp_f32 v41, v41
    v_exp_f32 v42, v42
    v_exp_f32 v43, v43
    v_cvt_pk_bf16_f32 v34, v36, v37
    v_cvt_pk_bf16_f32 v35, v38, v39
    v_pk_fma_f32 v[44:45], v[44:45], v[26:27], v[24:25] op_sel_hi:[1,0,0]
    v_pk_fma_f32 v[46:47], v[46:47], v[26:27], v[24:25] op_sel_hi:[1,0,0]
    v_exp_f32 v44, v44
    v_exp_f32 v45, v45
    v_exp_f32 v46, v46
    v_exp_f32 v47, v47
    v_cvt_pk_bf16_f32 v36, v40, v41
    v_cvt_pk_bf16_f32 v37, v42, v43
    v_pk_fma_f32 v[48:49], v[48:49], v[26:27], v[24:25] op_sel_hi:[1,0,0]
    v_pk_fma_f32 v[50:51], v[50:51], v[26:27], v[24:25] op_sel_hi:[1,0,0]
    v_exp_f32 v48, v48
    v_exp_f32 v49, v49
    v_exp_f32 v50, v50
    v_exp_f32 v51, v51
    v_cvt_pk_bf16_f32 v38, v44, v45
    v_cvt_pk_bf16_f32 v39, v46, v47
    v_pk_fma_f32 v[52:53], v[52:53], v[26:27], v[24:25] op_sel_hi:[1,0,0]
    v_pk_fma_f32 v[54:55], v[54:55], v[26:27], v[24:25] op_sel_hi:[1,0,0]
    v_exp_f32 v52, v52
    v_exp_f32 v53, v53
    v_exp_f32 v54, v54
    v_exp_f32 v55, v55
    v_cvt_pk_bf16_f32 v40, v48, v49
    v_cvt_pk_bf16_f32 v41, v50, v51
    v_pk_fma_f32 v[56:57], v[56:57], v[26:27], v[24:25] op_sel_hi:[1,0,0]
    v_pk_fma_f32 v[58:59], v[58:59], v[26:27], v[24:25] op_sel_hi:[1,0,0]
    v_exp_f32 v56, v56
    v_exp_f32 v57, v57
    v_exp_f32 v58, v58
    v_exp_f32 v59, v59
    v_cvt_pk_bf16_f32 v42, v52, v53
    v_cvt_pk_bf16_f32 v43, v54, v55
    v_pk_fma_f32 v[60:61], v[60:61], v[26:27], v[24:25] op_sel_hi:[1,0,0]
    v_pk_fma_f32 v[62:63], v[62:63], v[26:27], v[24:25] op_sel_hi:[1,0,0]
    v_exp_f32 v60, v60
    v_exp_f32 v61, v61
    v_exp_f32 v62, v62
    v_exp_f32 v63, v63
    v_cvt_pk_bf16_f32 v44, v56, v57
    v_cvt_pk_bf16_f32 v45, v58, v59
    v_pk_fma_f32 v[64:65], v[64:65], v[26:27], v[24:25] op_sel_hi:[1,0,0]
    v_pk_fma_f32 v[66:67], v[66:67], v[26:27], v[24:25] op_sel_hi:[1,0,0]
    v_exp_f32 v64, v64
    v_exp_f32 v65, v65
    v_exp_f32 v66, v66
    v_exp_f32 v67, v67
    v_cvt_pk_bf16_f32 v46, v60, v61
    v_cvt_pk_bf16_f32 v47, v62, v63
    v_pk_fma_f32 v[68:69], v[68:69], v[26:27], v[24:25] op_sel_hi:[1,0,0]
    v_pk_fma_f32 v[70:71], v[70:71], v[26:27], v[24:25] op_sel_hi:[1,0,0]
    v_exp_f32 v68, v68
    v_exp_f32 v69, v69
    v_exp_f32 v70, v70
    v_exp_f32 v71, v71
    v_cvt_pk_bf16_f32 v48, v64, v65
    v_cvt_pk_bf16_f32 v49, v66, v67
    v_pk_fma_f32 v[72:73], v[72:73], v[26:27], v[24:25] op_sel_hi:[1,0,0]
    v_pk_fma_f32 v[74:75], v[74:75], v[26:27], v[24:25] op_sel_hi:[1,0,0]
    v_exp_f32 v72, v72
    v_exp_f32 v73, v73
    v_exp_f32 v74, v74
    v_exp_f32 v75, v75
    v_cvt_pk_bf16_f32 v50, v68, v69
    v_cvt_pk_bf16_f32 v51, v70, v71
    v_pk_fma_f32 v[76:77], v[76:77], v[26:27], v[24:25] op_sel_hi:[1,0,0]
    v_pk_fma_f32 v[78:79], v[78:79], v[26:27], v[24:25] op_sel_hi:[1,0,0]
    v_exp_f32 v76, v76
    v_exp_f32 v77, v77
    v_exp_f32 v78, v78
    v_exp_f32 v79, v79
    v_cvt_pk_bf16_f32 v52, v72, v73
    v_cvt_pk_bf16_f32 v53, v74, v75
    v_pk_fma_f32 v[80:81], v[80:81], v[26:27], v[24:25] op_sel_hi:[1,0,0]
    v_pk_fma_f32 v[82:83], v[82:83], v[26:27], v[24:25] op_sel_hi:[1,0,0]
    v_exp_f32 v80, v80
    v_exp_f32 v81, v81
    v_exp_f32 v82, v82
    v_exp_f32 v83, v83
    v_cvt_pk_bf16_f32 v54, v76, v77
    v_cvt_pk_bf16_f32 v55, v78, v79
    v_pk_fma_f32 v[84:85], v[84:85], v[26:27], v[24:25] op_sel_hi:[1,0,0]
    v_pk_fma_f32 v[86:87], v[86:87], v[26:27], v[24:25] op_sel_hi:[1,0,0]
    v_exp_f32 v84, v84
    v_exp_f32 v85, v85
    v_exp_f32 v86, v86
    v_exp_f32 v87, v87
    v_cvt_pk_bf16_f32 v56, v80, v81
    v_cvt_pk_bf16_f32 v57, v82, v83
    v_pk_fma_f32 v[88:89], v[88:89], v[26:27], v[24:25] op_sel_hi:[1,0,0]
    v_pk_fma_f32 v[90:91], v[90:91], v[26:27], v[24:25] op_sel_hi:[1,0,0]
    v_exp_f32 v88, v88
    v_exp_f32 v89, v89
    v_exp_f32 v90, v90
    v_exp_f32 v91, v91
    v_cvt_pk_bf16_f32 v58, v84, v85
    v_cvt_pk_bf16_f32 v59, v86, v87
    v_pk_fma_f32 v[92:93], v[92:93], v[26:27], v[24:25] op_sel_hi:[1,0,0]
    v_pk_fma_f32 v[94:95], v[94:95], v[26:27], v[24:25] op_sel_hi:[1,0,0]
    v_exp_f32 v92, v92
    v_exp_f32 v93, v93
    v_exp_f32 v94, v94
    v_exp_f32 v95, v95
    v_cvt_pk_bf16_f32 v60, v88, v89
    v_cvt_pk_bf16_f32 v61, v90, v91
    v_pk_fma_f32 v[96:97], v[96:97], v[26:27], v[24:25] op_sel_hi:[1,0,0]
    v_pk_fma_f32 v[98:99], v[98:99], v[26:27], v[24:25] op_sel_hi:[1,0,0]
    v_exp_f32 v96, v96
    v_exp_f32 v97, v97
    v_exp_f32 v98, v98
    v_exp_f32 v99, v99
    v_cvt_pk_bf16_f32 v62, v92, v93
    v_cvt_pk_bf16_f32 v63, v94, v95
    s_nop 0
    v_cvt_pk_bf16_f32 v64, v96, v97
    v_cvt_pk_bf16_f32 v65, v98, v99
    v_add_u32 v9, 18, v11
    v_xor_b32 v9, v9, v8
    v_lshl_add_u32 v9, v9, 4, v30
    ds_read_b64 v[70:71], v9
    v_add_u32 v9, 20, v11
    v_xor_b32 v9, v9, v8
    v_lshl_add_u32 v9, v9, 4, v30
    ds_read_b64 v[72:73], v9
    v_add_u32 v9, 22, v11
    v_xor_b32 v9, v9, v8
    v_lshl_add_u32 v9, v9, 4, v30
    ds_read_b64 v[74:75], v9
    v_add_u32 v9, 24, v11
    v_xor_b32 v9, v9, v8
    v_lshl_add_u32 v9, v9, 4, v30
    ds_read_b64 v[76:77], v9
    v_add_u32 v9, 26, v11
    v_xor_b32 v9, v9, v8
    v_lshl_add_u32 v9, v9, 4, v30
    ds_read_b64 v[78:79], v9
    v_add_u32 v9, 28, v11
    v_xor_b32 v9, v9, v8
    v_lshl_add_u32 v9, v9, 4, v30
    ds_read_b64 v[80:81], v9
    v_add_u32 v9, 30, v11
    v_xor_b32 v9, v9, v8
    v_lshl_add_u32 v9, v9, 4, v30
    ds_read_b64 v[82:83], v9
    v_add_u32 v9, 32, v11
    v_xor_b32 v9, v9, v8
    v_lshl_add_u32 v9, v9, 4, v30
    ds_read_b64 v[84:85], v9
    s_mov_b32 s41, 0x3f803f80
    v_mov_b32 v12, s41
    v_mov_b32 v16, 0
    v_mov_b32 v20, 0
    v_mov_b32 v13, s41
    v_mov_b32 v17, 0
    v_mov_b32 v21, 0
    v_mov_b32 v14, s41
    v_mov_b32 v18, 0
    v_mov_b32 v22, 0
    v_mov_b32 v15, s41
    v_mov_b32 v19, 0
    v_mov_b32 v23, 0
    s_waitcnt lgkmcnt(8)
    v_mov_b32 v68, v116
    v_mov_b32 v69, v117
    s_nop 1
    v_mfma_f32_16x16x32_bf16 v[16:19], v[100:103], v[32:35], v[16:19]
    v_mfma_f32_16x16x32_bf16 v[20:23], v[12:15], v[32:35], v[20:23]
    v_mfma_f32_16x16x32_bf16 v[16:19], v[104:107], v[36:39], v[16:19]
    v_mfma_f32_16x16x32_bf16 v[20:23], v[12:15], v[36:39], v[20:23]
    v_mfma_f32_16x16x32_bf16 v[16:19], v[108:111], v[40:43], v[16:19]
    v_mfma_f32_16x16x32_bf16 v[20:23], v[12:15], v[40:43], v[20:23]
    v_mfma_f32_16x16x32_bf16 v[16:19], v[112:115], v[44:47], v[16:19]
    v_mfma_f32_16x16x32_bf16 v[20:23], v[12:15], v[44:47], v[20:23]
    s_waitcnt lgkmcnt(0)
    v_mfma_f32_16x16x32_bf16 v[16:19], v[68:71], v[48:51], v[16:19]
    v_mfma_f32_16x16x32_bf16 v[20:23], v[12:15], v[48:51], v[20:23]
    v_mfma_f32_16x16x32_bf16 v[16:19], v[72:75], v[52:55], v[16:19]
    v_mfma_f32_16x16x32_bf16 v[20:23], v[12:15], v[52:55], v[20:23]
    v_mfma_f32_16x16x32_bf16 v[16:19], v[76:79], v[56:59], v[16:19]
    v_mfma_f32_16x16x32_bf16 v[20:23], v[12:15], v[56:59], v[20:23]
    v_mfma_f32_16x16x32_bf16 v[16:19], v[80:83], v[60:63], v[16:19]
    v_mfma_f32_16x16x32_bf16 v[20:23], v[12:15], v[60:63], v[20:23]
    s_nop 3
    v_mfma_f32_16x16x16_bf16 v[16:19], v[84:85], v[64:65], v[16:19]
    v_mfma_f32_16x16x16_bf16 v[20:23], v[12:13], v[64:65], v[20:23]
    s_lshl_b32 s27, s31, 4
    s_add_u32 s27, s27, s25
    s_lshl_b32 s27, s27, 10
    s_lshl_b32 s28, s26, 2
    s_add_u32 s28, s28, s32
    s_lshl_b32 s28, s28, 5
    s_add_u32 s27, s27, s28
    s_add_u32 s27, s27, 6291456
    s_nop 3
    v_rcp_f32 v20, v20
    s_nop 0
    v_mul_f32 v16, v16, v20
    v_mul_f32 v17, v17, v20
    v_mul_f32 v18, v18, v20
    v_mul_f32 v19, v19, v20
    v_cvt_pk_bf16_f32 v12, v16, v17
    v_cvt_pk_bf16_f32 v13, v18, v19
    buffer_store_dwordx2 v[12:13], v31, s[16:19], s27 offen
    s_endpgm
k2_attn_kernel_end:
    s_endpgm
.globl k3_wo_kernel
.p2align 8
.type k3_wo_kernel,@function
k3_wo_kernel:
    s_cmp_ge_u32 s2, 256
    s_cbranch_scc1 k3_wo_kernel_end
    s_load_dwordx2 s[4:5], s[0:1], 64
    s_load_dwordx2 s[6:7], s[0:1], 16
    s_load_dwordx2 s[34:35], s[0:1], 64
    s_load_dwordx2 s[36:37], s[0:1], 48
    s_load_dwordx2 s[38:39], s[0:1], 0
    v_lshrrev_b32 v1, 6, v0
    v_and_b32 v2, 63, v0
    s_lshr_b32 s27, s2, 3
    s_lshr_b32 s28, s27, 3
    s_and_b32 s29, s27, 7
    s_and_b32 s27, s2, 7
    s_mul_i32 s27, s27, 4
    s_add_u32 s28, s28, s27
    v_readfirstlane_b32 s24, v1
    s_mul_i32 s25, s28, 64
    s_mul_i32 s26, s29, 64
    v_and_b32 v3, 15, v2
    v_lshrrev_b32 v4, 4, v2
    s_cmp_ge_u32 s24, 4
    s_cbranch_scc1 k3_wo_kernel_loader
    s_lshr_b32 s30, s24, 1
    s_and_b32 s31, s24, 1
    s_mul_i32 s32, s30, 32
    s_mul_i32 s27, s30, 4096
    s_mul_i32 s33, s31, 32
    s_add_u32 s33, s33, s26
    s_mul_i32 s28, s31, 4096
    s_add_u32 s28, s28, 2048
    s_add_u32 s32, s32, s25
    s_add_u32 s27, s27, 2048
    v_and_b32 v8, 3, v2
    v_bfe_u32 v9, v2, 2, 2
    v_lshl_add_u32 v9, v4, 3, v9
    v_lshlrev_b32 v9, 6, v9
    v_lshl_add_u32 v9, v8, 3, v9
    v_add_u32 v9, s28, v9
    v_and_b32 v10, 1, v4
    v_lshlrev_b32 v10, 5, v10
    v_xor_b32 v11, 32, v10
    v_add_u32 v10, v9, v10
    v_add_u32 v11, v9, v11
    v_lshlrev_b32 v9, 7, v3
    v_add_u32 v9, s27, v9
    v_lshrrev_b32 v8, 1, v3
    v_xor_b32 v12, v4, v8
    v_xor_b32 v13, 4, v12
    v_lshl_add_u32 v12, v12, 4, v9
    v_lshl_add_u32 v13, v13, 4, v9
    v_mov_b32 v80, 0
    v_mov_b32 v81, 0
    v_mov_b32 v82, 0
    v_mov_b32 v83, 0
    v_mov_b32 v84, 0
    v_mov_b32 v85, 0
    v_mov_b32 v86, 0
    v_mov_b32 v87, 0
    v_mov_b32 v88, 0
    v_mov_b32 v89, 0
    v_mov_b32 v90, 0
    v_mov_b32 v91, 0
    v_mov_b32 v92, 0
    v_mov_b32 v93, 0
    v_mov_b32 v94, 0
    v_mov_b32 v95, 0
    s_mov_b32 s45, 0
    s_mov_b32 s46, 4
    s_mov_b32 s40, -114688
    s_waitcnt lgkmcnt(0)
    s_mov_b32 s20, s38
    s_mov_b32 s21, s39
    s_mov_b32 s22, 2097152
    s_mov_b32 s23, 0x00020000
    s_mov_b32 s16, s34
    s_mov_b32 s17, s35
    s_mov_b32 s18, 10485760
    s_mov_b32 s19, 0x00020000
    v_and_b32 v8, 1, v4
    v_lshrrev_b32 v9, 1, v4
    v_lshlrev_b32 v8, 5, v8
    v_lshl_add_u32 v8, v9, 4, v8
    v_lshl_add_u32 v14, v3, 10, v8
    s_lshl_b32 s27, s32, 10
    s_lshl_b32 s28, s33, 1
    s_add_u32 s42, s27, s28
    s_add_u32 s27, s42, 0
    s_add_u32 s28, s27, 16384
    buffer_load_dwordx4 v[96:99], v14, s[20:23], s27 offen
    buffer_load_dwordx4 v[100:103], v14, s[20:23], s28 offen
    s_barrier
    ds_read_b128 v[16:19], v12 offset:0
    ds_read_b128 v[20:23], v12 offset:2048
    ds_read_b64_tr_b16 v[48:49], v10 offset:8192
    ds_read_b64_tr_b16 v[50:51], v10 offset:8448
    ds_read_b64_tr_b16 v[52:53], v11 offset:8192
    ds_read_b64_tr_b16 v[54:55], v11 offset:8448
    ds_read_b128 v[24:27], v13 offset:0
    ds_read_b128 v[28:31], v13 offset:2048
    ds_read_b64_tr_b16 v[56:57], v10 offset:10240
    ds_read_b64_tr_b16 v[58:59], v10 offset:10496
    ds_read_b64_tr_b16 v[60:61], v11 offset:10240
    ds_read_b64_tr_b16 v[62:63], v11 offset:10496
    s_waitcnt lgkmcnt(0)
    s_barrier
    v_add_u32 v10, 16384, v10
    v_add_u32 v11, 16384, v11
    v_add_u32 v12, 16384, v12
    v_add_u32 v13, 16384, v13
    ds_read_b128 v[32:35], v12 offset:0
    v_mfma_f32_16x16x32_bf16 v[80:83], v[48:51], v[16:19], v[80:83]
    ds_read_b128 v[36:39], v12 offset:2048
    ds_read_b64_tr_b16 v[64:65], v10 offset:8192
    v_mfma_f32_16x16x32_bf16 v[88:91], v[48:51], v[20:23], v[88:91]
    ds_read_b64_tr_b16 v[66:67], v10 offset:8448
    v_mfma_f32_16x16x32_bf16 v[84:87], v[52:55], v[16:19], v[84:87]
    ds_read_b64_tr_b16 v[68:69], v11 offset:8192
    ds_read_b64_tr_b16 v[70:71], v11 offset:8448
    v_mfma_f32_16x16x32_bf16 v[92:95], v[52:55], v[20:23], v[92:95]
    ds_read_b128 v[40:43], v13 offset:0
    v_mfma_f32_16x16x32_bf16 v[80:83], v[56:59], v[24:27], v[80:83]
    ds_read_b128 v[44:47], v13 offset:2048
    ds_read_b64_tr_b16 v[72:73], v10 offset:10240
    v_mfma_f32_16x16x32_bf16 v[88:91], v[56:59], v[28:31], v[88:91]
    ds_read_b64_tr_b16 v[74:75], v10 offset:10496
    v_mfma_f32_16x16x32_bf16 v[84:87], v[60:63], v[24:27], v[84:87]
    ds_read_b64_tr_b16 v[76:77], v11 offset:10240
    ds_read_b64_tr_b16 v[78:79], v11 offset:10496
    v_mfma_f32_16x16x32_bf16 v[92:95], v[60:63], v[28:31], v[92:95]
    s_waitcnt lgkmcnt(0)
    s_barrier
    v_add_u32 v10, 16384, v10
    v_add_u32 v11, 16384, v11
    v_add_u32 v12, 16384, v12
    v_add_u32 v13, 16384, v13
    ds_read_b128 v[16:19], v12 offset:0
    v_mfma_f32_16x16x32_bf16 v[80:83], v[64:67], v[32:35], v[80:83]
    ds_read_b128 v[20:23], v12 offset:2048
    ds_read_b64_tr_b16 v[48:49], v10 offset:8192
    v_mfma_f32_16x16x32_bf16 v[88:91], v[64:67], v[36:39], v[88:91]
    ds_read_b64_tr_b16 v[50:51], v10 offset:8448
    v_mfma_f32_16x16x32_bf16 v[84:87], v[68:71], v[32:35], v[84:87]
    ds_read_b64_tr_b16 v[52:53], v11 offset:8192
    ds_read_b64_tr_b16 v[54:55], v11 offset:8448
    v_mfma_f32_16x16x32_bf16 v[92:95], v[68:71], v[36:39], v[92:95]
    ds_read_b128 v[24:27], v13 offset:0
    v_mfma_f32_16x16x32_bf16 v[80:83], v[72:75], v[40:43], v[80:83]
    ds_read_b128 v[28:31], v13 offset:2048
    ds_read_b64_tr_b16 v[56:57], v10 offset:10240
    v_mfma_f32_16x16x32_bf16 v[88:91], v[72:75], v[44:47], v[88:91]
    ds_read_b64_tr_b16 v[58:59], v10 offset:10496
    v_mfma_f32_16x16x32_bf16 v[84:87], v[76:79], v[40:43], v[84:87]
    ds_read_b64_tr_b16 v[60:61], v11 offset:10240
    ds_read_b64_tr_b16 v[62:63], v11 offset:10496
    v_mfma_f32_16x16x32_bf16 v[92:95], v[76:79], v[44:47], v[92:95]
    s_waitcnt lgkmcnt(0)
    s_barrier
    v_add_u32 v10, 16384, v10
    v_add_u32 v11, 16384, v11
    v_add_u32 v12, 16384, v12
    v_add_u32 v13, 16384, v13
    ds_read_b128 v[32:35], v12 offset:0
    v_mfma_f32_16x16x32_bf16 v[80:83], v[48:51], v[16:19], v[80:83]
    ds_read_b128 v[36:39], v12 offset:2048
    ds_read_b64_tr_b16 v[64:65], v10 offset:8192
    v_mfma_f32_16x16x32_bf16 v[88:91], v[48:51], v[20:23], v[88:91]
    ds_read_b64_tr_b16 v[66:67], v10 offset:8448
    v_mfma_f32_16x16x32_bf16 v[84:87], v[52:55], v[16:19], v[84:87]
    ds_read_b64_tr_b16 v[68:69], v11 offset:8192
    ds_read_b64_tr_b16 v[70:71], v11 offset:8448
    v_mfma_f32_16x16x32_bf16 v[92:95], v[52:55], v[20:23], v[92:95]
    ds_read_b128 v[40:43], v13 offset:0
    v_mfma_f32_16x16x32_bf16 v[80:83], v[56:59], v[24:27], v[80:83]
    ds_read_b128 v[44:47], v13 offset:2048
    ds_read_b64_tr_b16 v[72:73], v10 offset:10240
    v_mfma_f32_16x16x32_bf16 v[88:91], v[56:59], v[28:31], v[88:91]
    ds_read_b64_tr_b16 v[74:75], v10 offset:10496
    v_mfma_f32_16x16x32_bf16 v[84:87], v[60:63], v[24:27], v[84:87]
    ds_read_b64_tr_b16 v[76:77], v11 offset:10240
    ds_read_b64_tr_b16 v[78:79], v11 offset:10496
    v_mfma_f32_16x16x32_bf16 v[92:95], v[60:63], v[28:31], v[92:95]
    s_waitcnt lgkmcnt(0)
    s_barrier
    v_add_u32 v10, 16384, v10
    v_add_u32 v11, 16384, v11
    v_add_u32 v12, 16384, v12
    v_add_u32 v13, 16384, v13
    ds_read_b128 v[16:19], v12 offset:0
    v_mfma_f32_16x16x32_bf16 v[80:83], v[64:67], v[32:35], v[80:83]
    ds_read_b128 v[20:23], v12 offset:2048
    ds_read_b64_tr_b16 v[48:49], v10 offset:8192
    v_mfma_f32_16x16x32_bf16 v[88:91], v[64:67], v[36:39], v[88:91]
    ds_read_b64_tr_b16 v[50:51], v10 offset:8448
    v_mfma_f32_16x16x32_bf16 v[84:87], v[68:71], v[32:35], v[84:87]
    ds_read_b64_tr_b16 v[52:53], v11 offset:8192
    ds_read_b64_tr_b16 v[54:55], v11 offset:8448
    v_mfma_f32_16x16x32_bf16 v[92:95], v[68:71], v[36:39], v[92:95]
    ds_read_b128 v[24:27], v13 offset:0
    v_mfma_f32_16x16x32_bf16 v[80:83], v[72:75], v[40:43], v[80:83]
    ds_read_b128 v[28:31], v13 offset:2048
    ds_read_b64_tr_b16 v[56:57], v10 offset:10240
    v_mfma_f32_16x16x32_bf16 v[88:91], v[72:75], v[44:47], v[88:91]
    ds_read_b64_tr_b16 v[58:59], v10 offset:10496
    v_mfma_f32_16x16x32_bf16 v[84:87], v[76:79], v[40:43], v[84:87]
    ds_read_b64_tr_b16 v[60:61], v11 offset:10240
    ds_read_b64_tr_b16 v[62:63], v11 offset:10496
    v_mfma_f32_16x16x32_bf16 v[92:95], v[76:79], v[44:47], v[92:95]
    s_waitcnt lgkmcnt(0)
    s_barrier
    v_add_u32 v10, 16384, v10
    v_add_u32 v11, 16384, v11
    v_add_u32 v12, 16384, v12
    v_add_u32 v13, 16384, v13
    ds_read_b128 v[32:35], v12 offset:0
    v_mfma_f32_16x16x32_bf16 v[80:83], v[48:51], v[16:19], v[80:83]
    ds_read_b128 v[36:39], v12 offset:2048
    ds_read_b64_tr_b16 v[64:65], v10 offset:8192
    v_mfma_f32_16x16x32_bf16 v[88:91], v[48:51], v[20:23], v[88:91]
    ds_read_b64_tr_b16 v[66:67], v10 offset:8448
    v_mfma_f32_16x16x32_bf16 v[84:87], v[52:55], v[16:19], v[84:87]
    ds_read_b64_tr_b16 v[68:69], v11 offset:8192
    ds_read_b64_tr_b16 v[70:71], v11 offset:8448
    v_mfma_f32_16x16x32_bf16 v[92:95], v[52:55], v[20:23], v[92:95]
    ds_read_b128 v[40:43], v13 offset:0
    v_mfma_f32_16x16x32_bf16 v[80:83], v[56:59], v[24:27], v[80:83]
    ds_read_b128 v[44:47], v13 offset:2048
    ds_read_b64_tr_b16 v[72:73], v10 offset:10240
    v_mfma_f32_16x16x32_bf16 v[88:91], v[56:59], v[28:31], v[88:91]
    ds_read_b64_tr_b16 v[74:75], v10 offset:10496
    v_mfma_f32_16x16x32_bf16 v[84:87], v[60:63], v[24:27], v[84:87]
    ds_read_b64_tr_b16 v[76:77], v11 offset:10240
    ds_read_b64_tr_b16 v[78:79], v11 offset:10496
    v_mfma_f32_16x16x32_bf16 v[92:95], v[60:63], v[28:31], v[92:95]
    s_waitcnt lgkmcnt(0)
    s_barrier
    v_add_u32 v10, 16384, v10
    v_add_u32 v11, 16384, v11
    v_add_u32 v12, 16384, v12
    v_add_u32 v13, 16384, v13
    ds_read_b128 v[16:19], v12 offset:0
    v_mfma_f32_16x16x32_bf16 v[80:83], v[64:67], v[32:35], v[80:83]
    ds_read_b128 v[20:23], v12 offset:2048
    ds_read_b64_tr_b16 v[48:49], v10 offset:8192
    v_mfma_f32_16x16x32_bf16 v[88:91], v[64:67], v[36:39], v[88:91]
    ds_read_b64_tr_b16 v[50:51], v10 offset:8448
    v_mfma_f32_16x16x32_bf16 v[84:87], v[68:71], v[32:35], v[84:87]
    ds_read_b64_tr_b16 v[52:53], v11 offset:8192
    ds_read_b64_tr_b16 v[54:55], v11 offset:8448
    v_mfma_f32_16x16x32_bf16 v[92:95], v[68:71], v[36:39], v[92:95]
    ds_read_b128 v[24:27], v13 offset:0
    v_mfma_f32_16x16x32_bf16 v[80:83], v[72:75], v[40:43], v[80:83]
    ds_read_b128 v[28:31], v13 offset:2048
    ds_read_b64_tr_b16 v[56:57], v10 offset:10240
    v_mfma_f32_16x16x32_bf16 v[88:91], v[72:75], v[44:47], v[88:91]
    ds_read_b64_tr_b16 v[58:59], v10 offset:10496
    v_mfma_f32_16x16x32_bf16 v[84:87], v[76:79], v[40:43], v[84:87]
    ds_read_b64_tr_b16 v[60:61], v11 offset:10240
    ds_read_b64_tr_b16 v[62:63], v11 offset:10496
    v_mfma_f32_16x16x32_bf16 v[92:95], v[76:79], v[44:47], v[92:95]
    s_waitcnt lgkmcnt(0)
    s_barrier
    v_add_u32 v10, 16384, v10
    v_add_u32 v11, 16384, v11
    v_add_u32 v12, 16384, v12
    v_add_u32 v13, 16384, v13
    ds_read_b128 v[32:35], v12 offset:0
    v_mfma_f32_16x16x32_bf16 v[80:83], v[48:51], v[16:19], v[80:83]
    ds_read_b128 v[36:39], v12 offset:2048
    ds_read_b64_tr_b16 v[64:65], v10 offset:8192
    v_mfma_f32_16x16x32_bf16 v[88:91], v[48:51], v[20:23], v[88:91]
    ds_read_b64_tr_b16 v[66:67], v10 offset:8448
    v_mfma_f32_16x16x32_bf16 v[84:87], v[52:55], v[16:19], v[84:87]
    ds_read_b64_tr_b16 v[68:69], v11 offset:8192
    ds_read_b64_tr_b16 v[70:71], v11 offset:8448
    v_mfma_f32_16x16x32_bf16 v[92:95], v[52:55], v[20:23], v[92:95]
    ds_read_b128 v[40:43], v13 offset:0
    v_mfma_f32_16x16x32_bf16 v[80:83], v[56:59], v[24:27], v[80:83]
    ds_read_b128 v[44:47], v13 offset:2048
    ds_read_b64_tr_b16 v[72:73], v10 offset:10240
    v_mfma_f32_16x16x32_bf16 v[88:91], v[56:59], v[28:31], v[88:91]
    ds_read_b64_tr_b16 v[74:75], v10 offset:10496
    v_mfma_f32_16x16x32_bf16 v[84:87], v[60:63], v[24:27], v[84:87]
    ds_read_b64_tr_b16 v[76:77], v11 offset:10240
    ds_read_b64_tr_b16 v[78:79], v11 offset:10496
    v_mfma_f32_16x16x32_bf16 v[92:95], v[60:63], v[28:31], v[92:95]
    s_waitcnt lgkmcnt(0)
    s_barrier
    v_add_u32 v10, 4294852608, v10
    v_add_u32 v11, 4294852608, v11
    v_add_u32 v12, 4294852608, v12
    v_add_u32 v13, 4294852608, v13
    ds_read_b128 v[16:19], v12 offset:0
    v_mfma_f32_16x16x32_bf16 v[80:83], v[64:67], v[32:35], v[80:83]
    ds_read_b128 v[20:23], v12 offset:2048
    ds_read_b64_tr_b16 v[48:49], v10 offset:8192
    v_mfma_f32_16x16x32_bf16 v[88:91], v[64:67], v[36:39], v[88:91]
    ds_read_b64_tr_b16 v[50:51], v10 offset:8448
    v_mfma_f32_16x16x32_bf16 v[84:87], v[68:71], v[32:35], v[84:87]
    ds_read_b64_tr_b16 v[52:53], v11 offset:8192
    ds_read_b64_tr_b16 v[54:55], v11 offset:8448
    v_mfma_f32_16x16x32_bf16 v[92:95], v[68:71], v[36:39], v[92:95]
    ds_read_b128 v[24:27], v13 offset:0
    v_mfma_f32_16x16x32_bf16 v[80:83], v[72:75], v[40:43], v[80:83]
    ds_read_b128 v[28:31], v13 offset:2048
    ds_read_b64_tr_b16 v[56:57], v10 offset:10240
    v_mfma_f32_16x16x32_bf16 v[88:91], v[72:75], v[44:47], v[88:91]
    ds_read_b64_tr_b16 v[58:59], v10 offset:10496
    v_mfma_f32_16x16x32_bf16 v[84:87], v[76:79], v[40:43], v[84:87]
    ds_read_b64_tr_b16 v[60:61], v11 offset:10240
    ds_read_b64_tr_b16 v[62:63], v11 offset:10496
    v_mfma_f32_16x16x32_bf16 v[92:95], v[76:79], v[44:47], v[92:95]
    s_waitcnt lgkmcnt(0)
    s_nop 7
    s_waitcnt vmcnt(0)
    v_cvt_pk_bf16_f32 v48, v80, v81
    v_cvt_pk_bf16_f32 v49, v82, v83
    v_cvt_pk_bf16_f32 v50, v84, v85
    v_cvt_pk_bf16_f32 v51, v86, v87
    s_add_u32 s27, s42, 0
    s_nop 0
    v_permlane16_swap_b32 v48, v50
    v_permlane16_swap_b32 v49, v51
    s_nop 0
    v_lshlrev_b32 v8, 16, v48
    v_and_b32 v9, 0xffff0000, v48
    v_lshlrev_b32 v10, 16, v96
    v_and_b32 v11, 0xffff0000, v96
    v_pk_add_f32 v[8:9], v[8:9], v[10:11]
    v_cvt_pk_bf16_f32 v48, v8, v9
    v_lshlrev_b32 v8, 16, v49
    v_and_b32 v9, 0xffff0000, v49
    v_lshlrev_b32 v10, 16, v97
    v_and_b32 v11, 0xffff0000, v97
    v_pk_add_f32 v[8:9], v[8:9], v[10:11]
    v_cvt_pk_bf16_f32 v49, v8, v9
    v_lshlrev_b32 v8, 16, v50
    v_and_b32 v9, 0xffff0000, v50
    v_lshlrev_b32 v10, 16, v98
    v_and_b32 v11, 0xffff0000, v98
    v_pk_add_f32 v[8:9], v[8:9], v[10:11]
    v_cvt_pk_bf16_f32 v50, v8, v9
    v_lshlrev_b32 v8, 16, v51
    v_and_b32 v9, 0xffff0000, v51
    v_lshlrev_b32 v10, 16, v99
    v_and_b32 v11, 0xffff0000, v99
    v_pk_add_f32 v[8:9], v[8:9], v[10:11]
    v_cvt_pk_bf16_f32 v51, v8, v9
    s_add_u32 s27, s27, 8388608
    buffer_store_dwordx4 v[48:51], v14, s[16:19], s27 offen
    v_cvt_pk_bf16_f32 v52, v88, v89
    v_cvt_pk_bf16_f32 v53, v90, v91
    v_cvt_pk_bf16_f32 v54, v92, v93
    v_cvt_pk_bf16_f32 v55, v94, v95
    s_add_u32 s27, s42, 16384
    s_nop 0
    v_permlane16_swap_b32 v52, v54
    v_permlane16_swap_b32 v53, v55
    s_nop 0
    v_lshlrev_b32 v8, 16, v52
    v_and_b32 v9, 0xffff0000, v52
    v_lshlrev_b32 v10, 16, v100
    v_and_b32 v11, 0xffff0000, v100
    v_pk_add_f32 v[8:9], v[8:9], v[10:11]
    v_cvt_pk_bf16_f32 v52, v8, v9
    v_lshlrev_b32 v8, 16, v53
    v_and_b32 v9, 0xffff0000, v53
    v_lshlrev_b32 v10, 16, v101
    v_and_b32 v11, 0xffff0000, v101
    v_pk_add_f32 v[8:9], v[8:9], v[10:11]
    v_cvt_pk_bf16_f32 v53, v8, v9
    v_lshlrev_b32 v8, 16, v54
    v_and_b32 v9, 0xffff0000, v54
    v_lshlrev_b32 v10, 16, v102
    v_and_b32 v11, 0xffff0000, v102
    v_pk_add_f32 v[8:9], v[8:9], v[10:11]
    v_cvt_pk_bf16_f32 v54, v8, v9
    v_lshlrev_b32 v8, 16, v55
    v_and_b32 v9, 0xffff0000, v55
    v_lshlrev_b32 v10, 16, v103
    v_and_b32 v11, 0xffff0000, v103
    v_pk_add_f32 v[8:9], v[8:9], v[10:11]
    v_cvt_pk_bf16_f32 v55, v8, v9
    s_add_u32 s27, s27, 8388608
    buffer_store_dwordx4 v[52:55], v14, s[16:19], s27 offen
    s_endpgm
k3_wo_kernel_loader:
    s_sub_u32 s24, s24, 4
    v_lshrrev_b32 v5, 3, v2
    v_and_b32 v6, 7, v2
    s_mov_b32 s27, 1024
    v_lshrrev_b32 v8, 1, v5
    v_xor_b32 v8, v8, v6
    v_mul_lo_u32 v7, v5, s27
    v_lshl_add_u32 v16, v8, 4, v7
    v_xor_b32 v9, 4, v8
    v_lshl_add_u32 v17, v9, 4, v7
    v_add_u32 v17, 7168, v17
    v_lshrrev_b32 v6, 2, v2
    s_mov_b32 s27, 1024
    v_mul_lo_u32 v6, v6, s27
    v_lshrrev_b32 v9, 5, v2
    v_lshlrev_b32 v9, 1, v9
    v_and_b32 v8, 3, v2
    v_xor_b32 v9, v9, v8
    v_lshl_add_u32 v20, v9, 4, v6
    v_add_u32 v21, 64, v20
    s_mul_i32 s28, s24, 16
    s_add_u32 s42, s28, s25
    s_mul_i32 s42, s42, 1024
    s_add_u32 s42, s42, 6291456
    s_mul_i32 s30, s24, 2048
    s_add_u32 s30, s30, 2048
    s_and_b32 s28, s24, 3
    s_mul_i32 s43, s28, 16384
    s_lshl_b32 s29, s26, 1
    s_add_u32 s43, s43, s29
    s_lshl_b32 s31, s28, 10
    s_add_u32 s31, s31, 10240
    s_mov_b32 s44, 0
    s_mov_b32 s45, 0
    s_waitcnt lgkmcnt(0)
    s_mov_b32 s8, s4
    s_mov_b32 s9, s5
    s_mov_b32 s10, 8388608
    s_mov_b32 s11, 0x00020000
    s_mov_b32 s12, s6
    s_mov_b32 s13, s7
    s_mov_b32 s14, 524288
    s_mov_b32 s15, 0x00020000
    s_add_u32 m0, s30, s44
    s_add_u32 s27, s31, s44
    buffer_load_dwordx4 v16, s[8:11], s42 offen offset:0 lds
    buffer_load_dwordx4 v17, s[8:11], s42 offen offset:1024 lds
    s_add_u32 m0, s27, 0
    s_add_u32 s42, s42, 128
    buffer_load_dwordx4 v20, s[12:15], s43 offen lds
    s_add_u32 m0, s27, 4096
    s_nop 0
    buffer_load_dwordx4 v21, s[12:15], s43 offen lds
    s_add_u32 s43, s43, 65536
    s_add_u32 s44, s44, 16384
    s_add_u32 s45, s45, 1
    s_cmp_eq_u32 s45, 8
    s_cselect_b32 s44, 0, s44
    s_cselect_b32 s45, 0, s45
    s_add_u32 m0, s30, s44
    s_add_u32 s27, s31, s44
    buffer_load_dwordx4 v16, s[8:11], s42 offen offset:0 lds
    buffer_load_dwordx4 v17, s[8:11], s42 offen offset:1024 lds
    s_add_u32 m0, s27, 0
    s_add_u32 s42, s42, 128
    buffer_load_dwordx4 v20, s[12:15], s43 offen lds
    s_add_u32 m0, s27, 4096
    s_nop 0
    buffer_load_dwordx4 v21, s[12:15], s43 offen lds
    s_add_u32 s43, s43, 65536
    s_add_u32 s44, s44, 16384
    s_add_u32 s45, s45, 1
    s_cmp_eq_u32 s45, 8
    s_cselect_b32 s44, 0, s44
    s_cselect_b32 s45, 0, s45
    s_waitcnt vmcnt(4)
    s_barrier
    s_add_u32 m0, s30, s44
    s_add_u32 s27, s31, s44
    buffer_load_dwordx4 v16, s[8:11], s42 offen offset:0 lds
    buffer_load_dwordx4 v17, s[8:11], s42 offen offset:1024 lds
    s_add_u32 m0, s27, 0
    s_add_u32 s42, s42, 128
    buffer_load_dwordx4 v20, s[12:15], s43 offen lds
    s_add_u32 m0, s27, 4096
    s_nop 0
    buffer_load_dwordx4 v21, s[12:15], s43 offen lds
    s_add_u32 s43, s43, 65536
    s_add_u32 s44, s44, 16384
    s_add_u32 s45, s45, 1
    s_cmp_eq_u32 s45, 8
    s_cselect_b32 s44, 0, s44
    s_cselect_b32 s45, 0, s45
    s_add_u32 m0, s30, s44
    s_add_u32 s27, s31, s44
    buffer_load_dwordx4 v16, s[8:11], s42 offen offset:0 lds
    buffer_load_dwordx4 v17, s[8:11], s42 offen offset:1024 lds
    s_add_u32 m0, s27, 0
    s_add_u32 s42, s42, 128
    buffer_load_dwordx4 v20, s[12:15], s43 offen lds
    s_add_u32 m0, s27, 4096
    s_nop 0
    buffer_load_dwordx4 v21, s[12:15], s43 offen lds
    s_add_u32 s43, s43, 65536
    s_add_u32 s44, s44, 16384
    s_add_u32 s45, s45, 1
    s_cmp_eq_u32 s45, 8
    s_cselect_b32 s44, 0, s44
    s_cselect_b32 s45, 0, s45
    s_waitcnt vmcnt(8)
    s_barrier
    s_add_u32 m0, s30, s44
    s_add_u32 s27, s31, s44
    buffer_load_dwordx4 v16, s[8:11], s42 offen offset:0 lds
    buffer_load_dwordx4 v17, s[8:11], s42 offen offset:1024 lds
    s_add_u32 m0, s27, 0
    s_add_u32 s42, s42, 128
    buffer_load_dwordx4 v20, s[12:15], s43 offen lds
    s_add_u32 m0, s27, 4096
    s_nop 0
    buffer_load_dwordx4 v21, s[12:15], s43 offen lds
    s_add_u32 s43, s43, 65536
    s_add_u32 s44, s44, 16384
    s_add_u32 s45, s45, 1
    s_cmp_eq_u32 s45, 8
    s_cselect_b32 s44, 0, s44
    s_cselect_b32 s45, 0, s45
    s_add_u32 m0, s30, s44
    s_add_u32 s27, s31, s44
    buffer_load_dwordx4 v16, s[8:11], s42 offen offset:0 lds
    buffer_load_dwordx4 v17, s[8:11], s42 offen offset:1024 lds
    s_add_u32 m0, s27, 0
    s_add_u32 s42, s42, 128
    buffer_load_dwordx4 v20, s[12:15], s43 offen lds
    s_add_u32 m0, s27, 4096
    s_nop 0
    buffer_load_dwordx4 v21, s[12:15], s43 offen lds
    s_add_u32 s43, s43, 65536
    s_add_u32 s44, s44, 16384
    s_add_u32 s45, s45, 1
    s_cmp_eq_u32 s45, 8
    s_cselect_b32 s44, 0, s44
    s_cselect_b32 s45, 0, s45
    s_waitcnt vmcnt(12)
    s_barrier
    s_add_u32 m0, s30, s44
    s_add_u32 s27, s31, s44
    buffer_load_dwordx4 v16, s[8:11], s42 offen offset:0 lds
    buffer_load_dwordx4 v17, s[8:11], s42 offen offset:1024 lds
    s_add_u32 m0, s27, 0
    s_add_u32 s42, s42, 128
    buffer_load_dwordx4 v20, s[12:15], s43 offen lds
    s_add_u32 m0, s27, 4096
    s_nop 0
    buffer_load_dwordx4 v21, s[12:15], s43 offen lds
    s_add_u32 s43, s43, 65536
    s_add_u32 s44, s44, 16384
    s_add_u32 s45, s45, 1
    s_cmp_eq_u32 s45, 8
    s_cselect_b32 s44, 0, s44
    s_cselect_b32 s45, 0, s45
    s_add_u32 m0, s30, s44
    s_add_u32 s27, s31, s44
    buffer_load_dwordx4 v16, s[8:11], s42 offen offset:0 lds
    buffer_load_dwordx4 v17, s[8:11], s42 offen offset:1024 lds
    s_add_u32 m0, s27, 0
    s_add_u32 s42, s42, 128
    buffer_load_dwordx4 v20, s[12:15], s43 offen lds
    s_add_u32 m0, s27, 4096
    s_nop 0
    buffer_load_dwordx4 v21, s[12:15], s43 offen lds
    s_add_u32 s43, s43, 65536
    s_add_u32 s44, s44, 16384
    s_add_u32 s45, s45, 1
    s_cmp_eq_u32 s45, 8
    s_cselect_b32 s44, 0, s44
    s_cselect_b32 s45, 0, s45
    s_load_dwordx2 s[36:37], s[0:1], 32
    s_lshr_b32 s27, s2, 3
    s_mul_i32 s27, s27, 4
    s_add_u32 s27, s27, s24
    s_mul_i32 s27, s27, 11264
    v_lshlrev_b32 v28, 4, v2
    s_waitcnt lgkmcnt(0)
    s_mov_b32 s16, s36
    s_mov_b32 s17, s37
    s_mov_b32 s18, 1409024
    s_mov_b32 s19, 0x00020000
    buffer_load_dwordx4 v[24:27], v28, s[16:19], s27 offen offset:0
    buffer_load_dwordx4 v[24:27], v28, s[16:19], s27 offen offset:1024
    buffer_load_dwordx4 v[24:27], v28, s[16:19], s27 offen offset:2048
    buffer_load_dwordx4 v[24:27], v28, s[16:19], s27 offen offset:3072
    s_add_u32 s27, s27, 4096
    buffer_load_dwordx4 v[24:27], v28, s[16:19], s27 offen offset:0
    buffer_load_dwordx4 v[24:27], v28, s[16:19], s27 offen offset:1024
    buffer_load_dwordx4 v[24:27], v28, s[16:19], s27 offen offset:2048
    buffer_load_dwordx4 v[24:27], v28, s[16:19], s27 offen offset:3072
    s_add_u32 s27, s27, 4096
    buffer_load_dwordx4 v[24:27], v28, s[16:19], s27 offen offset:0
    buffer_load_dwordx4 v[24:27], v28, s[16:19], s27 offen offset:1024
    buffer_load_dwordx4 v[24:27], v28, s[16:19], s27 offen offset:2048
    s_waitcnt vmcnt(27)
    s_barrier
    s_waitcnt vmcnt(23)
    s_barrier
    s_waitcnt vmcnt(19)
    s_barrier
    s_waitcnt vmcnt(15)
    s_barrier
    s_waitcnt vmcnt(11)
    s_barrier
    s_barrier
k3_wo_kernel_end:
    s_endpgm
.globl k4_w1_kernel
.p2align 8
.type k4_w1_kernel,@function
k4_w1_kernel:
    s_cmp_ge_u32 s2, 240
    s_cbranch_scc1 k4_w1_kernel_end
    s_load_dwordx2 s[4:5], s[0:1], 64
    s_load_dwordx2 s[6:7], s[0:1], 32
    s_load_dwordx2 s[34:35], s[0:1], 64
    v_lshrrev_b32 v1, 6, v0
    v_and_b32 v2, 63, v0
    s_lshr_b32 s27, s2, 3
    s_mov_b32 s29, 286331154
    s_mul_hi_u32 s28, s27, s29
    s_mul_i32 s29, s28, 15
    s_sub_u32 s29, s27, s29
    s_and_b32 s27, s2, 7
    s_mul_i32 s27, s27, 2
    s_add_u32 s28, s28, s27
    v_readfirstlane_b32 s24, v1
    s_mul_i32 s25, s28, 128
    s_mul_i32 s26, s29, 96
    v_and_b32 v3, 15, v2
    v_lshrrev_b32 v4, 4, v2
    s_cmp_ge_u32 s24, 4
    s_cbranch_scc1 k4_w1_kernel_loader
    s_mul_i32 s32, s24, 32
    s_mul_i32 s27, s24, 4096
    s_mov_b32 s33, s26
    s_mov_b32 s28, 2048
    s_add_u32 s32, s32, s25
    s_add_u32 s27, s27, 2048
    v_and_b32 v8, 3, v2
    v_bfe_u32 v9, v2, 2, 2
    v_lshl_add_u32 v9, v4, 3, v9
    v_lshlrev_b32 v9, 6, v9
    v_lshl_add_u32 v9, v8, 3, v9
    v_add_u32 v9, s28, v9
    v_and_b32 v10, 1, v4
    v_lshlrev_b32 v10, 5, v10
    v_xor_b32 v11, 32, v10
    v_add_u32 v10, v9, v10
    v_add_u32 v11, v9, v11
    v_lshlrev_b32 v9, 7, v3
    v_add_u32 v9, s27, v9
    v_lshrrev_b32 v8, 1, v3
    v_xor_b32 v12, v4, v8
    v_xor_b32 v13, 4, v12
    v_lshl_add_u32 v12, v12, 4, v9
    v_lshl_add_u32 v13, v13, 4, v9
    s_add_u32 s27, s24, 4
    s_cmp_lt_u32 s24, 2
    s_cselect_b32 s28, s27, s24
    s_lshr_b32 s27, s24, 1
    s_mul_i32 s27, s27, 4096
    s_and_b32 s29, s24, 1
    s_cmp_eq_u32 s29, 0
    s_cselect_b64 vcc, -1, 0
    v_cndmask_b32 v14, v11, v10, vcc
    v_add_u32 v14, s27, v14
    s_lshl_b32 s48, s24, 6
    s_lshr_b32 s27, s28, 1
    s_mul_i32 s27, s27, 4096
    s_and_b32 s29, s28, 1
    s_cmp_eq_u32 s29, 0
    s_cselect_b64 vcc, -1, 0
    v_cndmask_b32 v15, v11, v10, vcc
    v_add_u32 v15, s27, v15
    s_lshl_b32 s49, s28, 6
    v_mov_b32 v80, 0
    v_mov_b32 v81, 0
    v_mov_b32 v82, 0
    v_mov_b32 v83, 0
    v_mov_b32 v84, 0
    v_mov_b32 v85, 0
    v_mov_b32 v86, 0
    v_mov_b32 v87, 0
    v_mov_b32 v88, 0
    v_mov_b32 v89, 0
    v_mov_b32 v90, 0
    v_mov_b32 v91, 0
    v_mov_b32 v92, 0
    v_mov_b32 v93, 0
    v_mov_b32 v94, 0
    v_mov_b32 v95, 0
    v_mov_b32 v96, 0
    v_mov_b32 v97, 0
    v_mov_b32 v98, 0
    v_mov_b32 v99, 0
    v_mov_b32 v100, 0
    v_mov_b32 v101, 0
    v_mov_b32 v102, 0
    v_mov_b32 v103, 0
    v_mov_b32 v104, 0
    v_mov_b32 v105, 0
    v_mov_b32 v106, 0
    v_mov_b32 v107, 0
    v_mov_b32 v108, 0
    v_mov_b32 v109, 0
    v_mov_b32 v110, 0
    v_mov_b32 v111, 0
    v_mov_b32 v112, 0
    v_mov_b32 v113, 0
    v_mov_b32 v114, 0
    v_mov_b32 v115, 0
    v_mov_b32 v116, 0
    v_mov_b32 v117, 0
    v_mov_b32 v118, 0
    v_mov_b32 v119, 0
    v_mov_b32 v120, 0
    v_mov_b32 v121, 0
    v_mov_b32 v122, 0
    v_mov_b32 v123, 0
    v_mov_b32 v124, 0
    v_mov_b32 v125, 0
    v_mov_b32 v126, 0
    v_mov_b32 v127, 0
    v_mov_b32 v128, 0
    v_mov_b32 v129, 0
    v_mov_b32 v130, 0
    v_mov_b32 v131, 0
    v_mov_b32 v132, 0
    v_mov_b32 v133, 0
    v_mov_b32 v134, 0
    v_mov_b32 v135, 0
    v_mov_b32 v136, 0
    v_mov_b32 v137, 0
    v_mov_b32 v138, 0
    v_mov_b32 v139, 0
    v_mov_b32 v140, 0
    v_mov_b32 v141, 0
    v_mov_b32 v142, 0
    v_mov_b32 v143, 0
    v_mov_b32 v144, 0
    v_mov_b32 v145, 0
    v_mov_b32 v146, 0
    v_mov_b32 v147, 0
    v_mov_b32 v148, 0
    v_mov_b32 v149, 0
    v_mov_b32 v150, 0
    v_mov_b32 v151, 0
    v_mov_b32 v152, 0
    v_mov_b32 v153, 0
    v_mov_b32 v154, 0
    v_mov_b32 v155, 0
    v_mov_b32 v156, 0
    v_mov_b32 v157, 0
    v_mov_b32 v158, 0
    v_mov_b32 v159, 0
    v_mov_b32 v160, 0
    v_mov_b32 v161, 0
    v_mov_b32 v162, 0
    v_mov_b32 v163, 0
    v_mov_b32 v164, 0
    v_mov_b32 v165, 0
    v_mov_b32 v166, 0
    v_mov_b32 v167, 0
    s_mov_b32 s41, 0x3f803f80
    v_mov_b32 v168, s41
    v_mov_b32 v169, s41
    v_mov_b32 v170, s41
    v_mov_b32 v171, s41
    s_mov_b32 s45, 0
    s_mov_b32 s46, 8
    s_mov_b32 s40, -114688
    s_waitcnt lgkmcnt(0)
    s_mov_b32 s16, s34
    s_mov_b32 s17, s35
    s_mov_b32 s18, 16252928
    s_mov_b32 s19, 0x00020000
    s_barrier
    ds_read_b128 v[16:19], v12 offset:0
    ds_read_b128 v[20:23], v12 offset:2048
    ds_read_b64_tr_b16 v[32:33], v10 offset:16384
    ds_read_b64_tr_b16 v[34:35], v10 offset:16640
    ds_read_b64_tr_b16 v[36:37], v11 offset:16384
    ds_read_b64_tr_b16 v[38:39], v11 offset:16640
    ds_read_b64_tr_b16 v[40:41], v10 offset:20480
    ds_read_b64_tr_b16 v[42:43], v10 offset:20736
    s_waitcnt lgkmcnt(6)
    ds_read_b64_tr_b16 v[44:45], v11 offset:20480
    ds_read_b64_tr_b16 v[46:47], v11 offset:20736
    ds_read_b64_tr_b16 v[48:49], v10 offset:24576
    ds_read_b64_tr_b16 v[50:51], v10 offset:24832
    ds_read_b64_tr_b16 v[52:53], v11 offset:24576
    ds_read_b64_tr_b16 v[54:55], v11 offset:24832
    ds_read_b64_tr_b16 v[136:137], v14 offset:16384
    ds_read_b64_tr_b16 v[138:139], v14 offset:16640
    ds_read_b64_tr_b16 v[140:141], v15 offset:16384
    ds_read_b64_tr_b16 v[142:143], v15 offset:16640
    s_waitcnt lgkmcnt(0)
    ds_read_b128 v[24:27], v13 offset:0
    v_mfma_f32_16x16x32_bf16 v[80:83], v[32:35], v[16:19], v[80:83]
    ds_read_b128 v[28:31], v13 offset:2048
    v_mfma_f32_16x16x32_bf16 v[104:107], v[32:35], v[20:23], v[104:107]
    ds_read_b64_tr_b16 v[56:57], v10 offset:18432
    v_mfma_f32_16x16x32_bf16 v[152:155], v[168:171], v[16:19], v[152:155]
    ds_read_b64_tr_b16 v[58:59], v10 offset:18688
    v_mfma_f32_16x16x32_bf16 v[156:159], v[16:19], v[16:19], v[156:159]
    ds_read_b64_tr_b16 v[60:61], v11 offset:18432
    v_mfma_f32_16x16x32_bf16 v[84:87], v[36:39], v[16:19], v[84:87]
    ds_read_b64_tr_b16 v[62:63], v11 offset:18688
    v_mfma_f32_16x16x32_bf16 v[108:111], v[36:39], v[20:23], v[108:111]
    ds_read_b64_tr_b16 v[64:65], v10 offset:22528
    v_mfma_f32_16x16x32_bf16 v[160:163], v[168:171], v[20:23], v[160:163]
    ds_read_b64_tr_b16 v[66:67], v10 offset:22784
    v_mfma_f32_16x16x32_bf16 v[164:167], v[20:23], v[20:23], v[164:167]
    s_waitcnt lgkmcnt(6)
    v_mfma_f32_16x16x32_bf16 v[88:91], v[40:43], v[16:19], v[88:91]
    ds_read_b64_tr_b16 v[68:69], v11 offset:22528
    v_mfma_f32_16x16x32_bf16 v[112:115], v[40:43], v[20:23], v[112:115]
    ds_read_b64_tr_b16 v[70:71], v11 offset:22784
    v_mfma_f32_16x16x32_bf16 v[128:131], v[168:171], v[136:139], v[128:131]
    ds_read_b64_tr_b16 v[72:73], v10 offset:26624
    v_mfma_f32_16x16x32_bf16 v[92:95], v[44:47], v[16:19], v[92:95]
    ds_read_b64_tr_b16 v[74:75], v10 offset:26880
    v_mfma_f32_16x16x32_bf16 v[116:119], v[44:47], v[20:23], v[116:119]
    ds_read_b64_tr_b16 v[76:77], v11 offset:26624
    v_mfma_f32_16x16x32_bf16 v[132:135], v[168:171], v[140:143], v[132:135]
    ds_read_b64_tr_b16 v[78:79], v11 offset:26880
    v_mfma_f32_16x16x32_bf16 v[96:99], v[48:51], v[16:19], v[96:99]
    ds_read_b64_tr_b16 v[144:145], v14 offset:18432
    v_mfma_f32_16x16x32_bf16 v[120:123], v[48:51], v[20:23], v[120:123]
    ds_read_b64_tr_b16 v[146:147], v14 offset:18688
    v_mfma_f32_16x16x32_bf16 v[100:103], v[52:55], v[16:19], v[100:103]
    ds_read_b64_tr_b16 v[148:149], v15 offset:18432
    ds_read_b64_tr_b16 v[150:151], v15 offset:18688
    v_mfma_f32_16x16x32_bf16 v[124:127], v[52:55], v[20:23], v[124:127]
    s_waitcnt lgkmcnt(0)
    s_barrier
    v_add_u32 v10, 28672, v10
    v_add_u32 v11, 28672, v11
    v_add_u32 v12, 28672, v12
    v_add_u32 v13, 28672, v13
    v_add_u32 v14, 28672, v14
    v_add_u32 v15, 28672, v15
    ds_read_b128 v[16:19], v12 offset:0
    v_mfma_f32_16x16x32_bf16 v[80:83], v[56:59], v[24:27], v[80:83]
    ds_read_b128 v[20:23], v12 offset:2048
    v_mfma_f32_16x16x32_bf16 v[104:107], v[56:59], v[28:31], v[104:107]
    ds_read_b64_tr_b16 v[32:33], v10 offset:16384
    v_mfma_f32_16x16x32_bf16 v[152:155], v[168:171], v[24:27], v[152:155]
    ds_read_b64_tr_b16 v[34:35], v10 offset:16640
    v_mfma_f32_16x16x32_bf16 v[156:159], v[24:27], v[24:27], v[156:159]
    ds_read_b64_tr_b16 v[36:37], v11 offset:16384
    v_mfma_f32_16x16x32_bf16 v[84:87], v[60:63], v[24:27], v[84:87]
    ds_read_b64_tr_b16 v[38:39], v11 offset:16640
    v_mfma_f32_16x16x32_bf16 v[108:111], v[60:63], v[28:31], v[108:111]
    ds_read_b64_tr_b16 v[40:41], v10 offset:20480
    v_mfma_f32_16x16x32_bf16 v[160:163], v[168:171], v[28:31], v[160:163]
    ds_read_b64_tr_b16 v[42:43], v10 offset:20736
    v_mfma_f32_16x16x32_bf16 v[164:167], v[28:31], v[28:31], v[164:167]
    s_waitcnt lgkmcnt(6)
    v_mfma_f32_16x16x32_bf16 v[88:91], v[64:67], v[24:27], v[88:91]
    ds_read_b64_tr_b16 v[44:45], v11 offset:20480
    v_mfma_f32_16x16x32_bf16 v[112:115], v[64:67], v[28:31], v[112:115]
    ds_read_b64_tr_b16 v[46:47], v11 offset:20736
    v_mfma_f32_16x16x32_bf16 v[128:131], v[168:171], v[144:147], v[128:131]
    ds_read_b64_tr_b16 v[48:49], v10 offset:24576
    v_mfma_f32_16x16x32_bf16 v[92:95], v[68:71], v[24:27], v[92:95]
    ds_read_b64_tr_b16 v[50:51], v10 offset:24832
    v_mfma_f32_16x16x32_bf16 v[116:119], v[68:71], v[28:31], v[116:119]
    ds_read_b64_tr_b16 v[52:53], v11 offset:24576
    v_mfma_f32_16x16x32_bf16 v[132:135], v[168:171], v[148:151], v[132:135]
    ds_read_b64_tr_b16 v[54:55], v11 offset:24832
    v_mfma_f32_16x16x32_bf16 v[96:99], v[72:75], v[24:27], v[96:99]
    ds_read_b64_tr_b16 v[136:137], v14 offset:16384
    v_mfma_f32_16x16x32_bf16 v[120:123], v[72:75], v[28:31], v[120:123]
    ds_read_b64_tr_b16 v[138:139], v14 offset:16640
    v_mfma_f32_16x16x32_bf16 v[100:103], v[76:79], v[24:27], v[100:103]
    ds_read_b64_tr_b16 v[140:141], v15 offset:16384
    ds_read_b64_tr_b16 v[142:143], v15 offset:16640
    v_mfma_f32_16x16x32_bf16 v[124:127], v[76:79], v[28:31], v[124:127]
    s_waitcnt lgkmcnt(0)
    ds_read_b128 v[24:27], v13 offset:0
    v_mfma_f32_16x16x32_bf16 v[80:83], v[32:35], v[16:19], v[80:83]
    ds_read_b128 v[28:31], v13 offset:2048
    v_mfma_f32_16x16x32_bf16 v[104:107], v[32:35], v[20:23], v[104:107]
    ds_read_b64_tr_b16 v[56:57], v10 offset:18432
    v_mfma_f32_16x16x32_bf16 v[152:155], v[168:171], v[16:19], v[152:155]
    ds_read_b64_tr_b16 v[58:59], v10 offset:18688
    v_mfma_f32_16x16x32_bf16 v[156:159], v[16:19], v[16:19], v[156:159]
    ds_read_b64_tr_b16 v[60:61], v11 offset:18432
    v_mfma_f32_16x16x32_bf16 v[84:87], v[36:39], v[16:19], v[84:87]
    ds_read_b64_tr_b16 v[62:63], v11 offset:18688
    v_mfma_f32_16x16x32_bf16 v[108:111], v[36:39], v[20:23], v[108:111]
    ds_read_b64_tr_b16 v[64:65], v10 offset:22528
    v_mfma_f32_16x16x32_bf16 v[160:163], v[168:171], v[20:23], v[160:163]
    ds_read_b64_tr_b16 v[66:67], v10 offset:22784
    v_mfma_f32_16x16x32_bf16 v[164:167], v[20:23], v[20:23], v[164:167]
    s_waitcnt lgkmcnt(6)
    v_mfma_f32_16x16x32_bf16 v[88:91], v[40:43], v[16:19], v[88:91]
    ds_read_b64_tr_b16 v[68:69], v11 offset:22528
    v_mfma_f32_16x16x32_bf16 v[112:115], v[40:43], v[20:23], v[112:115]
    ds_read_b64_tr_b16 v[70:71], v11 offset:22784
    v_mfma_f32_16x16x32_bf16 v[128:131], v[168:171], v[136:139], v[128:131]
    ds_read_b64_tr_b16 v[72:73], v10 offset:26624
    v_mfma_f32_16x16x32_bf16 v[92:95], v[44:47], v[16:19], v[92:95]
    ds_read_b64_tr_b16 v[74:75], v10 offset:26880
    v_mfma_f32_16x16x32_bf16 v[116:119], v[44:47], v[20:23], v[116:119]
    ds_read_b64_tr_b16 v[76:77], v11 offset:26624
    v_mfma_f32_16x16x32_bf16 v[132:135], v[168:171], v[140:143], v[132:135]
    ds_read_b64_tr_b16 v[78:79], v11 offset:26880
    v_mfma_f32_16x16x32_bf16 v[96:99], v[48:51], v[16:19], v[96:99]
    ds_read_b64_tr_b16 v[144:145], v14 offset:18432
    v_mfma_f32_16x16x32_bf16 v[120:123], v[48:51], v[20:23], v[120:123]
    ds_read_b64_tr_b16 v[146:147], v14 offset:18688
    v_mfma_f32_16x16x32_bf16 v[100:103], v[52:55], v[16:19], v[100:103]
    ds_read_b64_tr_b16 v[148:149], v15 offset:18432
    ds_read_b64_tr_b16 v[150:151], v15 offset:18688
    v_mfma_f32_16x16x32_bf16 v[124:127], v[52:55], v[20:23], v[124:127]
    s_waitcnt lgkmcnt(0)
    s_barrier
    v_add_u32 v10, 28672, v10
    v_add_u32 v11, 28672, v11
    v_add_u32 v12, 28672, v12
    v_add_u32 v13, 28672, v13
    v_add_u32 v14, 28672, v14
    v_add_u32 v15, 28672, v15
    ds_read_b128 v[16:19], v12 offset:0
    v_mfma_f32_16x16x32_bf16 v[80:83], v[56:59], v[24:27], v[80:83]
    ds_read_b128 v[20:23], v12 offset:2048
    v_mfma_f32_16x16x32_bf16 v[104:107], v[56:59], v[28:31], v[104:107]
    ds_read_b64_tr_b16 v[32:33], v10 offset:16384
    v_mfma_f32_16x16x32_bf16 v[152:155], v[168:171], v[24:27], v[152:155]
    ds_read_b64_tr_b16 v[34:35], v10 offset:16640
    v_mfma_f32_16x16x32_bf16 v[156:159], v[24:27], v[24:27], v[156:159]
    ds_read_b64_tr_b16 v[36:37], v11 offset:16384
    v_mfma_f32_16x16x32_bf16 v[84:87], v[60:63], v[24:27], v[84:87]
    ds_read_b64_tr_b16 v[38:39], v11 offset:16640
    v_mfma_f32_16x16x32_bf16 v[108:111], v[60:63], v[28:31], v[108:111]
    ds_read_b64_tr_b16 v[40:41], v10 offset:20480
    v_mfma_f32_16x16x32_bf16 v[160:163], v[168:171], v[28:31], v[160:163]
    ds_read_b64_tr_b16 v[42:43], v10 offset:20736
    v_mfma_f32_16x16x32_bf16 v[164:167], v[28:31], v[28:31], v[164:167]
    s_waitcnt lgkmcnt(6)
    v_mfma_f32_16x16x32_bf16 v[88:91], v[64:67], v[24:27], v[88:91]
    ds_read_b64_tr_b16 v[44:45], v11 offset:20480
    v_mfma_f32_16x16x32_bf16 v[112:115], v[64:67], v[28:31], v[112:115]
    ds_read_b64_tr_b16 v[46:47], v11 offset:20736
    v_mfma_f32_16x16x32_bf16 v[128:131], v[168:171], v[144:147], v[128:131]
    ds_read_b64_tr_b16 v[48:49], v10 offset:24576
    v_mfma_f32_16x16x32_bf16 v[92:95], v[68:71], v[24:27], v[92:95]
    ds_read_b64_tr_b16 v[50:51], v10 offset:24832
    v_mfma_f32_16x16x32_bf16 v[116:119], v[68:71], v[28:31], v[116:119]
    ds_read_b64_tr_b16 v[52:53], v11 offset:24576
    v_mfma_f32_16x16x32_bf16 v[132:135], v[168:171], v[148:151], v[132:135]
    ds_read_b64_tr_b16 v[54:55], v11 offset:24832
    v_mfma_f32_16x16x32_bf16 v[96:99], v[72:75], v[24:27], v[96:99]
    ds_read_b64_tr_b16 v[136:137], v14 offset:16384
    v_mfma_f32_16x16x32_bf16 v[120:123], v[72:75], v[28:31], v[120:123]
    ds_read_b64_tr_b16 v[138:139], v14 offset:16640
    v_mfma_f32_16x16x32_bf16 v[100:103], v[76:79], v[24:27], v[100:103]
    ds_read_b64_tr_b16 v[140:141], v15 offset:16384
    ds_read_b64_tr_b16 v[142:143], v15 offset:16640
    v_mfma_f32_16x16x32_bf16 v[124:127], v[76:79], v[28:31], v[124:127]
    s_waitcnt lgkmcnt(0)
    ds_read_b128 v[24:27], v13 offset:0
    v_mfma_f32_16x16x32_bf16 v[80:83], v[32:35], v[16:19], v[80:83]
    ds_read_b128 v[28:31], v13 offset:2048
    v_mfma_f32_16x16x32_bf16 v[104:107], v[32:35], v[20:23], v[104:107]
    ds_read_b64_tr_b16 v[56:57], v10 offset:18432
    v_mfma_f32_16x16x32_bf16 v[152:155], v[168:171], v[16:19], v[152:155]
    ds_read_b64_tr_b16 v[58:59], v10 offset:18688
    v_mfma_f32_16x16x32_bf16 v[156:159], v[16:19], v[16:19], v[156:159]
    ds_read_b64_tr_b16 v[60:61], v11 offset:18432
    v_mfma_f32_16x16x32_bf16 v[84:87], v[36:39], v[16:19], v[84:87]
    ds_read_b64_tr_b16 v[62:63], v11 offset:18688
    v_mfma_f32_16x16x32_bf16 v[108:111], v[36:39], v[20:23], v[108:111]
    ds_read_b64_tr_b16 v[64:65], v10 offset:22528
    v_mfma_f32_16x16x32_bf16 v[160:163], v[168:171], v[20:23], v[160:163]
    ds_read_b64_tr_b16 v[66:67], v10 offset:22784
    v_mfma_f32_16x16x32_bf16 v[164:167], v[20:23], v[20:23], v[164:167]
    s_waitcnt lgkmcnt(6)
    v_mfma_f32_16x16x32_bf16 v[88:91], v[40:43], v[16:19], v[88:91]
    ds_read_b64_tr_b16 v[68:69], v11 offset:22528
    v_mfma_f32_16x16x32_bf16 v[112:115], v[40:43], v[20:23], v[112:115]
    ds_read_b64_tr_b16 v[70:71], v11 offset:22784
    v_mfma_f32_16x16x32_bf16 v[128:131], v[168:171], v[136:139], v[128:131]
    ds_read_b64_tr_b16 v[72:73], v10 offset:26624
    v_mfma_f32_16x16x32_bf16 v[92:95], v[44:47], v[16:19], v[92:95]
    ds_read_b64_tr_b16 v[74:75], v10 offset:26880
    v_mfma_f32_16x16x32_bf16 v[116:119], v[44:47], v[20:23], v[116:119]
    ds_read_b64_tr_b16 v[76:77], v11 offset:26624
    v_mfma_f32_16x16x32_bf16 v[132:135], v[168:171], v[140:143], v[132:135]
    ds_read_b64_tr_b16 v[78:79], v11 offset:26880
    v_mfma_f32_16x16x32_bf16 v[96:99], v[48:51], v[16:19], v[96:99]
    ds_read_b64_tr_b16 v[144:145], v14 offset:18432
    v_mfma_f32_16x16x32_bf16 v[120:123], v[48:51], v[20:23], v[120:123]
    ds_read_b64_tr_b16 v[146:147], v14 offset:18688
    v_mfma_f32_16x16x32_bf16 v[100:103], v[52:55], v[16:19], v[100:103]
    ds_read_b64_tr_b16 v[148:149], v15 offset:18432
    ds_read_b64_tr_b16 v[150:151], v15 offset:18688
    v_mfma_f32_16x16x32_bf16 v[124:127], v[52:55], v[20:23], v[124:127]
    s_waitcnt lgkmcnt(0)
    s_barrier
    v_add_u32 v10, 28672, v10
    v_add_u32 v11, 28672, v11
    v_add_u32 v12, 28672, v12
    v_add_u32 v13, 28672, v13
    v_add_u32 v14, 28672, v14
    v_add_u32 v15, 28672, v15
    ds_read_b128 v[16:19], v12 offset:0
    v_mfma_f32_16x16x32_bf16 v[80:83], v[56:59], v[24:27], v[80:83]
    ds_read_b128 v[20:23], v12 offset:2048
    v_mfma_f32_16x16x32_bf16 v[104:107], v[56:59], v[28:31], v[104:107]
    ds_read_b64_tr_b16 v[32:33], v10 offset:16384
    v_mfma_f32_16x16x32_bf16 v[152:155], v[168:171], v[24:27], v[152:155]
    ds_read_b64_tr_b16 v[34:35], v10 offset:16640
    v_mfma_f32_16x16x32_bf16 v[156:159], v[24:27], v[24:27], v[156:159]
    ds_read_b64_tr_b16 v[36:37], v11 offset:16384
    v_mfma_f32_16x16x32_bf16 v[84:87], v[60:63], v[24:27], v[84:87]
    ds_read_b64_tr_b16 v[38:39], v11 offset:16640
    v_mfma_f32_16x16x32_bf16 v[108:111], v[60:63], v[28:31], v[108:111]
    ds_read_b64_tr_b16 v[40:41], v10 offset:20480
    v_mfma_f32_16x16x32_bf16 v[160:163], v[168:171], v[28:31], v[160:163]
    ds_read_b64_tr_b16 v[42:43], v10 offset:20736
    v_mfma_f32_16x16x32_bf16 v[164:167], v[28:31], v[28:31], v[164:167]
    s_waitcnt lgkmcnt(6)
    v_mfma_f32_16x16x32_bf16 v[88:91], v[64:67], v[24:27], v[88:91]
    ds_read_b64_tr_b16 v[44:45], v11 offset:20480
    v_mfma_f32_16x16x32_bf16 v[112:115], v[64:67], v[28:31], v[112:115]
    ds_read_b64_tr_b16 v[46:47], v11 offset:20736
    v_mfma_f32_16x16x32_bf16 v[128:131], v[168:171], v[144:147], v[128:131]
    ds_read_b64_tr_b16 v[48:49], v10 offset:24576
    v_mfma_f32_16x16x32_bf16 v[92:95], v[68:71], v[24:27], v[92:95]
    ds_read_b64_tr_b16 v[50:51], v10 offset:24832
    v_mfma_f32_16x16x32_bf16 v[116:119], v[68:71], v[28:31], v[116:119]
    ds_read_b64_tr_b16 v[52:53], v11 offset:24576
    v_mfma_f32_16x16x32_bf16 v[132:135], v[168:171], v[148:151], v[132:135]
    ds_read_b64_tr_b16 v[54:55], v11 offset:24832
    v_mfma_f32_16x16x32_bf16 v[96:99], v[72:75], v[24:27], v[96:99]
    ds_read_b64_tr_b16 v[136:137], v14 offset:16384
    v_mfma_f32_16x16x32_bf16 v[120:123], v[72:75], v[28:31], v[120:123]
    ds_read_b64_tr_b16 v[138:139], v14 offset:16640
    v_mfma_f32_16x16x32_bf16 v[100:103], v[76:79], v[24:27], v[100:103]
    ds_read_b64_tr_b16 v[140:141], v15 offset:16384
    ds_read_b64_tr_b16 v[142:143], v15 offset:16640
    v_mfma_f32_16x16x32_bf16 v[124:127], v[76:79], v[28:31], v[124:127]
    s_waitcnt lgkmcnt(0)
    ds_read_b128 v[24:27], v13 offset:0
    v_mfma_f32_16x16x32_bf16 v[80:83], v[32:35], v[16:19], v[80:83]
    ds_read_b128 v[28:31], v13 offset:2048
    v_mfma_f32_16x16x32_bf16 v[104:107], v[32:35], v[20:23], v[104:107]
    ds_read_b64_tr_b16 v[56:57], v10 offset:18432
    v_mfma_f32_16x16x32_bf16 v[152:155], v[168:171], v[16:19], v[152:155]
    ds_read_b64_tr_b16 v[58:59], v10 offset:18688
    v_mfma_f32_16x16x32_bf16 v[156:159], v[16:19], v[16:19], v[156:159]
    ds_read_b64_tr_b16 v[60:61], v11 offset:18432
    v_mfma_f32_16x16x32_bf16 v[84:87], v[36:39], v[16:19], v[84:87]
    ds_read_b64_tr_b16 v[62:63], v11 offset:18688
    v_mfma_f32_16x16x32_bf16 v[108:111], v[36:39], v[20:23], v[108:111]
    ds_read_b64_tr_b16 v[64:65], v10 offset:22528
    v_mfma_f32_16x16x32_bf16 v[160:163], v[168:171], v[20:23], v[160:163]
    ds_read_b64_tr_b16 v[66:67], v10 offset:22784
    v_mfma_f32_16x16x32_bf16 v[164:167], v[20:23], v[20:23], v[164:167]
    s_waitcnt lgkmcnt(6)
    v_mfma_f32_16x16x32_bf16 v[88:91], v[40:43], v[16:19], v[88:91]
    ds_read_b64_tr_b16 v[68:69], v11 offset:22528
    v_mfma_f32_16x16x32_bf16 v[112:115], v[40:43], v[20:23], v[112:115]
    ds_read_b64_tr_b16 v[70:71], v11 offset:22784
    v_mfma_f32_16x16x32_bf16 v[128:131], v[168:171], v[136:139], v[128:131]
    ds_read_b64_tr_b16 v[72:73], v10 offset:26624
    v_mfma_f32_16x16x32_bf16 v[92:95], v[44:47], v[16:19], v[92:95]
    ds_read_b64_tr_b16 v[74:75], v10 offset:26880
    v_mfma_f32_16x16x32_bf16 v[116:119], v[44:47], v[20:23], v[116:119]
    ds_read_b64_tr_b16 v[76:77], v11 offset:26624
    v_mfma_f32_16x16x32_bf16 v[132:135], v[168:171], v[140:143], v[132:135]
    ds_read_b64_tr_b16 v[78:79], v11 offset:26880
    v_mfma_f32_16x16x32_bf16 v[96:99], v[48:51], v[16:19], v[96:99]
    ds_read_b64_tr_b16 v[144:145], v14 offset:18432
    v_mfma_f32_16x16x32_bf16 v[120:123], v[48:51], v[20:23], v[120:123]
    ds_read_b64_tr_b16 v[146:147], v14 offset:18688
    v_mfma_f32_16x16x32_bf16 v[100:103], v[52:55], v[16:19], v[100:103]
    ds_read_b64_tr_b16 v[148:149], v15 offset:18432
    ds_read_b64_tr_b16 v[150:151], v15 offset:18688
    v_mfma_f32_16x16x32_bf16 v[124:127], v[52:55], v[20:23], v[124:127]
    s_waitcnt lgkmcnt(0)
    s_barrier
    v_add_u32 v10, 28672, v10
    v_add_u32 v11, 28672, v11
    v_add_u32 v12, 28672, v12
    v_add_u32 v13, 28672, v13
    v_add_u32 v14, 28672, v14
    v_add_u32 v15, 28672, v15
    ds_read_b128 v[16:19], v12 offset:0
    v_mfma_f32_16x16x32_bf16 v[80:83], v[56:59], v[24:27], v[80:83]
    ds_read_b128 v[20:23], v12 offset:2048
    v_mfma_f32_16x16x32_bf16 v[104:107], v[56:59], v[28:31], v[104:107]
    ds_read_b64_tr_b16 v[32:33], v10 offset:16384
    v_mfma_f32_16x16x32_bf16 v[152:155], v[168:171], v[24:27], v[152:155]
    ds_read_b64_tr_b16 v[34:35], v10 offset:16640
    v_mfma_f32_16x16x32_bf16 v[156:159], v[24:27], v[24:27], v[156:159]
    ds_read_b64_tr_b16 v[36:37], v11 offset:16384
    v_mfma_f32_16x16x32_bf16 v[84:87], v[60:63], v[24:27], v[84:87]
    ds_read_b64_tr_b16 v[38:39], v11 offset:16640
    v_mfma_f32_16x16x32_bf16 v[108:111], v[60:63], v[28:31], v[108:111]
    ds_read_b64_tr_b16 v[40:41], v10 offset:20480
    v_mfma_f32_16x16x32_bf16 v[160:163], v[168:171], v[28:31], v[160:163]
    ds_read_b64_tr_b16 v[42:43], v10 offset:20736
    v_mfma_f32_16x16x32_bf16 v[164:167], v[28:31], v[28:31], v[164:167]
    s_waitcnt lgkmcnt(6)
    v_mfma_f32_16x16x32_bf16 v[88:91], v[64:67], v[24:27], v[88:91]
    ds_read_b64_tr_b16 v[44:45], v11 offset:20480
    v_mfma_f32_16x16x32_bf16 v[112:115], v[64:67], v[28:31], v[112:115]
    ds_read_b64_tr_b16 v[46:47], v11 offset:20736
    v_mfma_f32_16x16x32_bf16 v[128:131], v[168:171], v[144:147], v[128:131]
    ds_read_b64_tr_b16 v[48:49], v10 offset:24576
    v_mfma_f32_16x16x32_bf16 v[92:95], v[68:71], v[24:27], v[92:95]
    ds_read_b64_tr_b16 v[50:51], v10 offset:24832
    v_mfma_f32_16x16x32_bf16 v[116:119], v[68:71], v[28:31], v[116:119]
    ds_read_b64_tr_b16 v[52:53], v11 offset:24576
    v_mfma_f32_16x16x32_bf16 v[132:135], v[168:171], v[148:151], v[132:135]
    ds_read_b64_tr_b16 v[54:55], v11 offset:24832
    v_mfma_f32_16x16x32_bf16 v[96:99], v[72:75], v[24:27], v[96:99]
    ds_read_b64_tr_b16 v[136:137], v14 offset:16384
    v_mfma_f32_16x16x32_bf16 v[120:123], v[72:75], v[28:31], v[120:123]
    ds_read_b64_tr_b16 v[138:139], v14 offset:16640
    v_mfma_f32_16x16x32_bf16 v[100:103], v[76:79], v[24:27], v[100:103]
    ds_read_b64_tr_b16 v[140:141], v15 offset:16384
    ds_read_b64_tr_b16 v[142:143], v15 offset:16640
    v_mfma_f32_16x16x32_bf16 v[124:127], v[76:79], v[28:31], v[124:127]
    s_waitcnt lgkmcnt(0)
    ds_read_b128 v[24:27], v13 offset:0
    v_mfma_f32_16x16x32_bf16 v[80:83], v[32:35], v[16:19], v[80:83]
    ds_read_b128 v[28:31], v13 offset:2048
    v_mfma_f32_16x16x32_bf16 v[104:107], v[32:35], v[20:23], v[104:107]
    ds_read_b64_tr_b16 v[56:57], v10 offset:18432
    v_mfma_f32_16x16x32_bf16 v[152:155], v[168:171], v[16:19], v[152:155]
    ds_read_b64_tr_b16 v[58:59], v10 offset:18688
    v_mfma_f32_16x16x32_bf16 v[156:159], v[16:19], v[16:19], v[156:159]
    ds_read_b64_tr_b16 v[60:61], v11 offset:18432
    v_mfma_f32_16x16x32_bf16 v[84:87], v[36:39], v[16:19], v[84:87]
    ds_read_b64_tr_b16 v[62:63], v11 offset:18688
    v_mfma_f32_16x16x32_bf16 v[108:111], v[36:39], v[20:23], v[108:111]
    ds_read_b64_tr_b16 v[64:65], v10 offset:22528
    v_mfma_f32_16x16x32_bf16 v[160:163], v[168:171], v[20:23], v[160:163]
    ds_read_b64_tr_b16 v[66:67], v10 offset:22784
    v_mfma_f32_16x16x32_bf16 v[164:167], v[20:23], v[20:23], v[164:167]
    s_waitcnt lgkmcnt(6)
    v_mfma_f32_16x16x32_bf16 v[88:91], v[40:43], v[16:19], v[88:91]
    ds_read_b64_tr_b16 v[68:69], v11 offset:22528
    v_mfma_f32_16x16x32_bf16 v[112:115], v[40:43], v[20:23], v[112:115]
    ds_read_b64_tr_b16 v[70:71], v11 offset:22784
    v_mfma_f32_16x16x32_bf16 v[128:131], v[168:171], v[136:139], v[128:131]
    ds_read_b64_tr_b16 v[72:73], v10 offset:26624
    v_mfma_f32_16x16x32_bf16 v[92:95], v[44:47], v[16:19], v[92:95]
    ds_read_b64_tr_b16 v[74:75], v10 offset:26880
    v_mfma_f32_16x16x32_bf16 v[116:119], v[44:47], v[20:23], v[116:119]
    ds_read_b64_tr_b16 v[76:77], v11 offset:26624
    v_mfma_f32_16x16x32_bf16 v[132:135], v[168:171], v[140:143], v[132:135]
    ds_read_b64_tr_b16 v[78:79], v11 offset:26880
    v_mfma_f32_16x16x32_bf16 v[96:99], v[48:51], v[16:19], v[96:99]
    ds_read_b64_tr_b16 v[144:145], v14 offset:18432
    v_mfma_f32_16x16x32_bf16 v[120:123], v[48:51], v[20:23], v[120:123]
    ds_read_b64_tr_b16 v[146:147], v14 offset:18688
    v_mfma_f32_16x16x32_bf16 v[100:103], v[52:55], v[16:19], v[100:103]
    ds_read_b64_tr_b16 v[148:149], v15 offset:18432
    ds_read_b64_tr_b16 v[150:151], v15 offset:18688
    v_mfma_f32_16x16x32_bf16 v[124:127], v[52:55], v[20:23], v[124:127]
    s_waitcnt lgkmcnt(0)
    s_barrier
    v_add_u32 v10, 4294852608, v10
    v_add_u32 v11, 4294852608, v11
    v_add_u32 v12, 4294852608, v12
    v_add_u32 v13, 4294852608, v13
    v_add_u32 v14, 4294852608, v14
    v_add_u32 v15, 4294852608, v15
    ds_read_b128 v[16:19], v12 offset:0
    v_mfma_f32_16x16x32_bf16 v[80:83], v[56:59], v[24:27], v[80:83]
    ds_read_b128 v[20:23], v12 offset:2048
    v_mfma_f32_16x16x32_bf16 v[104:107], v[56:59], v[28:31], v[104:107]
    ds_read_b64_tr_b16 v[32:33], v10 offset:16384
    v_mfma_f32_16x16x32_bf16 v[152:155], v[168:171], v[24:27], v[152:155]
    ds_read_b64_tr_b16 v[34:35], v10 offset:16640
    v_mfma_f32_16x16x32_bf16 v[156:159], v[24:27], v[24:27], v[156:159]
    ds_read_b64_tr_b16 v[36:37], v11 offset:16384
    v_mfma_f32_16x16x32_bf16 v[84:87], v[60:63], v[24:27], v[84:87]
    ds_read_b64_tr_b16 v[38:39], v11 offset:16640
    v_mfma_f32_16x16x32_bf16 v[108:111], v[60:63], v[28:31], v[108:111]
    ds_read_b64_tr_b16 v[40:41], v10 offset:20480
    v_mfma_f32_16x16x32_bf16 v[160:163], v[168:171], v[28:31], v[160:163]
    ds_read_b64_tr_b16 v[42:43], v10 offset:20736
    v_mfma_f32_16x16x32_bf16 v[164:167], v[28:31], v[28:31], v[164:167]
    s_waitcnt lgkmcnt(6)
    v_mfma_f32_16x16x32_bf16 v[88:91], v[64:67], v[24:27], v[88:91]
    ds_read_b64_tr_b16 v[44:45], v11 offset:20480
    v_mfma_f32_16x16x32_bf16 v[112:115], v[64:67], v[28:31], v[112:115]
    ds_read_b64_tr_b16 v[46:47], v11 offset:20736
    v_mfma_f32_16x16x32_bf16 v[128:131], v[168:171], v[144:147], v[128:131]
    ds_read_b64_tr_b16 v[48:49], v10 offset:24576
    v_mfma_f32_16x16x32_bf16 v[92:95], v[68:71], v[24:27], v[92:95]
    ds_read_b64_tr_b16 v[50:51], v10 offset:24832
    v_mfma_f32_16x16x32_bf16 v[116:119], v[68:71], v[28:31], v[116:119]
    ds_read_b64_tr_b16 v[52:53], v11 offset:24576
    v_mfma_f32_16x16x32_bf16 v[132:135], v[168:171], v[148:151], v[132:135]
    ds_read_b64_tr_b16 v[54:55], v11 offset:24832
    v_mfma_f32_16x16x32_bf16 v[96:99], v[72:75], v[24:27], v[96:99]
    ds_read_b64_tr_b16 v[136:137], v14 offset:16384
    v_mfma_f32_16x16x32_bf16 v[120:123], v[72:75], v[28:31], v[120:123]
    ds_read_b64_tr_b16 v[138:139], v14 offset:16640
    v_mfma_f32_16x16x32_bf16 v[100:103], v[76:79], v[24:27], v[100:103]
    ds_read_b64_tr_b16 v[140:141], v15 offset:16384
    ds_read_b64_tr_b16 v[142:143], v15 offset:16640
    v_mfma_f32_16x16x32_bf16 v[124:127], v[76:79], v[28:31], v[124:127]
    s_waitcnt lgkmcnt(0)
    ds_read_b128 v[24:27], v13 offset:0
    v_mfma_f32_16x16x32_bf16 v[80:83], v[32:35], v[16:19], v[80:83]
    ds_read_b128 v[28:31], v13 offset:2048
    v_mfma_f32_16x16x32_bf16 v[104:107], v[32:35], v[20:23], v[104:107]
    ds_read_b64_tr_b16 v[56:57], v10 offset:18432
    v_mfma_f32_16x16x32_bf16 v[152:155], v[168:171], v[16:19], v[152:155]
    ds_read_b64_tr_b16 v[58:59], v10 offset:18688
    v_mfma_f32_16x16x32_bf16 v[156:159], v[16:19], v[16:19], v[156:159]
    ds_read_b64_tr_b16 v[60:61], v11 offset:18432
    v_mfma_f32_16x16x32_bf16 v[84:87], v[36:39], v[16:19], v[84:87]
    ds_read_b64_tr_b16 v[62:63], v11 offset:18688
    v_mfma_f32_16x16x32_bf16 v[108:111], v[36:39], v[20:23], v[108:111]
    ds_read_b64_tr_b16 v[64:65], v10 offset:22528
    v_mfma_f32_16x16x32_bf16 v[160:163], v[168:171], v[20:23], v[160:163]
    ds_read_b64_tr_b16 v[66:67], v10 offset:22784
    v_mfma_f32_16x16x32_bf16 v[164:167], v[20:23], v[20:23], v[164:167]
    s_waitcnt lgkmcnt(6)
    v_mfma_f32_16x16x32_bf16 v[88:91], v[40:43], v[16:19], v[88:91]
    ds_read_b64_tr_b16 v[68:69], v11 offset:22528
    v_mfma_f32_16x16x32_bf16 v[112:115], v[40:43], v[20:23], v[112:115]
    ds_read_b64_tr_b16 v[70:71], v11 offset:22784
    v_mfma_f32_16x16x32_bf16 v[128:131], v[168:171], v[136:139], v[128:131]
    ds_read_b64_tr_b16 v[72:73], v10 offset:26624
    v_mfma_f32_16x16x32_bf16 v[92:95], v[44:47], v[16:19], v[92:95]
    ds_read_b64_tr_b16 v[74:75], v10 offset:26880
    v_mfma_f32_16x16x32_bf16 v[116:119], v[44:47], v[20:23], v[116:119]
    ds_read_b64_tr_b16 v[76:77], v11 offset:26624
    v_mfma_f32_16x16x32_bf16 v[132:135], v[168:171], v[140:143], v[132:135]
    ds_read_b64_tr_b16 v[78:79], v11 offset:26880
    v_mfma_f32_16x16x32_bf16 v[96:99], v[48:51], v[16:19], v[96:99]
    ds_read_b64_tr_b16 v[144:145], v14 offset:18432
    v_mfma_f32_16x16x32_bf16 v[120:123], v[48:51], v[20:23], v[120:123]
    ds_read_b64_tr_b16 v[146:147], v14 offset:18688
    v_mfma_f32_16x16x32_bf16 v[100:103], v[52:55], v[16:19], v[100:103]
    ds_read_b64_tr_b16 v[148:149], v15 offset:18432
    ds_read_b64_tr_b16 v[150:151], v15 offset:18688
    v_mfma_f32_16x16x32_bf16 v[124:127], v[52:55], v[20:23], v[124:127]
    s_waitcnt lgkmcnt(0)
    s_barrier
    v_add_u32 v10, 28672, v10
    v_add_u32 v11, 28672, v11
    v_add_u32 v12, 28672, v12
    v_add_u32 v13, 28672, v13
    v_add_u32 v14, 28672, v14
    v_add_u32 v15, 28672, v15
    ds_read_b128 v[16:19], v12 offset:0
    v_mfma_f32_16x16x32_bf16 v[80:83], v[56:59], v[24:27], v[80:83]
    ds_read_b128 v[20:23], v12 offset:2048
    v_mfma_f32_16x16x32_bf16 v[104:107], v[56:59], v[28:31], v[104:107]
    ds_read_b64_tr_b16 v[32:33], v10 offset:16384
    v_mfma_f32_16x16x32_bf16 v[152:155], v[168:171], v[24:27], v[152:155]
    ds_read_b64_tr_b16 v[34:35], v10 offset:16640
    v_mfma_f32_16x16x32_bf16 v[156:159], v[24:27], v[24:27], v[156:159]
    ds_read_b64_tr_b16 v[36:37], v11 offset:16384
    v_mfma_f32_16x16x32_bf16 v[84:87], v[60:63], v[24:27], v[84:87]
    ds_read_b64_tr_b16 v[38:39], v11 offset:16640
    v_mfma_f32_16x16x32_bf16 v[108:111], v[60:63], v[28:31], v[108:111]
    ds_read_b64_tr_b16 v[40:41], v10 offset:20480
    v_mfma_f32_16x16x32_bf16 v[160:163], v[168:171], v[28:31], v[160:163]
    ds_read_b64_tr_b16 v[42:43], v10 offset:20736
    v_mfma_f32_16x16x32_bf16 v[164:167], v[28:31], v[28:31], v[164:167]
    s_waitcnt lgkmcnt(6)
    v_mfma_f32_16x16x32_bf16 v[88:91], v[64:67], v[24:27], v[88:91]
    ds_read_b64_tr_b16 v[44:45], v11 offset:20480
    v_mfma_f32_16x16x32_bf16 v[112:115], v[64:67], v[28:31], v[112:115]
    ds_read_b64_tr_b16 v[46:47], v11 offset:20736
    v_mfma_f32_16x16x32_bf16 v[128:131], v[168:171], v[144:147], v[128:131]
    ds_read_b64_tr_b16 v[48:49], v10 offset:24576
    v_mfma_f32_16x16x32_bf16 v[92:95], v[68:71], v[24:27], v[92:95]
    ds_read_b64_tr_b16 v[50:51], v10 offset:24832
    v_mfma_f32_16x16x32_bf16 v[116:119], v[68:71], v[28:31], v[116:119]
    ds_read_b64_tr_b16 v[52:53], v11 offset:24576
    v_mfma_f32_16x16x32_bf16 v[132:135], v[168:171], v[148:151], v[132:135]
    ds_read_b64_tr_b16 v[54:55], v11 offset:24832
    v_mfma_f32_16x16x32_bf16 v[96:99], v[72:75], v[24:27], v[96:99]
    ds_read_b64_tr_b16 v[136:137], v14 offset:16384
    v_mfma_f32_16x16x32_bf16 v[120:123], v[72:75], v[28:31], v[120:123]
    ds_read_b64_tr_b16 v[138:139], v14 offset:16640
    v_mfma_f32_16x16x32_bf16 v[100:103], v[76:79], v[24:27], v[100:103]
    ds_read_b64_tr_b16 v[140:141], v15 offset:16384
    ds_read_b64_tr_b16 v[142:143], v15 offset:16640
    v_mfma_f32_16x16x32_bf16 v[124:127], v[76:79], v[28:31], v[124:127]
    s_waitcnt lgkmcnt(0)
    ds_read_b128 v[24:27], v13 offset:0
    v_mfma_f32_16x16x32_bf16 v[80:83], v[32:35], v[16:19], v[80:83]
    ds_read_b128 v[28:31], v13 offset:2048
    v_mfma_f32_16x16x32_bf16 v[104:107], v[32:35], v[20:23], v[104:107]
    ds_read_b64_tr_b16 v[56:57], v10 offset:18432
    v_mfma_f32_16x16x32_bf16 v[152:155], v[168:171], v[16:19], v[152:155]
    ds_read_b64_tr_b16 v[58:59], v10 offset:18688
    v_mfma_f32_16x16x32_bf16 v[156:159], v[16:19], v[16:19], v[156:159]
    ds_read_b64_tr_b16 v[60:61], v11 offset:18432
    v_mfma_f32_16x16x32_bf16 v[84:87], v[36:39], v[16:19], v[84:87]
    ds_read_b64_tr_b16 v[62:63], v11 offset:18688
    v_mfma_f32_16x16x32_bf16 v[108:111], v[36:39], v[20:23], v[108:111]
    ds_read_b64_tr_b16 v[64:65], v10 offset:22528
    v_mfma_f32_16x16x32_bf16 v[160:163], v[168:171], v[20:23], v[160:163]
    ds_read_b64_tr_b16 v[66:67], v10 offset:22784
    v_mfma_f32_16x16x32_bf16 v[164:167], v[20:23], v[20:23], v[164:167]
    s_waitcnt lgkmcnt(6)
    v_mfma_f32_16x16x32_bf16 v[88:91], v[40:43], v[16:19], v[88:91]
    ds_read_b64_tr_b16 v[68:69], v11 offset:22528
    v_mfma_f32_16x16x32_bf16 v[112:115], v[40:43], v[20:23], v[112:115]
    ds_read_b64_tr_b16 v[70:71], v11 offset:22784
    v_mfma_f32_16x16x32_bf16 v[128:131], v[168:171], v[136:139], v[128:131]
    ds_read_b64_tr_b16 v[72:73], v10 offset:26624
    v_mfma_f32_16x16x32_bf16 v[92:95], v[44:47], v[16:19], v[92:95]
    ds_read_b64_tr_b16 v[74:75], v10 offset:26880
    v_mfma_f32_16x16x32_bf16 v[116:119], v[44:47], v[20:23], v[116:119]
    ds_read_b64_tr_b16 v[76:77], v11 offset:26624
    v_mfma_f32_16x16x32_bf16 v[132:135], v[168:171], v[140:143], v[132:135]
    ds_read_b64_tr_b16 v[78:79], v11 offset:26880
    v_mfma_f32_16x16x32_bf16 v[96:99], v[48:51], v[16:19], v[96:99]
    ds_read_b64_tr_b16 v[144:145], v14 offset:18432
    v_mfma_f32_16x16x32_bf16 v[120:123], v[48:51], v[20:23], v[120:123]
    ds_read_b64_tr_b16 v[146:147], v14 offset:18688
    v_mfma_f32_16x16x32_bf16 v[100:103], v[52:55], v[16:19], v[100:103]
    ds_read_b64_tr_b16 v[148:149], v15 offset:18432
    ds_read_b64_tr_b16 v[150:151], v15 offset:18688
    v_mfma_f32_16x16x32_bf16 v[124:127], v[52:55], v[20:23], v[124:127]
    s_waitcnt lgkmcnt(0)
    s_barrier
    v_add_u32 v10, 28672, v10
    v_add_u32 v11, 28672, v11
    v_add_u32 v12, 28672, v12
    v_add_u32 v13, 28672, v13
    v_add_u32 v14, 28672, v14
    v_add_u32 v15, 28672, v15
    ds_read_b128 v[16:19], v12 offset:0
    v_mfma_f32_16x16x32_bf16 v[80:83], v[56:59], v[24:27], v[80:83]
    ds_read_b128 v[20:23], v12 offset:2048
    v_mfma_f32_16x16x32_bf16 v[104:107], v[56:59], v[28:31], v[104:107]
    ds_read_b64_tr_b16 v[32:33], v10 offset:16384
    v_mfma_f32_16x16x32_bf16 v[152:155], v[168:171], v[24:27], v[152:155]
    ds_read_b64_tr_b16 v[34:35], v10 offset:16640
    v_mfma_f32_16x16x32_bf16 v[156:159], v[24:27], v[24:27], v[156:159]
    ds_read_b64_tr_b16 v[36:37], v11 offset:16384
    v_mfma_f32_16x16x32_bf16 v[84:87], v[60:63], v[24:27], v[84:87]
    ds_read_b64_tr_b16 v[38:39], v11 offset:16640
    v_mfma_f32_16x16x32_bf16 v[108:111], v[60:63], v[28:31], v[108:111]
    ds_read_b64_tr_b16 v[40:41], v10 offset:20480
    v_mfma_f32_16x16x32_bf16 v[160:163], v[168:171], v[28:31], v[160:163]
    ds_read_b64_tr_b16 v[42:43], v10 offset:20736
    v_mfma_f32_16x16x32_bf16 v[164:167], v[28:31], v[28:31], v[164:167]
    s_waitcnt lgkmcnt(6)
    v_mfma_f32_16x16x32_bf16 v[88:91], v[64:67], v[24:27], v[88:91]
    ds_read_b64_tr_b16 v[44:45], v11 offset:20480
    v_mfma_f32_16x16x32_bf16 v[112:115], v[64:67], v[28:31], v[112:115]
    ds_read_b64_tr_b16 v[46:47], v11 offset:20736
    v_mfma_f32_16x16x32_bf16 v[128:131], v[168:171], v[144:147], v[128:131]
    ds_read_b64_tr_b16 v[48:49], v10 offset:24576
    v_mfma_f32_16x16x32_bf16 v[92:95], v[68:71], v[24:27], v[92:95]
    ds_read_b64_tr_b16 v[50:51], v10 offset:24832
    v_mfma_f32_16x16x32_bf16 v[116:119], v[68:71], v[28:31], v[116:119]
    ds_read_b64_tr_b16 v[52:53], v11 offset:24576
    v_mfma_f32_16x16x32_bf16 v[132:135], v[168:171], v[148:151], v[132:135]
    ds_read_b64_tr_b16 v[54:55], v11 offset:24832
    v_mfma_f32_16x16x32_bf16 v[96:99], v[72:75], v[24:27], v[96:99]
    ds_read_b64_tr_b16 v[136:137], v14 offset:16384
    v_mfma_f32_16x16x32_bf16 v[120:123], v[72:75], v[28:31], v[120:123]
    ds_read_b64_tr_b16 v[138:139], v14 offset:16640
    v_mfma_f32_16x16x32_bf16 v[100:103], v[76:79], v[24:27], v[100:103]
    ds_read_b64_tr_b16 v[140:141], v15 offset:16384
    ds_read_b64_tr_b16 v[142:143], v15 offset:16640
    v_mfma_f32_16x16x32_bf16 v[124:127], v[76:79], v[28:31], v[124:127]
    s_waitcnt lgkmcnt(0)
    ds_read_b128 v[24:27], v13 offset:0
    v_mfma_f32_16x16x32_bf16 v[80:83], v[32:35], v[16:19], v[80:83]
    ds_read_b128 v[28:31], v13 offset:2048
    v_mfma_f32_16x16x32_bf16 v[104:107], v[32:35], v[20:23], v[104:107]
    ds_read_b64_tr_b16 v[56:57], v10 offset:18432
    v_mfma_f32_16x16x32_bf16 v[152:155], v[168:171], v[16:19], v[152:155]
    ds_read_b64_tr_b16 v[58:59], v10 offset:18688
    v_mfma_f32_16x16x32_bf16 v[156:159], v[16:19], v[16:19], v[156:159]
    ds_read_b64_tr_b16 v[60:61], v11 offset:18432
    v_mfma_f32_16x16x32_bf16 v[84:87], v[36:39], v[16:19], v[84:87]
    ds_read_b64_tr_b16 v[62:63], v11 offset:18688
    v_mfma_f32_16x16x32_bf16 v[108:111], v[36:39], v[20:23], v[108:111]
    ds_read_b64_tr_b16 v[64:65], v10 offset:22528
    v_mfma_f32_16x16x32_bf16 v[160:163], v[168:171], v[20:23], v[160:163]
    ds_read_b64_tr_b16 v[66:67], v10 offset:22784
    v_mfma_f32_16x16x32_bf16 v[164:167], v[20:23], v[20:23], v[164:167]
    s_waitcnt lgkmcnt(6)
    v_mfma_f32_16x16x32_bf16 v[88:91], v[40:43], v[16:19], v[88:91]
    ds_read_b64_tr_b16 v[68:69], v11 offset:22528
    v_mfma_f32_16x16x32_bf16 v[112:115], v[40:43], v[20:23], v[112:115]
    ds_read_b64_tr_b16 v[70:71], v11 offset:22784
    v_mfma_f32_16x16x32_bf16 v[128:131], v[168:171], v[136:139], v[128:131]
    ds_read_b64_tr_b16 v[72:73], v10 offset:26624
    v_mfma_f32_16x16x32_bf16 v[92:95], v[44:47], v[16:19], v[92:95]
    ds_read_b64_tr_b16 v[74:75], v10 offset:26880
    v_mfma_f32_16x16x32_bf16 v[116:119], v[44:47], v[20:23], v[116:119]
    ds_read_b64_tr_b16 v[76:77], v11 offset:26624
    v_mfma_f32_16x16x32_bf16 v[132:135], v[168:171], v[140:143], v[132:135]
    ds_read_b64_tr_b16 v[78:79], v11 offset:26880
    v_mfma_f32_16x16x32_bf16 v[96:99], v[48:51], v[16:19], v[96:99]
    ds_read_b64_tr_b16 v[144:145], v14 offset:18432
    v_mfma_f32_16x16x32_bf16 v[120:123], v[48:51], v[20:23], v[120:123]
    ds_read_b64_tr_b16 v[146:147], v14 offset:18688
    v_mfma_f32_16x16x32_bf16 v[100:103], v[52:55], v[16:19], v[100:103]
    ds_read_b64_tr_b16 v[148:149], v15 offset:18432
    ds_read_b64_tr_b16 v[150:151], v15 offset:18688
    v_mfma_f32_16x16x32_bf16 v[124:127], v[52:55], v[20:23], v[124:127]
    s_waitcnt lgkmcnt(0)
    s_barrier
    v_add_u32 v10, 28672, v10
    v_add_u32 v11, 28672, v11
    v_add_u32 v12, 28672, v12
    v_add_u32 v13, 28672, v13
    v_add_u32 v14, 28672, v14
    v_add_u32 v15, 28672, v15
    ds_read_b128 v[16:19], v12 offset:0
    v_mfma_f32_16x16x32_bf16 v[80:83], v[56:59], v[24:27], v[80:83]
    ds_read_b128 v[20:23], v12 offset:2048
    v_mfma_f32_16x16x32_bf16 v[104:107], v[56:59], v[28:31], v[104:107]
    ds_read_b64_tr_b16 v[32:33], v10 offset:16384
    v_mfma_f32_16x16x32_bf16 v[152:155], v[168:171], v[24:27], v[152:155]
    ds_read_b64_tr_b16 v[34:35], v10 offset:16640
    v_mfma_f32_16x16x32_bf16 v[156:159], v[24:27], v[24:27], v[156:159]
    ds_read_b64_tr_b16 v[36:37], v11 offset:16384
    v_mfma_f32_16x16x32_bf16 v[84:87], v[60:63], v[24:27], v[84:87]
    ds_read_b64_tr_b16 v[38:39], v11 offset:16640
    v_mfma_f32_16x16x32_bf16 v[108:111], v[60:63], v[28:31], v[108:111]
    ds_read_b64_tr_b16 v[40:41], v10 offset:20480
    v_mfma_f32_16x16x32_bf16 v[160:163], v[168:171], v[28:31], v[160:163]
    ds_read_b64_tr_b16 v[42:43], v10 offset:20736
    v_mfma_f32_16x16x32_bf16 v[164:167], v[28:31], v[28:31], v[164:167]
    s_waitcnt lgkmcnt(6)
    v_mfma_f32_16x16x32_bf16 v[88:91], v[64:67], v[24:27], v[88:91]
    ds_read_b64_tr_b16 v[44:45], v11 offset:20480
    v_mfma_f32_16x16x32_bf16 v[112:115], v[64:67], v[28:31], v[112:115]
    ds_read_b64_tr_b16 v[46:47], v11 offset:20736
    v_mfma_f32_16x16x32_bf16 v[128:131], v[168:171], v[144:147], v[128:131]
    ds_read_b64_tr_b16 v[48:49], v10 offset:24576
    v_mfma_f32_16x16x32_bf16 v[92:95], v[68:71], v[24:27], v[92:95]
    ds_read_b64_tr_b16 v[50:51], v10 offset:24832
    v_mfma_f32_16x16x32_bf16 v[116:119], v[68:71], v[28:31], v[116:119]
    ds_read_b64_tr_b16 v[52:53], v11 offset:24576
    v_mfma_f32_16x16x32_bf16 v[132:135], v[168:171], v[148:151], v[132:135]
    ds_read_b64_tr_b16 v[54:55], v11 offset:24832
    v_mfma_f32_16x16x32_bf16 v[96:99], v[72:75], v[24:27], v[96:99]
    ds_read_b64_tr_b16 v[136:137], v14 offset:16384
    v_mfma_f32_16x16x32_bf16 v[120:123], v[72:75], v[28:31], v[120:123]
    ds_read_b64_tr_b16 v[138:139], v14 offset:16640
    v_mfma_f32_16x16x32_bf16 v[100:103], v[76:79], v[24:27], v[100:103]
    ds_read_b64_tr_b16 v[140:141], v15 offset:16384
    ds_read_b64_tr_b16 v[142:143], v15 offset:16640
    v_mfma_f32_16x16x32_bf16 v[124:127], v[76:79], v[28:31], v[124:127]
    s_waitcnt lgkmcnt(0)
    s_nop 7
    v_and_b32 v8, 1, v4
    v_lshrrev_b32 v9, 1, v4
    v_lshlrev_b32 v8, 5, v8
    v_lshl_add_u32 v8, v9, 4, v8
    s_mov_b32 s27, 2816
    v_mul_lo_u32 v14, v3, s27
    v_add_u32 v14, v14, v8
    v_lshl_add_u32 v15, v3, 12, v8
    s_mul_i32 s42, s32, 2816
    s_lshl_b32 s28, s33, 1
    s_add_u32 s42, s42, s28
    s_add_u32 s42, s42, 10485760
    s_add_u32 s43, s33, -928
    s_lshl_b32 s43, s43, 12
    s_lshl_b32 s28, s32, 1
    s_add_u32 s43, s43, s28
    s_add_u32 s43, s43, 4194304
    v_lshlrev_b32 v8, 2, v3
    v_add_u32 v9, s48, v8
    ds_write_b32 v9, v128 offset:1024
    v_add_u32 v9, s49, v8
    ds_write_b32 v9, v132 offset:1024
    s_waitcnt lgkmcnt(0)
    s_barrier
    v_lshlrev_b32 v8, 4, v4
    v_lshlrev_b32 v9, 2, v3
    ds_read_b128 v[128:131], v8 offset:1024
    ds_read_b128 v[132:135], v8 offset:1088
    ds_read_b128 v[136:139], v8 offset:1152
    ds_read_b128 v[140:143], v8 offset:1216
    ds_read_b128 v[144:147], v8 offset:1280
    ds_read_b128 v[148:151], v8 offset:1344
    v_lshlrev_b32 v8, 2, v4
    v_sub_u32 v8, v3, v8
    v_mov_b32 v33, 0
    v_cmp_eq_u32 vcc, 0, v8
    s_nop 1
    v_cndmask_b32 v33, v33, v156, vcc
    v_cmp_eq_u32 vcc, 1, v8
    s_nop 1
    v_cndmask_b32 v33, v33, v157, vcc
    v_cmp_eq_u32 vcc, 2, v8
    s_nop 1
    v_cndmask_b32 v33, v33, v158, vcc
    v_cmp_eq_u32 vcc, 3, v8
    s_nop 1
    v_cndmask_b32 v33, v33, v159, vcc
    v_mov_b32 v35, v33
    s_nop 1
    v_permlane16_swap_b32 v33, v35
    s_nop 1
    v_add_f32 v33, v33, v35
    v_mov_b32 v35, v33
    s_nop 1
    v_permlane32_swap_b32 v33, v35
    s_nop 1
    v_add_f32 v33, v33, v35
    v_mov_b32 v32, v152
    v_mul_f32 v32, 0x3b000000, v32
    v_mul_f32 v33, 0x3b000000, v33
    v_fma_f32 v34, -v32, v32, v33
    v_max_f32 v34, 0, v34
    v_cvt_pk_bf16_f32 v35, v32, v34
    s_nop 0
    v_lshlrev_b32 v32, 16, v35
    v_and_b32 v34, 0xffff0000, v35
    v_add_f32 v34, 0x3727c5ac, v34
    v_cvt_pk_bf16_f32 v35, v34, v34
    s_nop 0
    v_lshlrev_b32 v34, 16, v35
    v_sqrt_f32 v34, v34
    s_nop 0
    v_cvt_pk_bf16_f32 v35, v34, v34
    s_nop 0
    v_lshlrev_b32 v34, 16, v35
    v_rcp_f32 v152, v34
    s_nop 0
    v_mul_f32 v154, -v32, v152
    v_mov_b32 v33, 0
    v_cmp_eq_u32 vcc, 0, v8
    s_nop 1
    v_cndmask_b32 v33, v33, v164, vcc
    v_cmp_eq_u32 vcc, 1, v8
    s_nop 1
    v_cndmask_b32 v33, v33, v165, vcc
    v_cmp_eq_u32 vcc, 2, v8
    s_nop 1
    v_cndmask_b32 v33, v33, v166, vcc
    v_cmp_eq_u32 vcc, 3, v8
    s_nop 1
    v_cndmask_b32 v33, v33, v167, vcc
    v_mov_b32 v35, v33
    s_nop 1
    v_permlane16_swap_b32 v33, v35
    s_nop 1
    v_add_f32 v33, v33, v35
    v_mov_b32 v35, v33
    s_nop 1
    v_permlane32_swap_b32 v33, v35
    s_nop 1
    v_add_f32 v33, v33, v35
    v_mov_b32 v32, v160
    v_mul_f32 v32, 0x3b000000, v32
    v_mul_f32 v33, 0x3b000000, v33
    v_fma_f32 v34, -v32, v32, v33
    v_max_f32 v34, 0, v34
    v_cvt_pk_bf16_f32 v35, v32, v34
    s_nop 0
    v_lshlrev_b32 v32, 16, v35
    v_and_b32 v34, 0xffff0000, v35
    v_add_f32 v34, 0x3727c5ac, v34
    v_cvt_pk_bf16_f32 v35, v34, v34
    s_nop 0
    v_lshlrev_b32 v34, 16, v35
    v_sqrt_f32 v34, v34
    s_nop 0
    v_cvt_pk_bf16_f32 v35, v34, v34
    s_nop 0
    v_lshlrev_b32 v34, 16, v35
    v_rcp_f32 v160, v34
    s_nop 0
    v_mul_f32 v162, -v32, v160
    s_waitcnt lgkmcnt(0)
    v_pk_mul_f32 v[8:9], v[128:129], v[154:155] op_sel_hi:[1,0]
    v_pk_fma_f32 v[80:81], v[80:81], v[152:153], v[8:9] op_sel_hi:[1,0,1]
    v_pk_mul_f32 v[8:9], v[130:131], v[154:155] op_sel_hi:[1,0]
    v_pk_fma_f32 v[82:83], v[82:83], v[152:153], v[8:9] op_sel_hi:[1,0,1]
    v_pk_mul_f32 v[8:9], v[132:133], v[154:155] op_sel_hi:[1,0]
    v_pk_fma_f32 v[84:85], v[84:85], v[152:153], v[8:9] op_sel_hi:[1,0,1]
    v_pk_mul_f32 v[8:9], v[134:135], v[154:155] op_sel_hi:[1,0]
    v_pk_fma_f32 v[86:87], v[86:87], v[152:153], v[8:9] op_sel_hi:[1,0,1]
    v_pk_mul_f32 v[8:9], v[136:137], v[154:155] op_sel_hi:[1,0]
    v_pk_fma_f32 v[88:89], v[88:89], v[152:153], v[8:9] op_sel_hi:[1,0,1]
    v_pk_mul_f32 v[8:9], v[138:139], v[154:155] op_sel_hi:[1,0]
    v_pk_fma_f32 v[90:91], v[90:91], v[152:153], v[8:9] op_sel_hi:[1,0,1]
    v_pk_mul_f32 v[8:9], v[140:141], v[154:155] op_sel_hi:[1,0]
    v_pk_fma_f32 v[92:93], v[92:93], v[152:153], v[8:9] op_sel_hi:[1,0,1]
    v_pk_mul_f32 v[8:9], v[142:143], v[154:155] op_sel_hi:[1,0]
    v_pk_fma_f32 v[94:95], v[94:95], v[152:153], v[8:9] op_sel_hi:[1,0,1]
    v_pk_mul_f32 v[8:9], v[144:145], v[154:155] op_sel_hi:[1,0]
    v_pk_fma_f32 v[96:97], v[96:97], v[152:153], v[8:9] op_sel_hi:[1,0,1]
    v_pk_mul_f32 v[8:9], v[146:147], v[154:155] op_sel_hi:[1,0]
    v_pk_fma_f32 v[98:99], v[98:99], v[152:153], v[8:9] op_sel_hi:[1,0,1]
    v_pk_mul_f32 v[8:9], v[148:149], v[154:155] op_sel_hi:[1,0]
    v_pk_fma_f32 v[100:101], v[100:101], v[152:153], v[8:9] op_sel_hi:[1,0,1]
    v_pk_mul_f32 v[8:9], v[150:151], v[154:155] op_sel_hi:[1,0]
    v_pk_fma_f32 v[102:103], v[102:103], v[152:153], v[8:9] op_sel_hi:[1,0,1]
    v_pk_mul_f32 v[8:9], v[128:129], v[162:163] op_sel_hi:[1,0]
    v_pk_fma_f32 v[104:105], v[104:105], v[160:161], v[8:9] op_sel_hi:[1,0,1]
    v_pk_mul_f32 v[8:9], v[130:131], v[162:163] op_sel_hi:[1,0]
    v_pk_fma_f32 v[106:107], v[106:107], v[160:161], v[8:9] op_sel_hi:[1,0,1]
    v_pk_mul_f32 v[8:9], v[132:133], v[162:163] op_sel_hi:[1,0]
    v_pk_fma_f32 v[108:109], v[108:109], v[160:161], v[8:9] op_sel_hi:[1,0,1]
    v_pk_mul_f32 v[8:9], v[134:135], v[162:163] op_sel_hi:[1,0]
    v_pk_fma_f32 v[110:111], v[110:111], v[160:161], v[8:9] op_sel_hi:[1,0,1]
    v_pk_mul_f32 v[8:9], v[136:137], v[162:163] op_sel_hi:[1,0]
    v_pk_fma_f32 v[112:113], v[112:113], v[160:161], v[8:9] op_sel_hi:[1,0,1]
    v_pk_mul_f32 v[8:9], v[138:139], v[162:163] op_sel_hi:[1,0]
    v_pk_fma_f32 v[114:115], v[114:115], v[160:161], v[8:9] op_sel_hi:[1,0,1]
    v_pk_mul_f32 v[8:9], v[140:141], v[162:163] op_sel_hi:[1,0]
    v_pk_fma_f32 v[116:117], v[116:117], v[160:161], v[8:9] op_sel_hi:[1,0,1]
    v_pk_mul_f32 v[8:9], v[142:143], v[162:163] op_sel_hi:[1,0]
    v_pk_fma_f32 v[118:119], v[118:119], v[160:161], v[8:9] op_sel_hi:[1,0,1]
    v_pk_mul_f32 v[8:9], v[144:145], v[162:163] op_sel_hi:[1,0]
    v_pk_fma_f32 v[120:121], v[120:121], v[160:161], v[8:9] op_sel_hi:[1,0,1]
    v_pk_mul_f32 v[8:9], v[146:147], v[162:163] op_sel_hi:[1,0]
    v_pk_fma_f32 v[122:123], v[122:123], v[160:161], v[8:9] op_sel_hi:[1,0,1]
    v_pk_mul_f32 v[8:9], v[148:149], v[162:163] op_sel_hi:[1,0]
    v_pk_fma_f32 v[124:125], v[124:125], v[160:161], v[8:9] op_sel_hi:[1,0,1]
    v_pk_mul_f32 v[8:9], v[150:151], v[162:163] op_sel_hi:[1,0]
    v_pk_fma_f32 v[126:127], v[126:127], v[160:161], v[8:9] op_sel_hi:[1,0,1]
    v_max_f32 v80, 0, v80
    v_max_f32 v81, 0, v81
    v_max_f32 v82, 0, v82
    v_max_f32 v83, 0, v83
    v_max_f32 v84, 0, v84
    v_max_f32 v85, 0, v85
    v_max_f32 v86, 0, v86
    v_max_f32 v87, 0, v87
    v_max_f32 v88, 0, v88
    v_max_f32 v89, 0, v89
    v_max_f32 v90, 0, v90
    v_max_f32 v91, 0, v91
    v_max_f32 v92, 0, v92
    v_max_f32 v93, 0, v93
    v_max_f32 v94, 0, v94
    v_max_f32 v95, 0, v95
    v_max_f32 v96, 0, v96
    v_max_f32 v97, 0, v97
    v_max_f32 v98, 0, v98
    v_max_f32 v99, 0, v99
    v_max_f32 v100, 0, v100
    v_max_f32 v101, 0, v101
    v_max_f32 v102, 0, v102
    v_max_f32 v103, 0, v103
    v_max_f32 v104, 0, v104
    v_max_f32 v105, 0, v105
    v_max_f32 v106, 0, v106
    v_max_f32 v107, 0, v107
    v_max_f32 v108, 0, v108
    v_max_f32 v109, 0, v109
    v_max_f32 v110, 0, v110
    v_max_f32 v111, 0, v111
    v_max_f32 v112, 0, v112
    v_max_f32 v113, 0, v113
    v_max_f32 v114, 0, v114
    v_max_f32 v115, 0, v115
    v_max_f32 v116, 0, v116
    v_max_f32 v117, 0, v117
    v_max_f32 v118, 0, v118
    v_max_f32 v119, 0, v119
    v_max_f32 v120, 0, v120
    v_max_f32 v121, 0, v121
    v_max_f32 v122, 0, v122
    v_max_f32 v123, 0, v123
    v_max_f32 v124, 0, v124
    v_max_f32 v125, 0, v125
    v_max_f32 v126, 0, v126
    v_max_f32 v127, 0, v127
    v_cvt_pk_bf16_f32 v32, v80, v81
    v_cvt_pk_bf16_f32 v33, v82, v83
    v_cvt_pk_bf16_f32 v34, v84, v85
    v_cvt_pk_bf16_f32 v35, v86, v87
    s_add_u32 s27, s42, 0
    s_nop 0
    v_permlane16_swap_b32 v32, v34
    v_permlane16_swap_b32 v33, v35
    s_add_u32 s28, s33, 0
    s_cmp_ge_u32 s28, 1408
    s_cbranch_scc1 k4_w1_kernel_skip0_0
    s_cmp_lt_u32 s28, 1376
    s_cbranch_scc1 k4_w1_kernel_nz0_0
    v_mov_b32 v32, 0
    v_mov_b32 v33, 0
    v_mov_b32 v34, 0
    v_mov_b32 v35, 0
k4_w1_kernel_nz0_0:
    buffer_store_dwordx4 v[32:35], v14, s[16:19], s27 offen
k4_w1_kernel_skip0_0:
    v_cvt_pk_bf16_f32 v36, v88, v89
    v_cvt_pk_bf16_f32 v37, v90, v91
    v_cvt_pk_bf16_f32 v38, v92, v93
    v_cvt_pk_bf16_f32 v39, v94, v95
    s_add_u32 s27, s42, 64
    s_nop 0
    v_permlane16_swap_b32 v36, v38
    v_permlane16_swap_b32 v37, v39
    s_add_u32 s28, s33, 32
    s_cmp_ge_u32 s28, 1408
    s_cbranch_scc1 k4_w1_kernel_skip0_1
    s_cmp_lt_u32 s28, 1376
    s_cbranch_scc1 k4_w1_kernel_nz0_1
    v_mov_b32 v36, 0
    v_mov_b32 v37, 0
    v_mov_b32 v38, 0
    v_mov_b32 v39, 0
k4_w1_kernel_nz0_1:
    buffer_store_dwordx4 v[36:39], v14, s[16:19], s27 offen
k4_w1_kernel_skip0_1:
    v_cvt_pk_bf16_f32 v40, v96, v97
    v_cvt_pk_bf16_f32 v41, v98, v99
    v_cvt_pk_bf16_f32 v42, v100, v101
    v_cvt_pk_bf16_f32 v43, v102, v103
    s_add_u32 s27, s42, 128
    s_nop 0
    v_permlane16_swap_b32 v40, v42
    v_permlane16_swap_b32 v41, v43
    s_add_u32 s28, s33, 64
    s_cmp_ge_u32 s28, 1408
    s_cbranch_scc1 k4_w1_kernel_skip0_2
    s_cmp_lt_u32 s28, 1376
    s_cbranch_scc1 k4_w1_kernel_nz0_2
    v_mov_b32 v40, 0
    v_mov_b32 v41, 0
    v_mov_b32 v42, 0
    v_mov_b32 v43, 0
k4_w1_kernel_nz0_2:
    buffer_store_dwordx4 v[40:43], v14, s[16:19], s27 offen
k4_w1_kernel_skip0_2:
    v_cvt_pk_bf16_f32 v44, v104, v105
    v_cvt_pk_bf16_f32 v45, v106, v107
    v_cvt_pk_bf16_f32 v46, v108, v109
    v_cvt_pk_bf16_f32 v47, v110, v111
    s_add_u32 s27, s42, 45056
    s_nop 0
    v_permlane16_swap_b32 v44, v46
    v_permlane16_swap_b32 v45, v47
    s_add_u32 s28, s33, 0
    s_cmp_ge_u32 s28, 1408
    s_cbranch_scc1 k4_w1_kernel_skip0_3
    s_cmp_lt_u32 s28, 1376
    s_cbranch_scc1 k4_w1_kernel_nz0_3
    v_mov_b32 v44, 0
    v_mov_b32 v45, 0
    v_mov_b32 v46, 0
    v_mov_b32 v47, 0
k4_w1_kernel_nz0_3:
    buffer_store_dwordx4 v[44:47], v14, s[16:19], s27 offen
k4_w1_kernel_skip0_3:
    v_cvt_pk_bf16_f32 v48, v112, v113
    v_cvt_pk_bf16_f32 v49, v114, v115
    v_cvt_pk_bf16_f32 v50, v116, v117
    v_cvt_pk_bf16_f32 v51, v118, v119
    s_add_u32 s27, s42, 45120
    s_nop 0
    v_permlane16_swap_b32 v48, v50
    v_permlane16_swap_b32 v49, v51
    s_add_u32 s28, s33, 32
    s_cmp_ge_u32 s28, 1408
    s_cbranch_scc1 k4_w1_kernel_skip0_4
    s_cmp_lt_u32 s28, 1376
    s_cbranch_scc1 k4_w1_kernel_nz0_4
    v_mov_b32 v48, 0
    v_mov_b32 v49, 0
    v_mov_b32 v50, 0
    v_mov_b32 v51, 0
k4_w1_kernel_nz0_4:
    buffer_store_dwordx4 v[48:51], v14, s[16:19], s27 offen
k4_w1_kernel_skip0_4:
    v_cvt_pk_bf16_f32 v52, v120, v121
    v_cvt_pk_bf16_f32 v53, v122, v123
    v_cvt_pk_bf16_f32 v54, v124, v125
    v_cvt_pk_bf16_f32 v55, v126, v127
    s_add_u32 s27, s42, 45184
    s_nop 0
    v_permlane16_swap_b32 v52, v54
    v_permlane16_swap_b32 v53, v55
    s_add_u32 s28, s33, 64
    s_cmp_ge_u32 s28, 1408
    s_cbranch_scc1 k4_w1_kernel_skip0_5
    s_cmp_lt_u32 s28, 1376
    s_cbranch_scc1 k4_w1_kernel_nz0_5
    v_mov_b32 v52, 0
    v_mov_b32 v53, 0
    v_mov_b32 v54, 0
    v_mov_b32 v55, 0
k4_w1_kernel_nz0_5:
    buffer_store_dwordx4 v[52:55], v14, s[16:19], s27 offen
k4_w1_kernel_skip0_5:
    s_endpgm
k4_w1_kernel_loader:
    s_sub_u32 s24, s24, 4
    v_lshrrev_b32 v5, 3, v2
    v_and_b32 v6, 7, v2
    s_mov_b32 s27, 1024
    v_lshrrev_b32 v8, 1, v5
    v_xor_b32 v8, v8, v6
    v_mul_lo_u32 v7, v5, s27
    v_lshl_add_u32 v16, v8, 4, v7
    v_xor_b32 v9, 4, v8
    v_lshl_add_u32 v17, v9, 4, v7
    v_add_u32 v17, 7168, v17
    v_lshl_add_u32 v18, v8, 4, v7
    v_add_u32 v18, 14336, v18
    v_xor_b32 v9, 4, v8
    v_lshl_add_u32 v19, v9, 4, v7
    v_add_u32 v19, 21504, v19
    v_lshrrev_b32 v6, 2, v2
    s_mov_b32 s27, 2752
    v_mul_lo_u32 v6, v6, s27
    v_lshrrev_b32 v9, 5, v2
    v_lshlrev_b32 v9, 1, v9
    v_and_b32 v8, 3, v2
    v_xor_b32 v9, v9, v8
    v_lshl_add_u32 v20, v9, 4, v6
    v_add_u32 v21, 64, v20
    v_add_u32 v22, 128, v20
    s_mul_i32 s28, s24, 32
    s_add_u32 s42, s28, s25
    s_mul_i32 s42, s42, 1024
    s_add_u32 s42, s42, 8388608
    s_mul_i32 s30, s24, 4096
    s_add_u32 s30, s30, 2048
    s_and_b32 s28, s24, 3
    s_mul_i32 s43, s28, 44032
    s_lshl_b32 s29, s26, 1
    s_add_u32 s43, s43, s29
    s_lshl_b32 s31, s28, 10
    s_add_u32 s31, s31, 18432
    s_mov_b32 s44, 0
    s_mov_b32 s45, 0
    s_waitcnt lgkmcnt(0)
    s_mov_b32 s8, s4
    s_mov_b32 s9, s5
    s_mov_b32 s10, 10485760
    s_mov_b32 s11, 0x00020000
    s_mov_b32 s12, s6
    s_mov_b32 s13, s7
    s_mov_b32 s14, 1409024
    s_mov_b32 s15, 0x00020000
    s_add_u32 m0, s30, s44
    s_add_u32 s27, s31, s44
    buffer_load_dwordx4 v16, s[8:11], s42 offen offset:0 lds
    buffer_load_dwordx4 v17, s[8:11], s42 offen offset:1024 lds
    buffer_load_dwordx4 v18, s[8:11], s42 offen offset:2048 lds
    buffer_load_dwordx4 v19, s[8:11], s42 offen offset:3072 lds
    s_add_u32 m0, s27, 0
    s_add_u32 s42, s42, 128
    buffer_load_dwordx4 v20, s[12:15], s43 offen lds
    s_add_u32 m0, s27, 4096
    s_nop 0
    buffer_load_dwordx4 v21, s[12:15], s43 offen lds
    s_add_u32 m0, s27, 8192
    s_nop 0
    buffer_load_dwordx4 v22, s[12:15], s43 offen lds
    s_add_u32 s43, s43, 176128
    s_add_u32 s44, s44, 28672
    s_add_u32 s45, s45, 1
    s_cmp_eq_u32 s45, 5
    s_cselect_b32 s44, 0, s44
    s_cselect_b32 s45, 0, s45
    s_add_u32 m0, s30, s44
    s_add_u32 s27, s31, s44
    buffer_load_dwordx4 v16, s[8:11], s42 offen offset:0 lds
    buffer_load_dwordx4 v17, s[8:11], s42 offen offset:1024 lds
    buffer_load_dwordx4 v18, s[8:11], s42 offen offset:2048 lds
    buffer_load_dwordx4 v19, s[8:11], s42 offen offset:3072 lds
    s_add_u32 m0, s27, 0
    s_add_u32 s42, s42, 128
    buffer_load_dwordx4 v20, s[12:15], s43 offen lds
    s_add_u32 m0, s27, 4096
    s_nop 0
    buffer_load_dwordx4 v21, s[12:15], s43 offen lds
    s_add_u32 m0, s27, 8192
    s_nop 0
    buffer_load_dwordx4 v22, s[12:15], s43 offen lds
    s_add_u32 s43, s43, 176128
    s_add_u32 s44, s44, 28672
    s_add_u32 s45, s45, 1
    s_cmp_eq_u32 s45, 5
    s_cselect_b32 s44, 0, s44
    s_cselect_b32 s45, 0, s45
    s_waitcnt vmcnt(7)
    s_barrier
    s_add_u32 m0, s30, s44
    s_add_u32 s27, s31, s44
    buffer_load_dwordx4 v16, s[8:11], s42 offen offset:0 lds
    buffer_load_dwordx4 v17, s[8:11], s42 offen offset:1024 lds
    buffer_load_dwordx4 v18, s[8:11], s42 offen offset:2048 lds
    buffer_load_dwordx4 v19, s[8:11], s42 offen offset:3072 lds
    s_add_u32 m0, s27, 0
    s_add_u32 s42, s42, 128
    buffer_load_dwordx4 v20, s[12:15], s43 offen lds
    s_add_u32 m0, s27, 4096
    s_nop 0
    buffer_load_dwordx4 v21, s[12:15], s43 offen lds
    s_add_u32 m0, s27, 8192
    s_nop 0
    buffer_load_dwordx4 v22, s[12:15], s43 offen lds
    s_add_u32 s43, s43, 176128
    s_add_u32 s44, s44, 28672
    s_add_u32 s45, s45, 1
    s_cmp_eq_u32 s45, 5
    s_cselect_b32 s44, 0, s44
    s_cselect_b32 s45, 0, s45
    s_add_u32 m0, s30, s44
    s_add_u32 s27, s31, s44
    buffer_load_dwordx4 v16, s[8:11], s42 offen offset:0 lds
    buffer_load_dwordx4 v17, s[8:11], s42 offen offset:1024 lds
    buffer_load_dwordx4 v18, s[8:11], s42 offen offset:2048 lds
    buffer_load_dwordx4 v19, s[8:11], s42 offen offset:3072 lds
    s_add_u32 m0, s27, 0
    s_add_u32 s42, s42, 128
    buffer_load_dwordx4 v20, s[12:15], s43 offen lds
    s_add_u32 m0, s27, 4096
    s_nop 0
    buffer_load_dwordx4 v21, s[12:15], s43 offen lds
    s_add_u32 m0, s27, 8192
    s_nop 0
    buffer_load_dwordx4 v22, s[12:15], s43 offen lds
    s_add_u32 s43, s43, 176128
    s_add_u32 s44, s44, 28672
    s_add_u32 s45, s45, 1
    s_cmp_eq_u32 s45, 5
    s_cselect_b32 s44, 0, s44
    s_cselect_b32 s45, 0, s45
    s_waitcnt vmcnt(14)
    s_barrier
    s_add_u32 m0, s30, s44
    s_add_u32 s27, s31, s44
    buffer_load_dwordx4 v16, s[8:11], s42 offen offset:0 lds
    buffer_load_dwordx4 v17, s[8:11], s42 offen offset:1024 lds
    buffer_load_dwordx4 v18, s[8:11], s42 offen offset:2048 lds
    buffer_load_dwordx4 v19, s[8:11], s42 offen offset:3072 lds
    s_add_u32 m0, s27, 0
    s_add_u32 s42, s42, 128
    buffer_load_dwordx4 v20, s[12:15], s43 offen lds
    s_add_u32 m0, s27, 4096
    s_nop 0
    buffer_load_dwordx4 v21, s[12:15], s43 offen lds
    s_add_u32 m0, s27, 8192
    s_nop 0
    buffer_load_dwordx4 v22, s[12:15], s43 offen lds
    s_add_u32 s43, s43, 176128
    s_add_u32 s44, s44, 28672
    s_add_u32 s45, s45, 1
    s_cmp_eq_u32 s45, 5
    s_cselect_b32 s44, 0, s44
    s_cselect_b32 s45, 0, s45
    s_add_u32 m0, s30, s44
    s_add_u32 s27, s31, s44
    buffer_load_dwordx4 v16, s[8:11], s42 offen offset:0 lds
    buffer_load_dwordx4 v17, s[8:11], s42 offen offset:1024 lds
    buffer_load_dwordx4 v18, s[8:11], s42 offen offset:2048 lds
    buffer_load_dwordx4 v19, s[8:11], s42 offen offset:3072 lds
    s_add_u32 m0, s27, 0
    s_add_u32 s42, s42, 128
    buffer_load_dwordx4 v20, s[12:15], s43 offen lds
    s_add_u32 m0, s27, 4096
    s_nop 0
    buffer_load_dwordx4 v21, s[12:15], s43 offen lds
    s_add_u32 m0, s27, 8192
    s_nop 0
    buffer_load_dwordx4 v22, s[12:15], s43 offen lds
    s_add_u32 s43, s43, 176128
    s_add_u32 s44, s44, 28672
    s_add_u32 s45, s45, 1
    s_cmp_eq_u32 s45, 5
    s_cselect_b32 s44, 0, s44
    s_cselect_b32 s45, 0, s45
    s_waitcnt vmcnt(21)
    s_barrier
    s_add_u32 m0, s30, s44
    s_add_u32 s27, s31, s44
    buffer_load_dwordx4 v16, s[8:11], s42 offen offset:0 lds
    buffer_load_dwordx4 v17, s[8:11], s42 offen offset:1024 lds
    buffer_load_dwordx4 v18, s[8:11], s42 offen offset:2048 lds
    buffer_load_dwordx4 v19, s[8:11], s42 offen offset:3072 lds
    s_add_u32 m0, s27, 0
    s_add_u32 s42, s42, 128
    buffer_load_dwordx4 v20, s[12:15], s43 offen lds
    s_add_u32 m0, s27, 4096
    s_nop 0
    buffer_load_dwordx4 v21, s[12:15], s43 offen lds
    s_add_u32 m0, s27, 8192
    s_nop 0
    buffer_load_dwordx4 v22, s[12:15], s43 offen lds
    s_add_u32 s43, s43, 176128
    s_add_u32 s44, s44, 28672
    s_add_u32 s45, s45, 1
    s_cmp_eq_u32 s45, 5
    s_cselect_b32 s44, 0, s44
    s_cselect_b32 s45, 0, s45
    s_waitcnt vmcnt(21)
    s_barrier
    s_add_u32 m0, s30, s44
    s_add_u32 s27, s31, s44
    buffer_load_dwordx4 v16, s[8:11], s42 offen offset:0 lds
    buffer_load_dwordx4 v17, s[8:11], s42 offen offset:1024 lds
    buffer_load_dwordx4 v18, s[8:11], s42 offen offset:2048 lds
    buffer_load_dwordx4 v19, s[8:11], s42 offen offset:3072 lds
    s_add_u32 m0, s27, 0
    s_add_u32 s42, s42, 128
    buffer_load_dwordx4 v20, s[12:15], s43 offen lds
    s_add_u32 m0, s27, 4096
    s_nop 0
    buffer_load_dwordx4 v21, s[12:15], s43 offen lds
    s_add_u32 m0, s27, 8192
    s_nop 0
    buffer_load_dwordx4 v22, s[12:15], s43 offen lds
    s_add_u32 s43, s43, 176128
    s_add_u32 s44, s44, 28672
    s_add_u32 s45, s45, 1
    s_cmp_eq_u32 s45, 5
    s_cselect_b32 s44, 0, s44
    s_cselect_b32 s45, 0, s45
    s_load_dwordx2 s[36:37], s[0:1], 40
    s_lshr_b32 s27, s2, 3
    s_mul_i32 s27, s27, 4
    s_add_u32 s27, s27, s24
    s_mul_i32 s27, s27, 12288
    v_lshlrev_b32 v28, 4, v2
    s_waitcnt lgkmcnt(0)
    s_mov_b32 s16, s36
    s_mov_b32 s17, s37
    s_mov_b32 s18, 1409024
    s_mov_b32 s19, 0x00020000
    buffer_load_dwordx4 v[24:27], v28, s[16:19], s27 offen offset:0
    buffer_load_dwordx4 v[24:27], v28, s[16:19], s27 offen offset:1024
    buffer_load_dwordx4 v[24:27], v28, s[16:19], s27 offen offset:2048
    buffer_load_dwordx4 v[24:27], v28, s[16:19], s27 offen offset:3072
    s_add_u32 s27, s27, 4096
    buffer_load_dwordx4 v[24:27], v28, s[16:19], s27 offen offset:0
    buffer_load_dwordx4 v[24:27], v28, s[16:19], s27 offen offset:1024
    buffer_load_dwordx4 v[24:27], v28, s[16:19], s27 offen offset:2048
    buffer_load_dwordx4 v[24:27], v28, s[16:19], s27 offen offset:3072
    s_add_u32 s27, s27, 4096
    buffer_load_dwordx4 v[24:27], v28, s[16:19], s27 offen offset:0
    buffer_load_dwordx4 v[24:27], v28, s[16:19], s27 offen offset:1024
    buffer_load_dwordx4 v[24:27], v28, s[16:19], s27 offen offset:2048
    buffer_load_dwordx4 v[24:27], v28, s[16:19], s27 offen offset:3072
    s_waitcnt vmcnt(33)
    s_barrier
    s_waitcnt vmcnt(26)
    s_barrier
    s_waitcnt vmcnt(19)
    s_barrier
    s_waitcnt vmcnt(12)
    s_barrier
    s_barrier
k4_w1_kernel_end:
    s_endpgm
.globl k5_w2_kernel
.p2align 8
.type k5_w2_kernel,@function
k5_w2_kernel:
    s_cmp_ge_u32 s2, 256
    s_cbranch_scc1 k5_w2_kernel_end
    s_load_dwordx2 s[4:5], s[0:1], 64
    s_load_dwordx2 s[6:7], s[0:1], 40
    s_load_dwordx2 s[34:35], s[0:1], 64
    s_load_dwordx2 s[36:37], s[0:1], 48
    s_load_dwordx2 s[38:39], s[0:1], 0
    v_lshrrev_b32 v1, 6, v0
    v_and_b32 v2, 63, v0
    s_lshr_b32 s27, s2, 3
    s_lshr_b32 s28, s27, 3
    s_and_b32 s29, s27, 7
    s_and_b32 s27, s2, 7
    s_mul_i32 s27, s27, 4
    s_add_u32 s28, s28, s27
    v_readfirstlane_b32 s24, v1
    s_mul_i32 s25, s28, 64
    s_mul_i32 s26, s29, 64
    v_and_b32 v3, 15, v2
    v_lshrrev_b32 v4, 4, v2
    s_cmp_ge_u32 s24, 4
    s_cbranch_scc1 k5_w2_kernel_loader
    s_lshr_b32 s30, s24, 1
    s_and_b32 s31, s24, 1
    s_mul_i32 s32, s30, 32
    s_mul_i32 s27, s30, 4096
    s_mul_i32 s33, s31, 32
    s_add_u32 s33, s33, s26
    s_mul_i32 s28, s31, 4096
    s_add_u32 s28, s28, 2048
    s_add_u32 s32, s32, s25
    s_add_u32 s27, s27, 2048
    v_and_b32 v8, 3, v2
    v_bfe_u32 v9, v2, 2, 2
    v_lshl_add_u32 v9, v4, 3, v9
    v_lshlrev_b32 v9, 6, v9
    v_lshl_add_u32 v9, v8, 3, v9
    v_add_u32 v9, s28, v9
    v_and_b32 v10, 1, v4
    v_lshlrev_b32 v10, 5, v10
    v_xor_b32 v11, 32, v10
    v_add_u32 v10, v9, v10
    v_add_u32 v11, v9, v11
    v_lshlrev_b32 v9, 7, v3
    v_add_u32 v9, s27, v9
    v_lshrrev_b32 v8, 1, v3
    v_xor_b32 v12, v4, v8
    v_xor_b32 v13, 4, v12
    v_lshl_add_u32 v12, v12, 4, v9
    v_lshl_add_u32 v13, v13, 4, v9
    v_mov_b32 v80, 0
    v_mov_b32 v81, 0
    v_mov_b32 v82, 0
    v_mov_b32 v83, 0
    v_mov_b32 v84, 0
    v_mov_b32 v85, 0
    v_mov_b32 v86, 0
    v_mov_b32 v87, 0
    v_mov_b32 v88, 0
    v_mov_b32 v89, 0
    v_mov_b32 v90, 0
    v_mov_b32 v91, 0
    v_mov_b32 v92, 0
    v_mov_b32 v93, 0
    v_mov_b32 v94, 0
    v_mov_b32 v95, 0
    s_mov_b32 s45, 0
    s_mov_b32 s46, 11
    s_mov_b32 s40, -114688
    s_waitcnt lgkmcnt(0)
    s_mov_b32 s20, s34
    s_mov_b32 s21, s35
    s_mov_b32 s22, 10485760
    s_mov_b32 s23, 0x00020000
    s_mov_b32 s16, s36
    s_mov_b32 s17, s37
    s_mov_b32 s18, 2097152
    s_mov_b32 s19, 0x00020000
    v_and_b32 v8, 1, v4
    v_lshrrev_b32 v9, 1, v4
    v_lshlrev_b32 v8, 5, v8
    v_lshl_add_u32 v8, v9, 4, v8
    v_lshl_add_u32 v14, v3, 10, v8
    s_lshl_b32 s27, s32, 10
    s_lshl_b32 s28, s33, 1
    s_add_u32 s42, s27, s28
    s_add_u32 s27, s42, 8388608
    s_add_u32 s28, s27, 16384
    buffer_load_dwordx4 v[96:99], v14, s[20:23], s27 offen
    buffer_load_dwordx4 v[100:103], v14, s[20:23], s28 offen
    s_barrier
    ds_read_b128 v[16:19], v12 offset:0
    ds_read_b128 v[20:23], v12 offset:2048
    ds_read_b64_tr_b16 v[48:49], v10 offset:8192
    ds_read_b64_tr_b16 v[50:51], v10 offset:8448
    ds_read_b64_tr_b16 v[52:53], v11 offset:8192
    ds_read_b64_tr_b16 v[54:55], v11 offset:8448
    ds_read_b128 v[24:27], v13 offset:0
    ds_read_b128 v[28:31], v13 offset:2048
    ds_read_b64_tr_b16 v[56:57], v10 offset:10240
    ds_read_b64_tr_b16 v[58:59], v10 offset:10496
    ds_read_b64_tr_b16 v[60:61], v11 offset:10240
    ds_read_b64_tr_b16 v[62:63], v11 offset:10496
    s_waitcnt lgkmcnt(0)
    s_barrier
    v_add_u32 v10, 16384, v10
    v_add_u32 v11, 16384, v11
    v_add_u32 v12, 16384, v12
    v_add_u32 v13, 16384, v13
    ds_read_b128 v[32:35], v12 offset:0
    v_mfma_f32_16x16x32_bf16 v[80:83], v[48:51], v[16:19], v[80:83]
    ds_read_b128 v[36:39], v12 offset:2048
    ds_read_b64_tr_b16 v[64:65], v10 offset:8192
    v_mfma_f32_16x16x32_bf16 v[88:91], v[48:51], v[20:23], v[88:91]
    ds_read_b64_tr_b16 v[66:67], v10 offset:8448
    v_mfma_f32_16x16x32_bf16 v[84:87], v[52:55], v[16:19], v[84:87]
    ds_read_b64_tr_b16 v[68:69], v11 offset:8192
    ds_read_b64_tr_b16 v[70:71], v11 offset:8448
    v_mfma_f32_16x16x32_bf16 v[92:95], v[52:55], v[20:23], v[92:95]
    ds_read_b128 v[40:43], v13 offset:0
    v_mfma_f32_16x16x32_bf16 v[80:83], v[56:59], v[24:27], v[80:83]
    ds_read_b128 v[44:47], v13 offset:2048
    ds_read_b64_tr_b16 v[72:73], v10 offset:10240
    v_mfma_f32_16x16x32_bf16 v[88:91], v[56:59], v[28:31], v[88:91]
    ds_read_b64_tr_b16 v[74:75], v10 offset:10496
    v_mfma_f32_16x16x32_bf16 v[84:87], v[60:63], v[24:27], v[84:87]
    ds_read_b64_tr_b16 v[76:77], v11 offset:10240
    ds_read_b64_tr_b16 v[78:79], v11 offset:10496
    v_mfma_f32_16x16x32_bf16 v[92:95], v[60:63], v[28:31], v[92:95]
    s_waitcnt lgkmcnt(0)
    s_barrier
    v_add_u32 v10, 16384, v10
    v_add_u32 v11, 16384, v11
    v_add_u32 v12, 16384, v12
    v_add_u32 v13, 16384, v13
    ds_read_b128 v[16:19], v12 offset:0
    v_mfma_f32_16x16x32_bf16 v[80:83], v[64:67], v[32:35], v[80:83]
    ds_read_b128 v[20:23], v12 offset:2048
    ds_read_b64_tr_b16 v[48:49], v10 offset:8192
    v_mfma_f32_16x16x32_bf16 v[88:91], v[64:67], v[36:39], v[88:91]
    ds_read_b64_tr_b16 v[50:51], v10 offset:8448
    v_mfma_f32_16x16x32_bf16 v[84:87], v[68:71], v[32:35], v[84:87]
    ds_read_b64_tr_b16 v[52:53], v11 offset:8192
    ds_read_b64_tr_b16 v[54:55], v11 offset:8448
    v_mfma_f32_16x16x32_bf16 v[92:95], v[68:71], v[36:39], v[92:95]
    ds_read_b128 v[24:27], v13 offset:0
    v_mfma_f32_16x16x32_bf16 v[80:83], v[72:75], v[40:43], v[80:83]
    ds_read_b128 v[28:31], v13 offset:2048
    ds_read_b64_tr_b16 v[56:57], v10 offset:10240
    v_mfma_f32_16x16x32_bf16 v[88:91], v[72:75], v[44:47], v[88:91]
    ds_read_b64_tr_b16 v[58:59], v10 offset:10496
    v_mfma_f32_16x16x32_bf16 v[84:87], v[76:79], v[40:43], v[84:87]
    ds_read_b64_tr_b16 v[60:61], v11 offset:10240
    ds_read_b64_tr_b16 v[62:63], v11 offset:10496
    v_mfma_f32_16x16x32_bf16 v[92:95], v[76:79], v[44:47], v[92:95]
    s_waitcnt lgkmcnt(0)
    s_barrier
    v_add_u32 v10, 16384, v10
    v_add_u32 v11, 16384, v11
    v_add_u32 v12, 16384, v12
    v_add_u32 v13, 16384, v13
    ds_read_b128 v[32:35], v12 offset:0
    v_mfma_f32_16x16x32_bf16 v[80:83], v[48:51], v[16:19], v[80:83]
    ds_read_b128 v[36:39], v12 offset:2048
    ds_read_b64_tr_b16 v[64:65], v10 offset:8192
    v_mfma_f32_16x16x32_bf16 v[88:91], v[48:51], v[20:23], v[88:91]
    ds_read_b64_tr_b16 v[66:67], v10 offset:8448
    v_mfma_f32_16x16x32_bf16 v[84:87], v[52:55], v[16:19], v[84:87]
    ds_read_b64_tr_b16 v[68:69], v11 offset:8192
    ds_read_b64_tr_b16 v[70:71], v11 offset:8448
    v_mfma_f32_16x16x32_bf16 v[92:95], v[52:55], v[20:23], v[92:95]
    ds_read_b128 v[40:43], v13 offset:0
    v_mfma_f32_16x16x32_bf16 v[80:83], v[56:59], v[24:27], v[80:83]
    ds_read_b128 v[44:47], v13 offset:2048
    ds_read_b64_tr_b16 v[72:73], v10 offset:10240
    v_mfma_f32_16x16x32_bf16 v[88:91], v[56:59], v[28:31], v[88:91]
    ds_read_b64_tr_b16 v[74:75], v10 offset:10496
    v_mfma_f32_16x16x32_bf16 v[84:87], v[60:63], v[24:27], v[84:87]
    ds_read_b64_tr_b16 v[76:77], v11 offset:10240
    ds_read_b64_tr_b16 v[78:79], v11 offset:10496
    v_mfma_f32_16x16x32_bf16 v[92:95], v[60:63], v[28:31], v[92:95]
    s_waitcnt lgkmcnt(0)
    s_barrier
    v_add_u32 v10, 16384, v10
    v_add_u32 v11, 16384, v11
    v_add_u32 v12, 16384, v12
    v_add_u32 v13, 16384, v13
    ds_read_b128 v[16:19], v12 offset:0
    v_mfma_f32_16x16x32_bf16 v[80:83], v[64:67], v[32:35], v[80:83]
    ds_read_b128 v[20:23], v12 offset:2048
    ds_read_b64_tr_b16 v[48:49], v10 offset:8192
    v_mfma_f32_16x16x32_bf16 v[88:91], v[64:67], v[36:39], v[88:91]
    ds_read_b64_tr_b16 v[50:51], v10 offset:8448
    v_mfma_f32_16x16x32_bf16 v[84:87], v[68:71], v[32:35], v[84:87]
    ds_read_b64_tr_b16 v[52:53], v11 offset:8192
    ds_read_b64_tr_b16 v[54:55], v11 offset:8448
    v_mfma_f32_16x16x32_bf16 v[92:95], v[68:71], v[36:39], v[92:95]
    ds_read_b128 v[24:27], v13 offset:0
    v_mfma_f32_16x16x32_bf16 v[80:83], v[72:75], v[40:43], v[80:83]
    ds_read_b128 v[28:31], v13 offset:2048
    ds_read_b64_tr_b16 v[56:57], v10 offset:10240
    v_mfma_f32_16x16x32_bf16 v[88:91], v[72:75], v[44:47], v[88:91]
    ds_read_b64_tr_b16 v[58:59], v10 offset:10496
    v_mfma_f32_16x16x32_bf16 v[84:87], v[76:79], v[40:43], v[84:87]
    ds_read_b64_tr_b16 v[60:61], v11 offset:10240
    ds_read_b64_tr_b16 v[62:63], v11 offset:10496
    v_mfma_f32_16x16x32_bf16 v[92:95], v[76:79], v[44:47], v[92:95]
    s_waitcnt lgkmcnt(0)
    s_barrier
    v_add_u32 v10, 16384, v10
    v_add_u32 v11, 16384, v11
    v_add_u32 v12, 16384, v12
    v_add_u32 v13, 16384, v13
    ds_read_b128 v[32:35], v12 offset:0
    v_mfma_f32_16x16x32_bf16 v[80:83], v[48:51], v[16:19], v[80:83]
    ds_read_b128 v[36:39], v12 offset:2048
    ds_read_b64_tr_b16 v[64:65], v10 offset:8192
    v_mfma_f32_16x16x32_bf16 v[88:91], v[48:51], v[20:23], v[88:91]
    ds_read_b64_tr_b16 v[66:67], v10 offset:8448
    v_mfma_f32_16x16x32_bf16 v[84:87], v[52:55], v[16:19], v[84:87]
    ds_read_b64_tr_b16 v[68:69], v11 offset:8192
    ds_read_b64_tr_b16 v[70:71], v11 offset:8448
    v_mfma_f32_16x16x32_bf16 v[92:95], v[52:55], v[20:23], v[92:95]
    ds_read_b128 v[40:43], v13 offset:0
    v_mfma_f32_16x16x32_bf16 v[80:83], v[56:59], v[24:27], v[80:83]
    ds_read_b128 v[44:47], v13 offset:2048
    ds_read_b64_tr_b16 v[72:73], v10 offset:10240
    v_mfma_f32_16x16x32_bf16 v[88:91], v[56:59], v[28:31], v[88:91]
    ds_read_b64_tr_b16 v[74:75], v10 offset:10496
    v_mfma_f32_16x16x32_bf16 v[84:87], v[60:63], v[24:27], v[84:87]
    ds_read_b64_tr_b16 v[76:77], v11 offset:10240
    ds_read_b64_tr_b16 v[78:79], v11 offset:10496
    v_mfma_f32_16x16x32_bf16 v[92:95], v[60:63], v[28:31], v[92:95]
    s_waitcnt lgkmcnt(0)
    s_barrier
    v_add_u32 v10, 16384, v10
    v_add_u32 v11, 16384, v11
    v_add_u32 v12, 16384, v12
    v_add_u32 v13, 16384, v13
    ds_read_b128 v[16:19], v12 offset:0
    v_mfma_f32_16x16x32_bf16 v[80:83], v[64:67], v[32:35], v[80:83]
    ds_read_b128 v[20:23], v12 offset:2048
    ds_read_b64_tr_b16 v[48:49], v10 offset:8192
    v_mfma_f32_16x16x32_bf16 v[88:91], v[64:67], v[36:39], v[88:91]
    ds_read_b64_tr_b16 v[50:51], v10 offset:8448
    v_mfma_f32_16x16x32_bf16 v[84:87], v[68:71], v[32:35], v[84:87]
    ds_read_b64_tr_b16 v[52:53], v11 offset:8192
    ds_read_b64_tr_b16 v[54:55], v11 offset:8448
    v_mfma_f32_16x16x32_bf16 v[92:95], v[68:71], v[36:39], v[92:95]
    ds_read_b128 v[24:27], v13 offset:0
    v_mfma_f32_16x16x32_bf16 v[80:83], v[72:75], v[40:43], v[80:83]
    ds_read_b128 v[28:31], v13 offset:2048
    ds_read_b64_tr_b16 v[56:57], v10 offset:10240
    v_mfma_f32_16x16x32_bf16 v[88:91], v[72:75], v[44:47], v[88:91]
    ds_read_b64_tr_b16 v[58:59], v10 offset:10496
    v_mfma_f32_16x16x32_bf16 v[84:87], v[76:79], v[40:43], v[84:87]
    ds_read_b64_tr_b16 v[60:61], v11 offset:10240
    ds_read_b64_tr_b16 v[62:63], v11 offset:10496
    v_mfma_f32_16x16x32_bf16 v[92:95], v[76:79], v[44:47], v[92:95]
    s_waitcnt lgkmcnt(0)
    s_barrier
    v_add_u32 v10, 16384, v10
    v_add_u32 v11, 16384, v11
    v_add_u32 v12, 16384, v12
    v_add_u32 v13, 16384, v13
    ds_read_b128 v[32:35], v12 offset:0
    v_mfma_f32_16x16x32_bf16 v[80:83], v[48:51], v[16:19], v[80:83]
    ds_read_b128 v[36:39], v12 offset:2048
    ds_read_b64_tr_b16 v[64:65], v10 offset:8192
    v_mfma_f32_16x16x32_bf16 v[88:91], v[48:51], v[20:23], v[88:91]
    ds_read_b64_tr_b16 v[66:67], v10 offset:8448
    v_mfma_f32_16x16x32_bf16 v[84:87], v[52:55], v[16:19], v[84:87]
    ds_read_b64_tr_b16 v[68:69], v11 offset:8192
    ds_read_b64_tr_b16 v[70:71], v11 offset:8448
    v_mfma_f32_16x16x32_bf16 v[92:95], v[52:55], v[20:23], v[92:95]
    ds_read_b128 v[40:43], v13 offset:0
    v_mfma_f32_16x16x32_bf16 v[80:83], v[56:59], v[24:27], v[80:83]
    ds_read_b128 v[44:47], v13 offset:2048
    ds_read_b64_tr_b16 v[72:73], v10 offset:10240
    v_mfma_f32_16x16x32_bf16 v[88:91], v[56:59], v[28:31], v[88:91]
    ds_read_b64_tr_b16 v[74:75], v10 offset:10496
    v_mfma_f32_16x16x32_bf16 v[84:87], v[60:63], v[24:27], v[84:87]
    ds_read_b64_tr_b16 v[76:77], v11 offset:10240
    ds_read_b64_tr_b16 v[78:79], v11 offset:10496
    v_mfma_f32_16x16x32_bf16 v[92:95], v[60:63], v[28:31], v[92:95]
    s_waitcnt lgkmcnt(0)
    s_barrier
    v_add_u32 v10, 4294852608, v10
    v_add_u32 v11, 4294852608, v11
    v_add_u32 v12, 4294852608, v12
    v_add_u32 v13, 4294852608, v13
    ds_read_b128 v[16:19], v12 offset:0
    v_mfma_f32_16x16x32_bf16 v[80:83], v[64:67], v[32:35], v[80:83]
    ds_read_b128 v[20:23], v12 offset:2048
    ds_read_b64_tr_b16 v[48:49], v10 offset:8192
    v_mfma_f32_16x16x32_bf16 v[88:91], v[64:67], v[36:39], v[88:91]
    ds_read_b64_tr_b16 v[50:51], v10 offset:8448
    v_mfma_f32_16x16x32_bf16 v[84:87], v[68:71], v[32:35], v[84:87]
    ds_read_b64_tr_b16 v[52:53], v11 offset:8192
    ds_read_b64_tr_b16 v[54:55], v11 offset:8448
    v_mfma_f32_16x16x32_bf16 v[92:95], v[68:71], v[36:39], v[92:95]
    ds_read_b128 v[24:27], v13 offset:0
    v_mfma_f32_16x16x32_bf16 v[80:83], v[72:75], v[40:43], v[80:83]
    ds_read_b128 v[28:31], v13 offset:2048
    ds_read_b64_tr_b16 v[56:57], v10 offset:10240
    v_mfma_f32_16x16x32_bf16 v[88:91], v[72:75], v[44:47], v[88:91]
    ds_read_b64_tr_b16 v[58:59], v10 offset:10496
    v_mfma_f32_16x16x32_bf16 v[84:87], v[76:79], v[40:43], v[84:87]
    ds_read_b64_tr_b16 v[60:61], v11 offset:10240
    ds_read_b64_tr_b16 v[62:63], v11 offset:10496
    v_mfma_f32_16x16x32_bf16 v[92:95], v[76:79], v[44:47], v[92:95]
    s_waitcnt lgkmcnt(0)
    s_barrier
    v_add_u32 v10, 16384, v10
    v_add_u32 v11, 16384, v11
    v_add_u32 v12, 16384, v12
    v_add_u32 v13, 16384, v13
    ds_read_b128 v[32:35], v12 offset:0
    v_mfma_f32_16x16x32_bf16 v[80:83], v[48:51], v[16:19], v[80:83]
    ds_read_b128 v[36:39], v12 offset:2048
    ds_read_b64_tr_b16 v[64:65], v10 offset:8192
    v_mfma_f32_16x16x32_bf16 v[88:91], v[48:51], v[20:23], v[88:91]
    ds_read_b64_tr_b16 v[66:67], v10 offset:8448
    v_mfma_f32_16x16x32_bf16 v[84:87], v[52:55], v[16:19], v[84:87]
    ds_read_b64_tr_b16 v[68:69], v11 offset:8192
    ds_read_b64_tr_b16 v[70:71], v11 offset:8448
    v_mfma_f32_16x16x32_bf16 v[92:95], v[52:55], v[20:23], v[92:95]
    ds_read_b128 v[40:43], v13 offset:0
    v_mfma_f32_16x16x32_bf16 v[80:83], v[56:59], v[24:27], v[80:83]
    ds_read_b128 v[44:47], v13 offset:2048
    ds_read_b64_tr_b16 v[72:73], v10 offset:10240
    v_mfma_f32_16x16x32_bf16 v[88:91], v[56:59], v[28:31], v[88:91]
    ds_read_b64_tr_b16 v[74:75], v10 offset:10496
    v_mfma_f32_16x16x32_bf16 v[84:87], v[60:63], v[24:27], v[84:87]
    ds_read_b64_tr_b16 v[76:77], v11 offset:10240
    ds_read_b64_tr_b16 v[78:79], v11 offset:10496
    v_mfma_f32_16x16x32_bf16 v[92:95], v[60:63], v[28:31], v[92:95]
    s_waitcnt lgkmcnt(0)
    s_barrier
    v_add_u32 v10, 16384, v10
    v_add_u32 v11, 16384, v11
    v_add_u32 v12, 16384, v12
    v_add_u32 v13, 16384, v13
    ds_read_b128 v[16:19], v12 offset:0
    v_mfma_f32_16x16x32_bf16 v[80:83], v[64:67], v[32:35], v[80:83]
    ds_read_b128 v[20:23], v12 offset:2048
    ds_read_b64_tr_b16 v[48:49], v10 offset:8192
    v_mfma_f32_16x16x32_bf16 v[88:91], v[64:67], v[36:39], v[88:91]
    ds_read_b64_tr_b16 v[50:51], v10 offset:8448
    v_mfma_f32_16x16x32_bf16 v[84:87], v[68:71], v[32:35], v[84:87]
    ds_read_b64_tr_b16 v[52:53], v11 offset:8192
    ds_read_b64_tr_b16 v[54:55], v11 offset:8448
    v_mfma_f32_16x16x32_bf16 v[92:95], v[68:71], v[36:39], v[92:95]
    ds_read_b128 v[24:27], v13 offset:0
    v_mfma_f32_16x16x32_bf16 v[80:83], v[72:75], v[40:43], v[80:83]
    ds_read_b128 v[28:31], v13 offset:2048
    ds_read_b64_tr_b16 v[56:57], v10 offset:10240
    v_mfma_f32_16x16x32_bf16 v[88:91], v[72:75], v[44:47], v[88:91]
    ds_read_b64_tr_b16 v[58:59], v10 offset:10496
    v_mfma_f32_16x16x32_bf16 v[84:87], v[76:79], v[40:43], v[84:87]
    ds_read_b64_tr_b16 v[60:61], v11 offset:10240
    ds_read_b64_tr_b16 v[62:63], v11 offset:10496
    v_mfma_f32_16x16x32_bf16 v[92:95], v[76:79], v[44:47], v[92:95]
    s_waitcnt lgkmcnt(0)
    s_barrier
    v_add_u32 v10, 16384, v10
    v_add_u32 v11, 16384, v11
    v_add_u32 v12, 16384, v12
    v_add_u32 v13, 16384, v13
    ds_read_b128 v[32:35], v12 offset:0
    v_mfma_f32_16x16x32_bf16 v[80:83], v[48:51], v[16:19], v[80:83]
    ds_read_b128 v[36:39], v12 offset:2048
    ds_read_b64_tr_b16 v[64:65], v10 offset:8192
    v_mfma_f32_16x16x32_bf16 v[88:91], v[48:51], v[20:23], v[88:91]
    ds_read_b64_tr_b16 v[66:67], v10 offset:8448
    v_mfma_f32_16x16x32_bf16 v[84:87], v[52:55], v[16:19], v[84:87]
    ds_read_b64_tr_b16 v[68:69], v11 offset:8192
    ds_read_b64_tr_b16 v[70:71], v11 offset:8448
    v_mfma_f32_16x16x32_bf16 v[92:95], v[52:55], v[20:23], v[92:95]
    ds_read_b128 v[40:43], v13 offset:0
    v_mfma_f32_16x16x32_bf16 v[80:83], v[56:59], v[24:27], v[80:83]
    ds_read_b128 v[44:47], v13 offset:2048
    ds_read_b64_tr_b16 v[72:73], v10 offset:10240
    v_mfma_f32_16x16x32_bf16 v[88:91], v[56:59], v[28:31], v[88:91]
    ds_read_b64_tr_b16 v[74:75], v10 offset:10496
    v_mfma_f32_16x16x32_bf16 v[84:87], v[60:63], v[24:27], v[84:87]
    ds_read_b64_tr_b16 v[76:77], v11 offset:10240
    ds_read_b64_tr_b16 v[78:79], v11 offset:10496
    v_mfma_f32_16x16x32_bf16 v[92:95], v[60:63], v[28:31], v[92:95]
    s_waitcnt lgkmcnt(0)
    s_barrier
    v_add_u32 v10, 16384, v10
    v_add_u32 v11, 16384, v11
    v_add_u32 v12, 16384, v12
    v_add_u32 v13, 16384, v13
    ds_read_b128 v[16:19], v12 offset:0
    v_mfma_f32_16x16x32_bf16 v[80:83], v[64:67], v[32:35], v[80:83]
    ds_read_b128 v[20:23], v12 offset:2048
    ds_read_b64_tr_b16 v[48:49], v10 offset:8192
    v_mfma_f32_16x16x32_bf16 v[88:91], v[64:67], v[36:39], v[88:91]
    ds_read_b64_tr_b16 v[50:51], v10 offset:8448
    v_mfma_f32_16x16x32_bf16 v[84:87], v[68:71], v[32:35], v[84:87]
    ds_read_b64_tr_b16 v[52:53], v11 offset:8192
    ds_read_b64_tr_b16 v[54:55], v11 offset:8448
    v_mfma_f32_16x16x32_bf16 v[92:95], v[68:71], v[36:39], v[92:95]
    ds_read_b128 v[24:27], v13 offset:0
    v_mfma_f32_16x16x32_bf16 v[80:83], v[72:75], v[40:43], v[80:83]
    ds_read_b128 v[28:31], v13 offset:2048
    ds_read_b64_tr_b16 v[56:57], v10 offset:10240
    v_mfma_f32_16x16x32_bf16 v[88:91], v[72:75], v[44:47], v[88:91]
    ds_read_b64_tr_b16 v[58:59], v10 offset:10496
    v_mfma_f32_16x16x32_bf16 v[84:87], v[76:79], v[40:43], v[84:87]
    ds_read_b64_tr_b16 v[60:61], v11 offset:10240
    ds_read_b64_tr_b16 v[62:63], v11 offset:10496
    v_mfma_f32_16x16x32_bf16 v[92:95], v[76:79], v[44:47], v[92:95]
    s_waitcnt lgkmcnt(0)
    s_barrier
    v_add_u32 v10, 16384, v10
    v_add_u32 v11, 16384, v11
    v_add_u32 v12, 16384, v12
    v_add_u32 v13, 16384, v13
    ds_read_b128 v[32:35], v12 offset:0
    v_mfma_f32_16x16x32_bf16 v[80:83], v[48:51], v[16:19], v[80:83]
    ds_read_b128 v[36:39], v12 offset:2048
    ds_read_b64_tr_b16 v[64:65], v10 offset:8192
    v_mfma_f32_16x16x32_bf16 v[88:91], v[48:51], v[20:23], v[88:91]
    ds_read_b64_tr_b16 v[66:67], v10 offset:8448
    v_mfma_f32_16x16x32_bf16 v[84:87], v[52:55], v[16:19], v[84:87]
    ds_read_b64_tr_b16 v[68:69], v11 offset:8192
    ds_read_b64_tr_b16 v[70:71], v11 offset:8448
    v_mfma_f32_16x16x32_bf16 v[92:95], v[52:55], v[20:23], v[92:95]
    ds_read_b128 v[40:43], v13 offset:0
    v_mfma_f32_16x16x32_bf16 v[80:83], v[56:59], v[24:27], v[80:83]
    ds_read_b128 v[44:47], v13 offset:2048
    ds_read_b64_tr_b16 v[72:73], v10 offset:10240
    v_mfma_f32_16x16x32_bf16 v[88:91], v[56:59], v[28:31], v[88:91]
    ds_read_b64_tr_b16 v[74:75], v10 offset:10496
    v_mfma_f32_16x16x32_bf16 v[84:87], v[60:63], v[24:27], v[84:87]
    ds_read_b64_tr_b16 v[76:77], v11 offset:10240
    ds_read_b64_tr_b16 v[78:79], v11 offset:10496
    v_mfma_f32_16x16x32_bf16 v[92:95], v[60:63], v[28:31], v[92:95]
    s_waitcnt lgkmcnt(0)
    s_barrier
    v_add_u32 v10, 16384, v10
    v_add_u32 v11, 16384, v11
    v_add_u32 v12, 16384, v12
    v_add_u32 v13, 16384, v13
    ds_read_b128 v[16:19], v12 offset:0
    v_mfma_f32_16x16x32_bf16 v[80:83], v[64:67], v[32:35], v[80:83]
    ds_read_b128 v[20:23], v12 offset:2048
    ds_read_b64_tr_b16 v[48:49], v10 offset:8192
    v_mfma_f32_16x16x32_bf16 v[88:91], v[64:67], v[36:39], v[88:91]
    ds_read_b64_tr_b16 v[50:51], v10 offset:8448
    v_mfma_f32_16x16x32_bf16 v[84:87], v[68:71], v[32:35], v[84:87]
    ds_read_b64_tr_b16 v[52:53], v11 offset:8192
    ds_read_b64_tr_b16 v[54:55], v11 offset:8448
    v_mfma_f32_16x16x32_bf16 v[92:95], v[68:71], v[36:39], v[92:95]
    ds_read_b128 v[24:27], v13 offset:0
    v_mfma_f32_16x16x32_bf16 v[80:83], v[72:75], v[40:43], v[80:83]
    ds_read_b128 v[28:31], v13 offset:2048
    ds_read_b64_tr_b16 v[56:57], v10 offset:10240
    v_mfma_f32_16x16x32_bf16 v[88:91], v[72:75], v[44:47], v[88:91]
    ds_read_b64_tr_b16 v[58:59], v10 offset:10496
    v_mfma_f32_16x16x32_bf16 v[84:87], v[76:79], v[40:43], v[84:87]
    ds_read_b64_tr_b16 v[60:61], v11 offset:10240
    ds_read_b64_tr_b16 v[62:63], v11 offset:10496
    v_mfma_f32_16x16x32_bf16 v[92:95], v[76:79], v[44:47], v[92:95]
    s_waitcnt lgkmcnt(0)
    s_barrier
    v_add_u32 v10, 16384, v10
    v_add_u32 v11, 16384, v11
    v_add_u32 v12, 16384, v12
    v_add_u32 v13, 16384, v13
    ds_read_b128 v[32:35], v12 offset:0
    v_mfma_f32_16x16x32_bf16 v[80:83], v[48:51], v[16:19], v[80:83]
    ds_read_b128 v[36:39], v12 offset:2048
    ds_read_b64_tr_b16 v[64:65], v10 offset:8192
    v_mfma_f32_16x16x32_bf16 v[88:91], v[48:51], v[20:23], v[88:91]
    ds_read_b64_tr_b16 v[66:67], v10 offset:8448
    v_mfma_f32_16x16x32_bf16 v[84:87], v[52:55], v[16:19], v[84:87]
    ds_read_b64_tr_b16 v[68:69], v11 offset:8192
    ds_read_b64_tr_b16 v[70:71], v11 offset:8448
    v_mfma_f32_16x16x32_bf16 v[92:95], v[52:55], v[20:23], v[92:95]
    ds_read_b128 v[40:43], v13 offset:0
    v_mfma_f32_16x16x32_bf16 v[80:83], v[56:59], v[24:27], v[80:83]
    ds_read_b128 v[44:47], v13 offset:2048
    ds_read_b64_tr_b16 v[72:73], v10 offset:10240
    v_mfma_f32_16x16x32_bf16 v[88:91], v[56:59], v[28:31], v[88:91]
    ds_read_b64_tr_b16 v[74:75], v10 offset:10496
    v_mfma_f32_16x16x32_bf16 v[84:87], v[60:63], v[24:27], v[84:87]
    ds_read_b64_tr_b16 v[76:77], v11 offset:10240
    ds_read_b64_tr_b16 v[78:79], v11 offset:10496
    v_mfma_f32_16x16x32_bf16 v[92:95], v[60:63], v[28:31], v[92:95]
    s_waitcnt lgkmcnt(0)
    s_barrier
    v_add_u32 v10, 4294852608, v10
    v_add_u32 v11, 4294852608, v11
    v_add_u32 v12, 4294852608, v12
    v_add_u32 v13, 4294852608, v13
    ds_read_b128 v[16:19], v12 offset:0
    v_mfma_f32_16x16x32_bf16 v[80:83], v[64:67], v[32:35], v[80:83]
    ds_read_b128 v[20:23], v12 offset:2048
    ds_read_b64_tr_b16 v[48:49], v10 offset:8192
    v_mfma_f32_16x16x32_bf16 v[88:91], v[64:67], v[36:39], v[88:91]
    ds_read_b64_tr_b16 v[50:51], v10 offset:8448
    v_mfma_f32_16x16x32_bf16 v[84:87], v[68:71], v[32:35], v[84:87]
    ds_read_b64_tr_b16 v[52:53], v11 offset:8192
    ds_read_b64_tr_b16 v[54:55], v11 offset:8448
    v_mfma_f32_16x16x32_bf16 v[92:95], v[68:71], v[36:39], v[92:95]
    ds_read_b128 v[24:27], v13 offset:0
    v_mfma_f32_16x16x32_bf16 v[80:83], v[72:75], v[40:43], v[80:83]
    ds_read_b128 v[28:31], v13 offset:2048
    ds_read_b64_tr_b16 v[56:57], v10 offset:10240
    v_mfma_f32_16x16x32_bf16 v[88:91], v[72:75], v[44:47], v[88:91]
    ds_read_b64_tr_b16 v[58:59], v10 offset:10496
    v_mfma_f32_16x16x32_bf16 v[84:87], v[76:79], v[40:43], v[84:87]
    ds_read_b64_tr_b16 v[60:61], v11 offset:10240
    ds_read_b64_tr_b16 v[62:63], v11 offset:10496
    v_mfma_f32_16x16x32_bf16 v[92:95], v[76:79], v[44:47], v[92:95]
    s_waitcnt lgkmcnt(0)
    s_barrier
    v_add_u32 v10, 16384, v10
    v_add_u32 v11, 16384, v11
    v_add_u32 v12, 16384, v12
    v_add_u32 v13, 16384, v13
    ds_read_b128 v[32:35], v12 offset:0
    v_mfma_f32_16x16x32_bf16 v[80:83], v[48:51], v[16:19], v[80:83]
    ds_read_b128 v[36:39], v12 offset:2048
    ds_read_b64_tr_b16 v[64:65], v10 offset:8192
    v_mfma_f32_16x16x32_bf16 v[88:91], v[48:51], v[20:23], v[88:91]
    ds_read_b64_tr_b16 v[66:67], v10 offset:8448
    v_mfma_f32_16x16x32_bf16 v[84:87], v[52:55], v[16:19], v[84:87]
    ds_read_b64_tr_b16 v[68:69], v11 offset:8192
    ds_read_b64_tr_b16 v[70:71], v11 offset:8448
    v_mfma_f32_16x16x32_bf16 v[92:95], v[52:55], v[20:23], v[92:95]
    ds_read_b128 v[40:43], v13 offset:0
    v_mfma_f32_16x16x32_bf16 v[80:83], v[56:59], v[24:27], v[80:83]
    ds_read_b128 v[44:47], v13 offset:2048
    ds_read_b64_tr_b16 v[72:73], v10 offset:10240
    v_mfma_f32_16x16x32_bf16 v[88:91], v[56:59], v[28:31], v[88:91]
    ds_read_b64_tr_b16 v[74:75], v10 offset:10496
    v_mfma_f32_16x16x32_bf16 v[84:87], v[60:63], v[24:27], v[84:87]
    ds_read_b64_tr_b16 v[76:77], v11 offset:10240
    ds_read_b64_tr_b16 v[78:79], v11 offset:10496
    v_mfma_f32_16x16x32_bf16 v[92:95], v[60:63], v[28:31], v[92:95]
    s_waitcnt lgkmcnt(0)
    s_barrier
    v_add_u32 v10, 16384, v10
    v_add_u32 v11, 16384, v11
    v_add_u32 v12, 16384, v12
    v_add_u32 v13, 16384, v13
    ds_read_b128 v[16:19], v12 offset:0
    v_mfma_f32_16x16x32_bf16 v[80:83], v[64:67], v[32:35], v[80:83]
    ds_read_b128 v[20:23], v12 offset:2048
    ds_read_b64_tr_b16 v[48:49], v10 offset:8192
    v_mfma_f32_16x16x32_bf16 v[88:91], v[64:67], v[36:39], v[88:91]
    ds_read_b64_tr_b16 v[50:51], v10 offset:8448
    v_mfma_f32_16x16x32_bf16 v[84:87], v[68:71], v[32:35], v[84:87]
    ds_read_b64_tr_b16 v[52:53], v11 offset:8192
    ds_read_b64_tr_b16 v[54:55], v11 offset:8448
    v_mfma_f32_16x16x32_bf16 v[92:95], v[68:71], v[36:39], v[92:95]
    ds_read_b128 v[24:27], v13 offset:0
    v_mfma_f32_16x16x32_bf16 v[80:83], v[72:75], v[40:43], v[80:83]
    ds_read_b128 v[28:31], v13 offset:2048
    ds_read_b64_tr_b16 v[56:57], v10 offset:10240
    v_mfma_f32_16x16x32_bf16 v[88:91], v[72:75], v[44:47], v[88:91]
    ds_read_b64_tr_b16 v[58:59], v10 offset:10496
    v_mfma_f32_16x16x32_bf16 v[84:87], v[76:79], v[40:43], v[84:87]
    ds_read_b64_tr_b16 v[60:61], v11 offset:10240
    ds_read_b64_tr_b16 v[62:63], v11 offset:10496
    v_mfma_f32_16x16x32_bf16 v[92:95], v[76:79], v[44:47], v[92:95]
    s_waitcnt lgkmcnt(0)
    s_barrier
    v_add_u32 v10, 16384, v10
    v_add_u32 v11, 16384, v11
    v_add_u32 v12, 16384, v12
    v_add_u32 v13, 16384, v13
    ds_read_b128 v[32:35], v12 offset:0
    v_mfma_f32_16x16x32_bf16 v[80:83], v[48:51], v[16:19], v[80:83]
    ds_read_b128 v[36:39], v12 offset:2048
    ds_read_b64_tr_b16 v[64:65], v10 offset:8192
    v_mfma_f32_16x16x32_bf16 v[88:91], v[48:51], v[20:23], v[88:91]
    ds_read_b64_tr_b16 v[66:67], v10 offset:8448
    v_mfma_f32_16x16x32_bf16 v[84:87], v[52:55], v[16:19], v[84:87]
    ds_read_b64_tr_b16 v[68:69], v11 offset:8192
    ds_read_b64_tr_b16 v[70:71], v11 offset:8448
    v_mfma_f32_16x16x32_bf16 v[92:95], v[52:55], v[20:23], v[92:95]
    ds_read_b128 v[40:43], v13 offset:0
    v_mfma_f32_16x16x32_bf16 v[80:83], v[56:59], v[24:27], v[80:83]
    ds_read_b128 v[44:47], v13 offset:2048
    ds_read_b64_tr_b16 v[72:73], v10 offset:10240
    v_mfma_f32_16x16x32_bf16 v[88:91], v[56:59], v[28:31], v[88:91]
    ds_read_b64_tr_b16 v[74:75], v10 offset:10496
    v_mfma_f32_16x16x32_bf16 v[84:87], v[60:63], v[24:27], v[84:87]
    ds_read_b64_tr_b16 v[76:77], v11 offset:10240
    ds_read_b64_tr_b16 v[78:79], v11 offset:10496
    v_mfma_f32_16x16x32_bf16 v[92:95], v[60:63], v[28:31], v[92:95]
    s_waitcnt lgkmcnt(0)
    s_barrier
    v_add_u32 v10, 16384, v10
    v_add_u32 v11, 16384, v11
    v_add_u32 v12, 16384, v12
    v_add_u32 v13, 16384, v13
    ds_read_b128 v[16:19], v12 offset:0
    v_mfma_f32_16x16x32_bf16 v[80:83], v[64:67], v[32:35], v[80:83]
    ds_read_b128 v[20:23], v12 offset:2048
    ds_read_b64_tr_b16 v[48:49], v10 offset:8192
    v_mfma_f32_16x16x32_bf16 v[88:91], v[64:67], v[36:39], v[88:91]
    ds_read_b64_tr_b16 v[50:51], v10 offset:8448
    v_mfma_f32_16x16x32_bf16 v[84:87], v[68:71], v[32:35], v[84:87]
    ds_read_b64_tr_b16 v[52:53], v11 offset:8192
    ds_read_b64_tr_b16 v[54:55], v11 offset:8448
    v_mfma_f32_16x16x32_bf16 v[92:95], v[68:71], v[36:39], v[92:95]
    ds_read_b128 v[24:27], v13 offset:0
    v_mfma_f32_16x16x32_bf16 v[80:83], v[72:75], v[40:43], v[80:83]
    ds_read_b128 v[28:31], v13 offset:2048
    ds_read_b64_tr_b16 v[56:57], v10 offset:10240
    v_mfma_f32_16x16x32_bf16 v[88:91], v[72:75], v[44:47], v[88:91]
    ds_read_b64_tr_b16 v[58:59], v10 offset:10496
    v_mfma_f32_16x16x32_bf16 v[84:87], v[76:79], v[40:43], v[84:87]
    ds_read_b64_tr_b16 v[60:61], v11 offset:10240
    ds_read_b64_tr_b16 v[62:63], v11 offset:10496
    v_mfma_f32_16x16x32_bf16 v[92:95], v[76:79], v[44:47], v[92:95]
    s_waitcnt lgkmcnt(0)
    s_barrier
    v_add_u32 v10, 16384, v10
    v_add_u32 v11, 16384, v11
    v_add_u32 v12, 16384, v12
    v_add_u32 v13, 16384, v13
    ds_read_b128 v[32:35], v12 offset:0
    v_mfma_f32_16x16x32_bf16 v[80:83], v[48:51], v[16:19], v[80:83]
    ds_read_b128 v[36:39], v12 offset:2048
    ds_read_b64_tr_b16 v[64:65], v10 offset:8192
    v_mfma_f32_16x16x32_bf16 v[88:91], v[48:51], v[20:23], v[88:91]
    ds_read_b64_tr_b16 v[66:67], v10 offset:8448
    v_mfma_f32_16x16x32_bf16 v[84:87], v[52:55], v[16:19], v[84:87]
    ds_read_b64_tr_b16 v[68:69], v11 offset:8192
    ds_read_b64_tr_b16 v[70:71], v11 offset:8448
    v_mfma_f32_16x16x32_bf16 v[92:95], v[52:55], v[20:23], v[92:95]
    ds_read_b128 v[40:43], v13 offset:0
    v_mfma_f32_16x16x32_bf16 v[80:83], v[56:59], v[24:27], v[80:83]
    ds_read_b128 v[44:47], v13 offset:2048
    ds_read_b64_tr_b16 v[72:73], v10 offset:10240
    v_mfma_f32_16x16x32_bf16 v[88:91], v[56:59], v[28:31], v[88:91]
    ds_read_b64_tr_b16 v[74:75], v10 offset:10496
    v_mfma_f32_16x16x32_bf16 v[84:87], v[60:63], v[24:27], v[84:87]
    ds_read_b64_tr_b16 v[76:77], v11 offset:10240
    ds_read_b64_tr_b16 v[78:79], v11 offset:10496
    v_mfma_f32_16x16x32_bf16 v[92:95], v[60:63], v[28:31], v[92:95]
    s_waitcnt lgkmcnt(0)
    s_barrier
    v_add_u32 v10, 16384, v10
    v_add_u32 v11, 16384, v11
    v_add_u32 v12, 16384, v12
    v_add_u32 v13, 16384, v13
    ds_read_b128 v[16:19], v12 offset:0
    v_mfma_f32_16x16x32_bf16 v[80:83], v[64:67], v[32:35], v[80:83]
    ds_read_b128 v[20:23], v12 offset:2048
    ds_read_b64_tr_b16 v[48:49], v10 offset:8192
    v_mfma_f32_16x16x32_bf16 v[88:91], v[64:67], v[36:39], v[88:91]
    ds_read_b64_tr_b16 v[50:51], v10 offset:8448
    v_mfma_f32_16x16x32_bf16 v[84:87], v[68:71], v[32:35], v[84:87]
    ds_read_b64_tr_b16 v[52:53], v11 offset:8192
    ds_read_b64_tr_b16 v[54:55], v11 offset:8448
    v_mfma_f32_16x16x32_bf16 v[92:95], v[68:71], v[36:39], v[92:95]
    ds_read_b128 v[24:27], v13 offset:0
    v_mfma_f32_16x16x32_bf16 v[80:83], v[72:75], v[40:43], v[80:83]
    ds_read_b128 v[28:31], v13 offset:2048
    ds_read_b64_tr_b16 v[56:57], v10 offset:10240
    v_mfma_f32_16x16x32_bf16 v[88:91], v[72:75], v[44:47], v[88:91]
    ds_read_b64_tr_b16 v[58:59], v10 offset:10496
    v_mfma_f32_16x16x32_bf16 v[84:87], v[76:79], v[40:43], v[84:87]
    ds_read_b64_tr_b16 v[60:61], v11 offset:10240
    ds_read_b64_tr_b16 v[62:63], v11 offset:10496
    v_mfma_f32_16x16x32_bf16 v[92:95], v[76:79], v[44:47], v[92:95]
    s_waitcnt lgkmcnt(0)
    s_nop 7
    s_waitcnt vmcnt(0)
    v_cvt_pk_bf16_f32 v48, v80, v81
    v_cvt_pk_bf16_f32 v49, v82, v83
    v_cvt_pk_bf16_f32 v50, v84, v85
    v_cvt_pk_bf16_f32 v51, v86, v87
    s_add_u32 s27, s42, 0
    s_nop 0
    v_permlane16_swap_b32 v48, v50
    v_permlane16_swap_b32 v49, v51
    s_nop 0
    v_lshlrev_b32 v8, 16, v48
    v_and_b32 v9, 0xffff0000, v48
    v_lshlrev_b32 v10, 16, v96
    v_and_b32 v11, 0xffff0000, v96
    v_pk_add_f32 v[8:9], v[8:9], v[10:11]
    v_cvt_pk_bf16_f32 v48, v8, v9
    v_lshlrev_b32 v8, 16, v49
    v_and_b32 v9, 0xffff0000, v49
    v_lshlrev_b32 v10, 16, v97
    v_and_b32 v11, 0xffff0000, v97
    v_pk_add_f32 v[8:9], v[8:9], v[10:11]
    v_cvt_pk_bf16_f32 v49, v8, v9
    v_lshlrev_b32 v8, 16, v50
    v_and_b32 v9, 0xffff0000, v50
    v_lshlrev_b32 v10, 16, v98
    v_and_b32 v11, 0xffff0000, v98
    v_pk_add_f32 v[8:9], v[8:9], v[10:11]
    v_cvt_pk_bf16_f32 v50, v8, v9
    v_lshlrev_b32 v8, 16, v51
    v_and_b32 v9, 0xffff0000, v51
    v_lshlrev_b32 v10, 16, v99
    v_and_b32 v11, 0xffff0000, v99
    v_pk_add_f32 v[8:9], v[8:9], v[10:11]
    v_cvt_pk_bf16_f32 v51, v8, v9
    s_add_u32 s27, s27, 0
    buffer_store_dwordx4 v[48:51], v14, s[16:19], s27 offen
    v_cvt_pk_bf16_f32 v52, v88, v89
    v_cvt_pk_bf16_f32 v53, v90, v91
    v_cvt_pk_bf16_f32 v54, v92, v93
    v_cvt_pk_bf16_f32 v55, v94, v95
    s_add_u32 s27, s42, 16384
    s_nop 0
    v_permlane16_swap_b32 v52, v54
    v_permlane16_swap_b32 v53, v55
    s_nop 0
    v_lshlrev_b32 v8, 16, v52
    v_and_b32 v9, 0xffff0000, v52
    v_lshlrev_b32 v10, 16, v100
    v_and_b32 v11, 0xffff0000, v100
    v_pk_add_f32 v[8:9], v[8:9], v[10:11]
    v_cvt_pk_bf16_f32 v52, v8, v9
    v_lshlrev_b32 v8, 16, v53
    v_and_b32 v9, 0xffff0000, v53
    v_lshlrev_b32 v10, 16, v101
    v_and_b32 v11, 0xffff0000, v101
    v_pk_add_f32 v[8:9], v[8:9], v[10:11]
    v_cvt_pk_bf16_f32 v53, v8, v9
    v_lshlrev_b32 v8, 16, v54
    v_and_b32 v9, 0xffff0000, v54
    v_lshlrev_b32 v10, 16, v102
    v_and_b32 v11, 0xffff0000, v102
    v_pk_add_f32 v[8:9], v[8:9], v[10:11]
    v_cvt_pk_bf16_f32 v54, v8, v9
    v_lshlrev_b32 v8, 16, v55
    v_and_b32 v9, 0xffff0000, v55
    v_lshlrev_b32 v10, 16, v103
    v_and_b32 v11, 0xffff0000, v103
    v_pk_add_f32 v[8:9], v[8:9], v[10:11]
    v_cvt_pk_bf16_f32 v55, v8, v9
    s_add_u32 s27, s27, 0
    buffer_store_dwordx4 v[52:55], v14, s[16:19], s27 offen
    s_endpgm
k5_w2_kernel_loader:
    s_sub_u32 s24, s24, 4
    v_lshrrev_b32 v5, 3, v2
    v_and_b32 v6, 7, v2
    s_mov_b32 s27, 2816
    v_lshrrev_b32 v8, 1, v5
    v_xor_b32 v8, v8, v6
    v_mul_lo_u32 v7, v5, s27
    v_lshl_add_u32 v16, v8, 4, v7
    v_xor_b32 v9, 4, v8
    v_lshl_add_u32 v17, v9, 4, v7
    v_add_u32 v17, 21504, v17
    v_lshrrev_b32 v6, 2, v2
    s_mov_b32 s27, 1024
    v_mul_lo_u32 v6, v6, s27
    v_lshrrev_b32 v9, 5, v2
    v_lshlrev_b32 v9, 1, v9
    v_and_b32 v8, 3, v2
    v_xor_b32 v9, v9, v8
    v_lshl_add_u32 v20, v9, 4, v6
    v_add_u32 v21, 64, v20
    s_mul_i32 s28, s24, 16
    s_add_u32 s42, s28, s25
    s_mul_i32 s42, s42, 2816
    s_add_u32 s42, s42, 10485760
    s_mul_i32 s30, s24, 2048
    s_add_u32 s30, s30, 2048
    s_and_b32 s28, s24, 3
    s_mul_i32 s43, s28, 16384
    s_lshl_b32 s29, s26, 1
    s_add_u32 s43, s43, s29
    s_lshl_b32 s31, s28, 10
    s_add_u32 s31, s31, 10240
    s_mov_b32 s44, 0
    s_mov_b32 s45, 0
    s_waitcnt lgkmcnt(0)
    s_mov_b32 s8, s4
    s_mov_b32 s9, s5
    s_mov_b32 s10, 16252928
    s_mov_b32 s11, 0x00020000
    s_mov_b32 s12, s6
    s_mov_b32 s13, s7
    s_mov_b32 s14, 1409024
    s_mov_b32 s15, 0x00020000
    s_add_u32 m0, s30, s44
    s_add_u32 s27, s31, s44
    buffer_load_dwordx4 v16, s[8:11], s42 offen offset:0 lds
    buffer_load_dwordx4 v17, s[8:11], s42 offen offset:1024 lds
    s_add_u32 m0, s27, 0
    s_add_u32 s42, s42, 128
    buffer_load_dwordx4 v20, s[12:15], s43 offen lds
    s_add_u32 m0, s27, 4096
    s_nop 0
    buffer_load_dwordx4 v21, s[12:15], s43 offen lds
    s_add_u32 s43, s43, 65536
    s_add_u32 s44, s44, 16384
    s_add_u32 s45, s45, 1
    s_cmp_eq_u32 s45, 8
    s_cselect_b32 s44, 0, s44
    s_cselect_b32 s45, 0, s45
    s_add_u32 m0, s30, s44
    s_add_u32 s27, s31, s44
    buffer_load_dwordx4 v16, s[8:11], s42 offen offset:0 lds
    buffer_load_dwordx4 v17, s[8:11], s42 offen offset:1024 lds
    s_add_u32 m0, s27, 0
    s_add_u32 s42, s42, 128
    buffer_load_dwordx4 v20, s[12:15], s43 offen lds
    s_add_u32 m0, s27, 4096
    s_nop 0
    buffer_load_dwordx4 v21, s[12:15], s43 offen lds
    s_add_u32 s43, s43, 65536
    s_add_u32 s44, s44, 16384
    s_add_u32 s45, s45, 1
    s_cmp_eq_u32 s45, 8
    s_cselect_b32 s44, 0, s44
    s_cselect_b32 s45, 0, s45
    s_waitcnt vmcnt(4)
    s_barrier
    s_add_u32 m0, s30, s44
    s_add_u32 s27, s31, s44
    buffer_load_dwordx4 v16, s[8:11], s42 offen offset:0 lds
    buffer_load_dwordx4 v17, s[8:11], s42 offen offset:1024 lds
    s_add_u32 m0, s27, 0
    s_add_u32 s42, s42, 128
    buffer_load_dwordx4 v20, s[12:15], s43 offen lds
    s_add_u32 m0, s27, 4096
    s_nop 0
    buffer_load_dwordx4 v21, s[12:15], s43 offen lds
    s_add_u32 s43, s43, 65536
    s_add_u32 s44, s44, 16384
    s_add_u32 s45, s45, 1
    s_cmp_eq_u32 s45, 8
    s_cselect_b32 s44, 0, s44
    s_cselect_b32 s45, 0, s45
    s_add_u32 m0, s30, s44
    s_add_u32 s27, s31, s44
    buffer_load_dwordx4 v16, s[8:11], s42 offen offset:0 lds
    buffer_load_dwordx4 v17, s[8:11], s42 offen offset:1024 lds
    s_add_u32 m0, s27, 0
    s_add_u32 s42, s42, 128
    buffer_load_dwordx4 v20, s[12:15], s43 offen lds
    s_add_u32 m0, s27, 4096
    s_nop 0
    buffer_load_dwordx4 v21, s[12:15], s43 offen lds
    s_add_u32 s43, s43, 65536
    s_add_u32 s44, s44, 16384
    s_add_u32 s45, s45, 1
    s_cmp_eq_u32 s45, 8
    s_cselect_b32 s44, 0, s44
    s_cselect_b32 s45, 0, s45
    s_waitcnt vmcnt(8)
    s_barrier
    s_add_u32 m0, s30, s44
    s_add_u32 s27, s31, s44
    buffer_load_dwordx4 v16, s[8:11], s42 offen offset:0 lds
    buffer_load_dwordx4 v17, s[8:11], s42 offen offset:1024 lds
    s_add_u32 m0, s27, 0
    s_add_u32 s42, s42, 128
    buffer_load_dwordx4 v20, s[12:15], s43 offen lds
    s_add_u32 m0, s27, 4096
    s_nop 0
    buffer_load_dwordx4 v21, s[12:15], s43 offen lds
    s_add_u32 s43, s43, 65536
    s_add_u32 s44, s44, 16384
    s_add_u32 s45, s45, 1
    s_cmp_eq_u32 s45, 8
    s_cselect_b32 s44, 0, s44
    s_cselect_b32 s45, 0, s45
    s_add_u32 m0, s30, s44
    s_add_u32 s27, s31, s44
    buffer_load_dwordx4 v16, s[8:11], s42 offen offset:0 lds
    buffer_load_dwordx4 v17, s[8:11], s42 offen offset:1024 lds
    s_add_u32 m0, s27, 0
    s_add_u32 s42, s42, 128
    buffer_load_dwordx4 v20, s[12:15], s43 offen lds
    s_add_u32 m0, s27, 4096
    s_nop 0
    buffer_load_dwordx4 v21, s[12:15], s43 offen lds
    s_add_u32 s43, s43, 65536
    s_add_u32 s44, s44, 16384
    s_add_u32 s45, s45, 1
    s_cmp_eq_u32 s45, 8
    s_cselect_b32 s44, 0, s44
    s_cselect_b32 s45, 0, s45
    s_waitcnt vmcnt(12)
    s_barrier
    s_add_u32 m0, s30, s44
    s_add_u32 s27, s31, s44
    buffer_load_dwordx4 v16, s[8:11], s42 offen offset:0 lds
    buffer_load_dwordx4 v17, s[8:11], s42 offen offset:1024 lds
    s_add_u32 m0, s27, 0
    s_add_u32 s42, s42, 128
    buffer_load_dwordx4 v20, s[12:15], s43 offen lds
    s_add_u32 m0, s27, 4096
    s_nop 0
    buffer_load_dwordx4 v21, s[12:15], s43 offen lds
    s_add_u32 s43, s43, 65536
    s_add_u32 s44, s44, 16384
    s_add_u32 s45, s45, 1
    s_cmp_eq_u32 s45, 8
    s_cselect_b32 s44, 0, s44
    s_cselect_b32 s45, 0, s45
    s_add_u32 m0, s30, s44
    s_add_u32 s27, s31, s44
    buffer_load_dwordx4 v16, s[8:11], s42 offen offset:0 lds
    buffer_load_dwordx4 v17, s[8:11], s42 offen offset:1024 lds
    s_add_u32 m0, s27, 0
    s_add_u32 s42, s42, 128
    buffer_load_dwordx4 v20, s[12:15], s43 offen lds
    s_add_u32 m0, s27, 4096
    s_nop 0
    buffer_load_dwordx4 v21, s[12:15], s43 offen lds
    s_add_u32 s43, s43, 65536
    s_add_u32 s44, s44, 16384
    s_add_u32 s45, s45, 1
    s_cmp_eq_u32 s45, 8
    s_cselect_b32 s44, 0, s44
    s_cselect_b32 s45, 0, s45
    s_waitcnt vmcnt(16)
    s_barrier
    s_add_u32 m0, s30, s44
    s_add_u32 s27, s31, s44
    buffer_load_dwordx4 v16, s[8:11], s42 offen offset:0 lds
    buffer_load_dwordx4 v17, s[8:11], s42 offen offset:1024 lds
    s_add_u32 m0, s27, 0
    s_add_u32 s42, s42, 128
    buffer_load_dwordx4 v20, s[12:15], s43 offen lds
    s_add_u32 m0, s27, 4096
    s_nop 0
    buffer_load_dwordx4 v21, s[12:15], s43 offen lds
    s_add_u32 s43, s43, 65536
    s_add_u32 s44, s44, 16384
    s_add_u32 s45, s45, 1
    s_cmp_eq_u32 s45, 8
    s_cselect_b32 s44, 0, s44
    s_cselect_b32 s45, 0, s45
    s_add_u32 m0, s30, s44
    s_add_u32 s27, s31, s44
    buffer_load_dwordx4 v16, s[8:11], s42 offen offset:0 lds
    buffer_load_dwordx4 v17, s[8:11], s42 offen offset:1024 lds
    s_add_u32 m0, s27, 0
    s_add_u32 s42, s42, 128
    buffer_load_dwordx4 v20, s[12:15], s43 offen lds
    s_add_u32 m0, s27, 4096
    s_nop 0
    buffer_load_dwordx4 v21, s[12:15], s43 offen lds
    s_add_u32 s43, s43, 65536
    s_add_u32 s44, s44, 16384
    s_add_u32 s45, s45, 1
    s_cmp_eq_u32 s45, 8
    s_cselect_b32 s44, 0, s44
    s_cselect_b32 s45, 0, s45
    s_waitcnt vmcnt(20)
    s_barrier
    s_add_u32 m0, s30, s44
    s_add_u32 s27, s31, s44
    buffer_load_dwordx4 v16, s[8:11], s42 offen offset:0 lds
    buffer_load_dwordx4 v17, s[8:11], s42 offen offset:1024 lds
    s_add_u32 m0, s27, 0
    s_add_u32 s42, s42, 128
    buffer_load_dwordx4 v20, s[12:15], s43 offen lds
    s_add_u32 m0, s27, 4096
    s_nop 0
    buffer_load_dwordx4 v21, s[12:15], s43 offen lds
    s_add_u32 s43, s43, 65536
    s_add_u32 s44, s44, 16384
    s_add_u32 s45, s45, 1
    s_cmp_eq_u32 s45, 8
    s_cselect_b32 s44, 0, s44
    s_cselect_b32 s45, 0, s45
    s_add_u32 m0, s30, s44
    s_add_u32 s27, s31, s44
    buffer_load_dwordx4 v16, s[8:11], s42 offen offset:0 lds
    buffer_load_dwordx4 v17, s[8:11], s42 offen offset:1024 lds
    s_add_u32 m0, s27, 0
    s_add_u32 s42, s42, 128
    buffer_load_dwordx4 v20, s[12:15], s43 offen lds
    s_add_u32 m0, s27, 4096
    s_nop 0
    buffer_load_dwordx4 v21, s[12:15], s43 offen lds
    s_add_u32 s43, s43, 65536
    s_add_u32 s44, s44, 16384
    s_add_u32 s45, s45, 1
    s_cmp_eq_u32 s45, 8
    s_cselect_b32 s44, 0, s44
    s_cselect_b32 s45, 0, s45
    s_waitcnt vmcnt(24)
    s_barrier
    s_add_u32 m0, s30, s44
    s_add_u32 s27, s31, s44
    buffer_load_dwordx4 v16, s[8:11], s42 offen offset:0 lds
    buffer_load_dwordx4 v17, s[8:11], s42 offen offset:1024 lds
    s_add_u32 m0, s27, 0
    s_add_u32 s42, s42, 128
    buffer_load_dwordx4 v20, s[12:15], s43 offen lds
    s_add_u32 m0, s27, 4096
    s_nop 0
    buffer_load_dwordx4 v21, s[12:15], s43 offen lds
    s_add_u32 s43, s43, 65536
    s_add_u32 s44, s44, 16384
    s_add_u32 s45, s45, 1
    s_cmp_eq_u32 s45, 8
    s_cselect_b32 s44, 0, s44
    s_cselect_b32 s45, 0, s45
    s_waitcnt vmcnt(24)
    s_barrier
    s_add_u32 m0, s30, s44
    s_add_u32 s27, s31, s44
    buffer_load_dwordx4 v16, s[8:11], s42 offen offset:0 lds
    buffer_load_dwordx4 v17, s[8:11], s42 offen offset:1024 lds
    s_add_u32 m0, s27, 0
    s_add_u32 s42, s42, 128
    buffer_load_dwordx4 v20, s[12:15], s43 offen lds
    s_add_u32 m0, s27, 4096
    s_nop 0
    buffer_load_dwordx4 v21, s[12:15], s43 offen lds
    s_add_u32 s43, s43, 65536
    s_add_u32 s44, s44, 16384
    s_add_u32 s45, s45, 1
    s_cmp_eq_u32 s45, 8
    s_cselect_b32 s44, 0, s44
    s_cselect_b32 s45, 0, s45
    s_waitcnt vmcnt(24)
    s_barrier
    s_add_u32 m0, s30, s44
    s_add_u32 s27, s31, s44
    buffer_load_dwordx4 v16, s[8:11], s42 offen offset:0 lds
    buffer_load_dwordx4 v17, s[8:11], s42 offen offset:1024 lds
    s_add_u32 m0, s27, 0
    s_add_u32 s42, s42, 128
    buffer_load_dwordx4 v20, s[12:15], s43 offen lds
    s_add_u32 m0, s27, 4096
    s_nop 0
    buffer_load_dwordx4 v21, s[12:15], s43 offen lds
    s_add_u32 s43, s43, 65536
    s_add_u32 s44, s44, 16384
    s_add_u32 s45, s45, 1
    s_cmp_eq_u32 s45, 8
    s_cselect_b32 s44, 0, s44
    s_cselect_b32 s45, 0, s45
    s_waitcnt vmcnt(24)
    s_barrier
    s_add_u32 m0, s30, s44
    s_add_u32 s27, s31, s44
    buffer_load_dwordx4 v16, s[8:11], s42 offen offset:0 lds
    buffer_load_dwordx4 v17, s[8:11], s42 offen offset:1024 lds
    s_add_u32 m0, s27, 0
    s_add_u32 s42, s42, 128
    buffer_load_dwordx4 v20, s[12:15], s43 offen lds
    s_add_u32 m0, s27, 4096
    s_nop 0
    buffer_load_dwordx4 v21, s[12:15], s43 offen lds
    s_add_u32 s43, s43, 65536
    s_add_u32 s44, s44, 16384
    s_add_u32 s45, s45, 1
    s_cmp_eq_u32 s45, 8
    s_cselect_b32 s44, 0, s44
    s_cselect_b32 s45, 0, s45
    s_waitcnt vmcnt(24)
    s_barrier
    s_add_u32 m0, s30, s44
    s_add_u32 s27, s31, s44
    buffer_load_dwordx4 v16, s[8:11], s42 offen offset:0 lds
    buffer_load_dwordx4 v17, s[8:11], s42 offen offset:1024 lds
    s_add_u32 m0, s27, 0
    s_add_u32 s42, s42, 128
    buffer_load_dwordx4 v20, s[12:15], s43 offen lds
    s_add_u32 m0, s27, 4096
    s_nop 0
    buffer_load_dwordx4 v21, s[12:15], s43 offen lds
    s_add_u32 s43, s43, 65536
    s_add_u32 s44, s44, 16384
    s_add_u32 s45, s45, 1
    s_cmp_eq_u32 s45, 8
    s_cselect_b32 s44, 0, s44
    s_cselect_b32 s45, 0, s45
    s_waitcnt vmcnt(24)
    s_barrier
    s_add_u32 m0, s30, s44
    s_add_u32 s27, s31, s44
    buffer_load_dwordx4 v16, s[8:11], s42 offen offset:0 lds
    buffer_load_dwordx4 v17, s[8:11], s42 offen offset:1024 lds
    s_add_u32 m0, s27, 0
    s_add_u32 s42, s42, 128
    buffer_load_dwordx4 v20, s[12:15], s43 offen lds
    s_add_u32 m0, s27, 4096
    s_nop 0
    buffer_load_dwordx4 v21, s[12:15], s43 offen lds
    s_add_u32 s43, s43, 65536
    s_add_u32 s44, s44, 16384
    s_add_u32 s45, s45, 1
    s_cmp_eq_u32 s45, 8
    s_cselect_b32 s44, 0, s44
    s_cselect_b32 s45, 0, s45
    s_waitcnt vmcnt(24)
    s_barrier
    s_add_u32 m0, s30, s44
    s_add_u32 s27, s31, s44
    buffer_load_dwordx4 v16, s[8:11], s42 offen offset:0 lds
    buffer_load_dwordx4 v17, s[8:11], s42 offen offset:1024 lds
    s_add_u32 m0, s27, 0
    s_add_u32 s42, s42, 128
    buffer_load_dwordx4 v20, s[12:15], s43 offen lds
    s_add_u32 m0, s27, 4096
    s_nop 0
    buffer_load_dwordx4 v21, s[12:15], s43 offen lds
    s_add_u32 s43, s43, 65536
    s_add_u32 s44, s44, 16384
    s_add_u32 s45, s45, 1
    s_cmp_eq_u32 s45, 8
    s_cselect_b32 s44, 0, s44
    s_cselect_b32 s45, 0, s45
    s_waitcnt vmcnt(24)
    s_barrier
    s_add_u32 m0, s30, s44
    s_add_u32 s27, s31, s44
    buffer_load_dwordx4 v16, s[8:11], s42 offen offset:0 lds
    buffer_load_dwordx4 v17, s[8:11], s42 offen offset:1024 lds
    s_add_u32 m0, s27, 0
    s_add_u32 s42, s42, 128
    buffer_load_dwordx4 v20, s[12:15], s43 offen lds
    s_add_u32 m0, s27, 4096
    s_nop 0
    buffer_load_dwordx4 v21, s[12:15], s43 offen lds
    s_add_u32 s43, s43, 65536
    s_add_u32 s44, s44, 16384
    s_add_u32 s45, s45, 1
    s_cmp_eq_u32 s45, 8
    s_cselect_b32 s44, 0, s44
    s_cselect_b32 s45, 0, s45
    s_waitcnt vmcnt(24)
    s_barrier
    s_add_u32 m0, s30, s44
    s_add_u32 s27, s31, s44
    buffer_load_dwordx4 v16, s[8:11], s42 offen offset:0 lds
    buffer_load_dwordx4 v17, s[8:11], s42 offen offset:1024 lds
    s_add_u32 m0, s27, 0
    s_add_u32 s42, s42, 128
    buffer_load_dwordx4 v20, s[12:15], s43 offen lds
    s_add_u32 m0, s27, 4096
    s_nop 0
    buffer_load_dwordx4 v21, s[12:15], s43 offen lds
    s_add_u32 s43, s43, 65536
    s_add_u32 s44, s44, 16384
    s_add_u32 s45, s45, 1
    s_cmp_eq_u32 s45, 8
    s_cselect_b32 s44, 0, s44
    s_cselect_b32 s45, 0, s45
    s_waitcnt vmcnt(24)
    s_barrier
    s_add_u32 m0, s30, s44
    s_add_u32 s27, s31, s44
    buffer_load_dwordx4 v16, s[8:11], s42 offen offset:0 lds
    buffer_load_dwordx4 v17, s[8:11], s42 offen offset:1024 lds
    s_add_u32 m0, s27, 0
    s_add_u32 s42, s42, 128
    buffer_load_dwordx4 v20, s[12:15], s43 offen lds
    s_add_u32 m0, s27, 4096
    s_nop 0
    buffer_load_dwordx4 v21, s[12:15], s43 offen lds
    s_add_u32 s43, s43, 65536
    s_add_u32 s44, s44, 16384
    s_add_u32 s45, s45, 1
    s_cmp_eq_u32 s45, 8
    s_cselect_b32 s44, 0, s44
    s_cselect_b32 s45, 0, s45
    s_waitcnt vmcnt(24)
    s_barrier
    s_waitcnt vmcnt(20)
    s_barrier
    s_waitcnt vmcnt(16)
    s_barrier
    s_waitcnt vmcnt(12)
    s_barrier
    s_waitcnt vmcnt(8)
    s_barrier
    s_waitcnt vmcnt(4)
    s_barrier
    s_waitcnt vmcnt(0)
    s_barrier
    s_barrier
k5_w2_kernel_end:
    s_endpgm
.section .rodata,"a"
.p2align 6
.amdhsa_kernel k1_qkv_kernel
  .amdhsa_next_free_vgpr 172
  .amdhsa_next_free_sgpr 56
  .amdhsa_accum_offset 172
  .amdhsa_group_segment_fixed_size 0
  .amdhsa_kernarg_size 72
  .amdhsa_user_sgpr_count 2
  .amdhsa_user_sgpr_kernarg_segment_ptr 1
  .amdhsa_system_sgpr_workgroup_id_x 1
.end_amdhsa_kernel
.p2align 6
.amdhsa_kernel k2_attn_kernel
  .amdhsa_next_free_vgpr 118
  .amdhsa_next_free_sgpr 56
  .amdhsa_accum_offset 120
  .amdhsa_group_segment_fixed_size 0
  .amdhsa_kernarg_size 72
  .amdhsa_user_sgpr_count 2
  .amdhsa_user_sgpr_kernarg_segment_ptr 1
  .amdhsa_system_sgpr_workgroup_id_x 1
.end_amdhsa_kernel
.p2align 6
.amdhsa_kernel k3_wo_kernel
  .amdhsa_next_free_vgpr 112
  .amdhsa_next_free_sgpr 56
  .amdhsa_accum_offset 112
  .amdhsa_group_segment_fixed_size 0
  .amdhsa_kernarg_size 72
  .amdhsa_user_sgpr_count 2
  .amdhsa_user_sgpr_kernarg_segment_ptr 1
  .amdhsa_system_sgpr_workgroup_id_x 1
.end_amdhsa_kernel
.p2align 6
.amdhsa_kernel k4_w1_kernel
  .amdhsa_next_free_vgpr 172
  .amdhsa_next_free_sgpr 56
  .amdhsa_accum_offset 172
  .amdhsa_group_segment_fixed_size 0
  .amdhsa_kernarg_size 72
  .amdhsa_user_sgpr_count 2
  .amdhsa_user_sgpr_kernarg_segment_ptr 1
  .amdhsa_system_sgpr_workgroup_id_x 1
.end_amdhsa_kernel
.p2align 6
.amdhsa_kernel k5_w2_kernel
  .amdhsa_next_free_vgpr 112
  .amdhsa_next_free_sgpr 56
  .amdhsa_accum_offset 112
  .amdhsa_group_segment_fixed_size 0
  .amdhsa_kernarg_size 72
  .amdhsa_user_sgpr_count 2
  .amdhsa_user_sgpr_kernarg_segment_ptr 1
  .amdhsa_system_sgpr_workgroup_id_x 1
.end_amdhsa_kernel
```
